```python
import torch

def _softmax(x, axis=-1):
    return torch.softmax(x, dim=axis)
def _gelu(x):
    return torch.nn.functional.gelu(x, approximate="tanh")
def _silu(x):
    return torch.nn.functional.silu(x)
def _sigmoid(x):
    return torch.sigmoid(x)
def _layernorm(x, axis=-1, eps=1e-5):
    m = x.mean(dim=axis, keepdim=True)
    v = x.var(dim=axis, keepdim=True, unbiased=False)
    return (x - m) / torch.sqrt(v + eps)
def _scatter_add(tgt, idx, src, axis=0):
    return tgt.clone().index_add_(axis, idx, src)
def _segment_sum(src, seg, n):
    out = torch.zeros((n,) + src.shape[1:], dtype=src.dtype)
    return out.index_add_(0, seg, src)
def _pad(x, pw):
    flat = tuple(v for pair in reversed(pw) for v in pair)
    return torch.nn.functional.pad(x, flat)

kernel_name = 'concat_heads__mha_block_cached__gqa_block_cached__near_ridge'

def setup_inputs():

    _w = (lambda a: (lambda t: t.to(torch.bfloat16) if t.is_floating_point() else t)(torch.as_tensor(a)))
    def _A_setup():
        B, Sq, D = 8, 160, 448
        H, Sk, Dh = 16, 512, 256
        return {
            "x": _w((lambda *s: torch.randn(*s, dtype=torch.bfloat16) * 0.8)(B, Sq, D)),
            "k_cache": _w((lambda *s: torch.randn(*s, dtype=torch.bfloat16) * 0.8)(B, H, Sk, Dh)),
            "v_cache": _w((lambda *s: torch.randn(*s, dtype=torch.bfloat16) * 0.05)(B, H, Sk, Dh)),
            "wq": _w((lambda *s: torch.randn(*s, dtype=torch.bfloat16) * 0.8)(D, H * Dh) * (D ** -0.5)),
            "wo": _w((lambda *s: torch.randn(*s, dtype=torch.bfloat16) * 0.05)(H * Dh, D) * ((H * Dh) ** -0.5)),
        }
    _A_in = _A_setup()

    def _B_setup():
        B, Sq, D = 8, 160, 448
        Hq, Hkv, Sk, Dh = 16, 16, 512, 256
        assert Hq % Hkv == 0, (Hq, Hkv)
        return {
            "x": _w((lambda *s: torch.randn(*s, dtype=torch.bfloat16) * 0.8)(B, Sq, D)),
            "k_cache": _w((lambda *s: torch.randn(*s, dtype=torch.bfloat16) * 0.8)(B, Hkv, Sk, Dh)),
            "v_cache": _w((lambda *s: torch.randn(*s, dtype=torch.bfloat16) * 0.05)(B, Hkv, Sk, Dh)),
            "wq": _w((lambda *s: torch.randn(*s, dtype=torch.bfloat16) * 0.8)(D, Hq * Dh) * (D ** -0.5)),
            "wo": _w((lambda *s: torch.randn(*s, dtype=torch.bfloat16) * 0.05)(Hq * Dh, D) * ((Hq * Dh) ** -0.5)),
        }
    _B_in = _B_setup()

    return {
        "A_x": _A_in["x"],
        "A_k_cache": _A_in["k_cache"],
        "A_v_cache": _A_in["v_cache"],
        "A_wq": _A_in["wq"],
        "A_wo": _A_in["wo"],
        "B_x": _B_in["x"],
        "B_k_cache": _B_in["k_cache"],
        "B_v_cache": _B_in["v_cache"],
        "B_wq": _B_in["wq"],
        "B_wo": _B_in["wo"],
    }

def reference(A_x, A_k_cache, A_v_cache, A_wq, A_wo, B_x, B_k_cache, B_v_cache, B_wq, B_wo):
    def _A_ref(x, k_cache, v_cache, wq, wo):
        B, Sq, D = x.shape
        H, Dh = 16, 256
        q = (lambda x, *d: x.permute(*d))((x @ wq).reshape(B, Sq, H, Dh), 0, 2, 1, 3)
        scores = torch.einsum("bhqd,bhkd->bhqk", q, k_cache) * (Dh ** -0.5)
        p = _softmax(scores, axis=-1)
        o = torch.einsum("bhqk,bhkd->bhqd", p, v_cache)
        return (lambda x, *d: x.permute(*d))(o, 0, 2, 1, 3).reshape(B, Sq, H * Dh) @ wo

    def _B_ref(x, k_cache, v_cache, wq, wo):
        B, Sq, D = x.shape
        Hq, Dh = 16, 256
        Hkv = k_cache.shape[1]
        rep = Hq // Hkv
        q = (lambda x, *d: x.permute(*d))((x @ wq).reshape(B, Sq, Hq, Dh), 0, 2, 1, 3)
        k = (lambda x, n, axis: torch.repeat_interleave(x, n, dim=axis))(k_cache, rep, axis=1)
        v = (lambda x, n, axis: torch.repeat_interleave(x, n, dim=axis))(v_cache, rep, axis=1)
        scores = torch.einsum("bhqd,bhkd->bhqk", q, k) * (Dh ** -0.5)
        p = _softmax(scores, axis=-1)
        o = torch.einsum("bhqk,bhkd->bhqd", p, v)
        return (lambda x, *d: x.permute(*d))(o, 0, 2, 1, 3).reshape(B, Sq, Hq * Dh) @ wo

    a = _A_ref(A_x, A_k_cache, A_v_cache, A_wq, A_wo)
    b = _B_ref(B_x, B_k_cache, B_v_cache, B_wq, B_wo)
    return torch.concatenate([a, b], axis=-1)
```

```asm
; @launch grid=(256,1,1) block=(256,1,1) lds=163840
.amdgcn_target "amdgcn-amd-amdhsa--gfx950"
.text
.globl concat_heads__mha_block_cached__gqa_block_cached__near_ridge_kernel
.p2align 8
.type concat_heads__mha_block_cached__gqa_block_cached__near_ridge_kernel,@function
concat_heads__mha_block_cached__gqa_block_cached__near_ridge_kernel:
    s_cmp_ge_u32 s2, 256
    s_cbranch_scc1 L_end
    s_load_dwordx8 s[4:11], s[0:1], 0
    s_load_dwordx4 s[12:15], s[0:1], 32
    s_load_dwordx8 s[16:23], s[0:1], 48
    s_load_dwordx4 s[96:99], s[0:1], 80
    s_load_dwordx2 s[100:101], s[0:1], 96
    s_getpc_b64 s[44:45]
    s_lshr_b32 s3, s2, 3
    s_and_b32 s3, s3, 15
    s_lshl_b32 s3, s3, 13
    v_lshrrev_b32 v230, 2, v0
    v_lshl_add_u32 v230, v230, 7, s3
    v_min_u32 v5, 0xd900, v230
    global_load_dword v251, v5, s[44:45]
    v_lshrrev_b32 v229, 6, v0
    v_and_b32 v0, 63, v0
    v_readfirstlane_b32 s48, v229
    v_lshrrev_b32 v230, 5, v0
    v_and_b32 v231, 31, v0
    v_lshlrev_b32 v231, 4, v231
    v_lshl_add_u32 v232, v229, 2, v230
    v_lshl_add_u32 v1, v232, 15, v231
    v_add_u32 v231, 2048, v231
    v_lshl_add_u32 v2, v232, 11, v231
    v_lshl_add_u32 v232, v229, 1, v230
    v_lshl_add_u32 v3, v232, 12, v231
    v_lshrrev_b32 v230, 3, v0
    v_mul_u32_u24 v232, 40, v229
    v_add_u32 v232, v232, v230
    v_mul_u32_u24 v232, 896, v232
    v_and_b32 v231, 1, v229
    v_lshlrev_b32 v231, 2, v231
    v_lshrrev_b32 v233, 4, v0
    v_add_u32 v231, v231, v233
    v_xor_b32 v231, v231, v0
    v_and_b32 v231, 7, v231
    v_lshl_add_u32 v224, v231, 4, v232
    v_xor_b32 v231, 4, v231
    v_lshl_add_u32 v225, v231, 4, v232
    v_add_u32 v226, 12288, v224
    v_add_u32 v227, 18432, v225
    v_add_u32 v228, 28672, v224
    v_add_u32 v225, 6144, v225
    s_lshr_b32 s3, s2, 3
    s_and_b32 s46, s3, 7
    s_lshr_b32 s3, s3, 3
    s_and_b32 s62, s2, 3
    s_lshl_b32 s62, s62, 2
    s_add_u32 s62, s62, s3
    s_add_u32 s56, s46, s3
    s_lshl_b32 s52, s3, 1
    s_add_u32 s52, s52, s46
    s_mov_b32 s47, s52
    s_mul_i32 s49, s48, 8448
    s_mul_i32 s50, s48, 5120
    s_mul_i32 s58, s46, 143360
    s_lshl_b32 s59, s62, 9
    s_mov_b32 s26, 143360
    s_mov_b32 s27, 0x20000
    s_sub_u32 s30, 3670016, s59
    s_mov_b32 s31, 0x20000
    s_bitcmp1_b32 s2, 2
    s_waitcnt lgkmcnt(0)
    s_cselect_b32 s4, s14, s4
    s_cselect_b32 s5, s15, s5
    s_cselect_b32 s10, s20, s10
    s_cselect_b32 s11, s21, s11
    s_cselect_b32 s6, s16, s6
    s_cselect_b32 s7, s17, s7
    s_cselect_b32 s8, s18, s8
    s_cselect_b32 s9, s19, s9
    s_cselect_b32 s12, s22, s12
    s_cselect_b32 s13, s23, s13
    s_cselect_b32 s14, 8, 0
    s_add_u32 s24, s4, s58
    s_addc_u32 s25, s5, 0
    s_add_u32 s28, s10, s59
    s_addc_u32 s29, s11, 0
    v_add_u32 v28, 0, v1
    v_add_u32 v29, 7160, v1
    v_add_u32 v30, 14272, v1
    v_add_u32 v31, 21432, v1
    s_bitcmp1_b32 s56, 0
    s_cselect_b32 s54, 1, 0
    s_lshl_b32 s53, s54, 19
    s_lshl_b32 s54, s54, 7
    s_add_u32 m0, s50, 101376
    s_nop 0
    buffer_load_dwordx4 v224, s[24:27], s54 offen offset:0  lds
    buffer_load_dwordx4 v225, s[24:27], s54 offen offset:1024  lds
    buffer_load_dwordx4 v226, s[24:27], s54 offen offset:2048  lds
    buffer_load_dwordx4 v227, s[24:27], s54 offen offset:3072  lds
    s_add_u32 m0, s50, 105472
    s_nop 0
    buffer_load_dwordx4 v228, s[24:27], s54 offen  lds
    s_add_u32 m0, s49, 0
    s_nop 0
    buffer_load_dwordx4 v28, s[28:31], s53 offen offset:0  lds
    buffer_load_dwordx4 v29, s[28:31], s53 offen offset:1032  lds
    buffer_load_dwordx4 v30, s[28:31], s53 offen offset:2112  lds
    buffer_load_dwordx4 v31, s[28:31], s53 offen offset:3144  lds
    s_add_u32 s51, s53, 65536
    s_add_u32 m0, s49, 4224
    s_nop 0
    buffer_load_dwordx4 v28, s[28:31], s51 offen offset:0  lds
    buffer_load_dwordx4 v29, s[28:31], s51 offen offset:1032  lds
    buffer_load_dwordx4 v30, s[28:31], s51 offen offset:2112  lds
    buffer_load_dwordx4 v31, s[28:31], s51 offen offset:3144  lds
    s_lshl_b32 s3, s46, 4
    s_add_u32 s3, s3, s62
    s_lshl_b32 s15, s3, 18
    s_add_u32 s32, s6, s15
    s_addc_u32 s33, s7, 0
    s_sub_u32 s32, s32, 2048
    s_subb_u32 s33, s33, 0
    s_mov_b32 s34, 264192
    s_mov_b32 s35, 0x20000
    s_add_u32 s36, s8, s15
    s_addc_u32 s37, s9, 0
    s_sub_u32 s36, s36, 2048
    s_subb_u32 s37, s37, 0
    s_mov_b32 s38, 264192
    s_mov_b32 s39, 0x20000
    s_and_b32 s15, s62, 14
    s_mul_i32 s15, s15, 229376
    s_add_u32 s40, s12, s15
    s_addc_u32 s41, s13, 0
    s_sub_u32 s40, s40, 2048
    s_subb_u32 s41, s41, 0
    s_mov_b32 s42, 460800
    s_mov_b32 s43, 0x20000
    s_cmp_eq_u32 s46, 7
    s_cselect_b32 s55, 0, s46
    s_mov_b32 s57, s55
    s_and_b32 s7, s62, 1
    s_mul_i32 s1, s7, 229376
    s_mul_i32 s63, s46, 286720
    s_mul_i32 s15, s7, 143360
    s_add_u32 s63, s63, s15
    s_mul_i32 s15, s14, 112
    s_add_u32 s63, s63, s15
    s_add_u32 s5, s14, s46
    s_lshl_b32 s14, s14, 4
    s_add_u32 s3, s3, s14
    s_mul_i32 s6, s7, 589824
    s_lshl_b32 s15, s5, 21
    s_add_u32 s6, s6, s15
    s_add_u32 s6, s6, 745472
    s_lshr_b32 s15, s62, 1
    s_mul_i32 s15, s15, 73728
    s_add_u32 s15, s15, s6
    s_add_u32 s44, s100, s15
    s_addc_u32 s45, s101, 0
    s_mov_b32 s46, 73728
    s_mov_b32 s47, 0x20000
    s_add_u32 s12, s100, s6
    s_addc_u32 s13, s101, 0
    s_mov_b32 s14, 589824
    s_mov_b32 s15, 0x20000
    s_lshl_b32 s6, s5, 21
    s_add_u32 s8, s100, s6
    s_addc_u32 s9, s101, 0
    s_mov_b32 s10, 20480
    s_mov_b32 s11, 0x20000
    s_mov_b32 s16, s96
    s_mov_b32 s17, s97
    s_mov_b32 s18, 2293760
    s_mov_b32 s19, 0x20000
    s_lshl_b32 s6, s5, 4
    s_add_u32 s20, s98, s6
    s_addc_u32 s21, s99, 0
    s_mov_b32 s22, 16
    s_mov_b32 s23, 0x20000
    s_and_b32 s3, s62, 14
    s_mul_i32 s3, s3, 45056
    s_add_u32 s3, s3, 24576
    s_add_u32 s96, s8, s3
    s_addc_u32 s97, s9, 0
    s_mov_b32 s98, 90112
    s_mov_b32 s99, 0x20000
    s_mul_i32 s6, s7, 45056
    s_sub_u32 s0, 45056, s6
    s_and_b32 s3, s48, 1
    s_mul_i32 s52, s3, 5120
    s_add_u32 s52, s52, s6
    s_mul_i32 s4, s3, 1280
    s_add_u32 s4, s4, s6
    s_add_u32 s4, s4, 40960
    s_lshl_b32 s3, s3, 7
    s_xor_b32 s6, s62, 1
    s_lshl_b32 s6, s6, 8
    s_add_u32 s3, s3, s6
    s_add_u32 s3, s3, 16384
    s_lshr_b32 s6, s48, 1
    s_cmp_eq_u32 s6, s7
    s_cselect_b32 s4, 0x40000000, s4
    s_cselect_b32 s3, 0x10000, s3
    v_lshrrev_b32 v231, 5, v0
    v_lshlrev_b32 v231, 16, v231
    v_lshl_add_u32 v231, v0, 2, v231
    v_add_u32 v19, s3, v231
    s_lshl_b32 s3, s7, 10
    s_lshr_b32 s6, s62, 1
    s_lshl_b32 s6, s6, 7
    s_add_u32 s3, s3, s6
    s_lshl_b32 s6, s48, 16
    s_add_u32 s3, s3, s6
    v_lshrrev_b32 v231, 3, v0
    v_lshl_add_u32 v255, v231, 11, s3
    v_and_b32 v231, 7, v0
    v_lshl_add_u32 v255, v231, 4, v255
    s_lshl_b32 s3, s62, 8
    s_add_u32 s3, s3, 16384
    v_and_b32 v231, 1, v0
    v_lshl_add_u32 v20, v231, 7, s3
    s_mul_i32 s6, s7, 21120
    s_mov_b32 s5, 0
    v_mov_b32 v23, 0xff800000
    v_mov_b32 v24, 0xff800000
    v_mov_b32 v25, 0xff800000
    v_mov_b32 v26, 0xff800000
    v_mov_b32 v27, 0xff800000
    v_lshrrev_b32 v230, 3, v0
    v_lshl_add_u32 v232, v229, 3, v230
    v_mul_u32_u24 v232, 7168, v232
    v_and_b32 v231, 7, v0
    v_lshl_add_u32 v232, v231, 4, v232
    v_add_u32 v4, 2048, v232
    v_and_b32 v234, 15, v0
    v_lshrrev_b32 v235, 4, v0
    v_and_b32 v236, 1, v229
    v_lshrrev_b32 v237, 1, v229
    v_lshlrev_b32 v18, 4, v0
    v_and_b32 v238, 3, v234
    v_lshlrev_b32 v238, 3, v238
    v_lshrrev_b32 v239, 2, v234
    v_lshrrev_b32 v230, 1, v239
    v_lshl_add_u32 v230, v235, 1, v230
    v_mul_u32_u24 v230, 2112, v230
    v_and_b32 v231, 1, v239
    v_mul_u32_u24 v231, 1032, v231
    v_add_u32 v230, v230, v231
    v_lshl_add_u32 v230, v236, 8, v230
    v_lshl_add_u32 v6, v238, 1, v230
    v_mul_u32_u24 v230, 80, v237
    v_add_u32 v230, v230, v234
    v_lshrrev_b32 v231, 1, v234
    v_xor_b32 v231, v231, v235
    v_lshlrev_b32 v231, 4, v231
    v_lshl_add_u32 v231, v230, 7, v231
    v_add_u32 v14, 101376, v231
    v_xor_b32 v15, 64, v14
    v_lshlrev_b32 v230, 5, v230
    v_add_u32 v22, 142336, v230
    v_lshl_add_u32 v231, v236, 2, v235
    v_lshl_add_u32 v21, v231, 2, v22
    v_and_b32 v230, 3, v234
    v_lshrrev_b32 v231, 3, v234
    v_lshl_add_u32 v230, v231, 2, v230
    v_lshl_add_u32 v230, v236, 4, v230
    v_mul_u32_u24 v230, 1056, v230
    v_and_b32 v231, 1, v239
    v_lshl_add_u32 v230, v231, 9, v230
    v_lshl_add_u32 v230, v235, 4, v230
    v_lshl_add_u32 v7, v236, 8, v230
    v_xor_b32 v231, 1, v236
    v_lshl_add_u32 v8, v231, 8, v230
    v_and_b32 v230, 1, v235
    v_lshl_add_u32 v230, v230, 2, v239
    v_mul_u32_u24 v230, 1056, v230
    v_add_u32 v230, v230, v238
    v_lshrrev_b32 v232, 1, v235
    v_lshl_add_u32 v233, v232, 9, v230
    v_lshl_add_u32 v9, v236, 8, v233
    v_lshl_add_u32 v233, v232, 7, v230
    v_lshl_add_u32 v10, v229, 5, v233
    v_add_u32 v5, 101376, v18
    v_mul_u32_u24 v230, 5120, v236
    v_add_u32 v11, v230, v5
    v_mul_u32_u24 v230, 10240, v237
    v_add_u32 v230, v230, v18
    v_add_u32 v16, 101376, v230
    v_mul_u32_u24 v230, 5120, v229
    v_add_u32 v230, v230, v18
    v_add_u32 v17, 101376, v230
    v_xor_b32 v230, 1, v229
    v_mul_u32_u24 v230, 5120, v230
    v_add_u32 v252, v230, v5
    v_mul_u32_u24 v230, 20, v237
    v_add_u32 v230, v230, v239
    v_mul_u32_u24 v230, 1056, v230
    v_add_u32 v230, v230, v238
    v_add_u32 v230, 1024, v230
    v_lshl_add_u32 v254, v236, 2, v230
    v_mul_u32_u24 v230, 1056, v239
    v_add3_u32 v230, v230, v238, s6
    v_add_u32 v253, 1024, v230
    v_lshlrev_b32 v250, 2, v229
    v_add_u32 v250, 162816, v250
    s_mul_i32 s61, s48, 5120
    s_mov_b32 s60, 0x3db8aa3b
    s_mov_b32 s7, 0x41c00000
    v_mov_b32 v230, 0x3f803f80
    v_accvgpr_write_b32 a240, v230
    v_accvgpr_write_b32 a241, v230
    v_accvgpr_write_b32 a242, v230
    v_accvgpr_write_b32 a243, v230
    v_lshlrev_b32 v230, 7, v0
    s_bfe_u32 s3, s2, 0x30003
    s_mul_i32 s3, s3, 28672
    s_add_u32 s3, s3, s1
    s_mul_i32 s6, s48, 7168
    s_add_u32 s3, s3, s6
    v_min_u32 v230, 7040, v230
    buffer_load_dword v251, v230, s[40:43], s3 offen offset:2048
L_restart:
    s_waitcnt vmcnt(1)
    s_barrier
    v_add_u32 v12, 0, v6
    ds_read_b128 a[100:103], v14 offset:0
    ds_read_b64_tr_b16 v[192:193], v12 offset:0
    ds_read_b64_tr_b16 v[194:195], v12 offset:512
    ds_read_b128 a[104:107], v14 offset:2048
    ds_read_b128 a[108:111], v14 offset:4096
    ds_read_b128 a[112:115], v14 offset:6144
    ds_read_b128 a[116:119], v14 offset:8192
    ds_read_b64_tr_b16 v[196:197], v12 offset:8
    ds_read_b64_tr_b16 v[198:199], v12 offset:520
    ds_read_b64_tr_b16 v[200:201], v12 offset:64
    ds_read_b64_tr_b16 v[202:203], v12 offset:576
    ds_read_b64_tr_b16 v[204:205], v12 offset:72
    ds_read_b64_tr_b16 v[206:207], v12 offset:584
    s_waitcnt lgkmcnt(4)
    v_mfma_f32_16x16x32_bf16 v[32:35], v[192:195], a[100:103], 0
    ds_read_b64_tr_b16 v[208:209], v12 offset:128
    v_mfma_f32_16x16x32_bf16 v[40:43], v[192:195], a[104:107], 0
    ds_read_b64_tr_b16 v[210:211], v12 offset:640
    v_mfma_f32_16x16x32_bf16 v[48:51], v[192:195], a[108:111], 0
    ds_read_b64_tr_b16 v[212:213], v12 offset:136
    v_mfma_f32_16x16x32_bf16 v[56:59], v[192:195], a[112:115], 0
    ds_read_b64_tr_b16 v[214:215], v12 offset:648
    v_mfma_f32_16x16x32_bf16 v[64:67], v[192:195], a[116:119], 0
    ds_read_b64_tr_b16 v[216:217], v12 offset:192
    v_mfma_f32_16x16x32_bf16 v[36:39], v[196:199], a[100:103], 0
    ds_read_b64_tr_b16 v[218:219], v12 offset:704
    v_mfma_f32_16x16x32_bf16 v[44:47], v[196:199], a[104:107], 0
    ds_read_b64_tr_b16 v[220:221], v12 offset:200
    v_mfma_f32_16x16x32_bf16 v[52:55], v[196:199], a[108:111], 0
    ds_read_b64_tr_b16 v[222:223], v12 offset:712
    v_mfma_f32_16x16x32_bf16 v[60:63], v[196:199], a[112:115], 0
    ds_read_b128 a[120:123], v15 offset:0
    v_mfma_f32_16x16x32_bf16 v[68:71], v[196:199], a[116:119], 0
    s_waitcnt lgkmcnt(9)
    ds_read_b128 a[124:127], v15 offset:2048
    v_mfma_f32_16x16x32_bf16 v[72:75], v[200:203], a[100:103], 0
    ds_read_b128 a[128:131], v15 offset:4096
    v_mfma_f32_16x16x32_bf16 v[80:83], v[200:203], a[104:107], 0
    ds_read_b128 a[132:135], v15 offset:6144
    v_mfma_f32_16x16x32_bf16 v[88:91], v[200:203], a[108:111], 0
    ds_read_b128 a[136:139], v15 offset:8192
    v_mfma_f32_16x16x32_bf16 v[96:99], v[200:203], a[112:115], 0
    ds_read_b64_tr_b16 v[192:193], v12 offset:16896
    v_mfma_f32_16x16x32_bf16 v[104:107], v[200:203], a[116:119], 0
    ds_read_b64_tr_b16 v[194:195], v12 offset:17408
    v_mfma_f32_16x16x32_bf16 v[76:79], v[204:207], a[100:103], 0
    s_bitcmp1_b32 s56, 0
    s_cselect_b32 s54, 0, 1
    s_lshl_b32 s53, s54, 19
    v_mfma_f32_16x16x32_bf16 v[84:87], v[204:207], a[104:107], 0
    s_lshl_b32 s54, s54, 7
    s_add_u32 m0, s50, 121856
    v_mfma_f32_16x16x32_bf16 v[92:95], v[204:207], a[108:111], 0
    buffer_load_dwordx4 v224, s[24:27], s54 offen offset:0  lds
    v_mfma_f32_16x16x32_bf16 v[100:103], v[204:207], a[112:115], 0
    buffer_load_dwordx4 v225, s[24:27], s54 offen offset:1024  lds
    v_mfma_f32_16x16x32_bf16 v[108:111], v[204:207], a[116:119], 0
    s_waitcnt lgkmcnt(11)
    ds_read_b64_tr_b16 v[196:197], v12 offset:16904
    v_mfma_f32_16x16x32_bf16 v[112:115], v[208:211], a[100:103], 0
    ds_read_b64_tr_b16 v[198:199], v12 offset:17416
    v_mfma_f32_16x16x32_bf16 v[120:123], v[208:211], a[104:107], 0
    buffer_load_dwordx4 v226, s[24:27], s54 offen offset:2048  lds
    v_mfma_f32_16x16x32_bf16 v[128:131], v[208:211], a[108:111], 0
    ds_read_b64_tr_b16 v[200:201], v12 offset:16960
    v_mfma_f32_16x16x32_bf16 v[136:139], v[208:211], a[112:115], 0
    ds_read_b64_tr_b16 v[202:203], v12 offset:17472
    v_mfma_f32_16x16x32_bf16 v[144:147], v[208:211], a[116:119], 0
    buffer_load_dwordx4 v227, s[24:27], s54 offen offset:3072  lds
    v_mfma_f32_16x16x32_bf16 v[116:119], v[212:215], a[100:103], 0
    ds_read_b64_tr_b16 v[204:205], v12 offset:16968
    v_mfma_f32_16x16x32_bf16 v[124:127], v[212:215], a[104:107], 0
    ds_read_b64_tr_b16 v[206:207], v12 offset:17480
    v_mfma_f32_16x16x32_bf16 v[132:135], v[212:215], a[108:111], 0
    s_add_u32 m0, s50, 125952
    ds_read_b64_tr_b16 v[208:209], v12 offset:17024
    v_mfma_f32_16x16x32_bf16 v[140:143], v[212:215], a[112:115], 0
    buffer_load_dwordx4 v228, s[24:27], s54 offen  lds
    v_mfma_f32_16x16x32_bf16 v[148:151], v[212:215], a[116:119], 0
    s_waitcnt lgkmcnt(14)
    ds_read_b64_tr_b16 v[210:211], v12 offset:17536
    v_mfma_f32_16x16x32_bf16 v[152:155], v[216:219], a[100:103], 0
    s_add_u32 m0, s49, 33792
    ds_read_b64_tr_b16 v[212:213], v12 offset:17032
    v_mfma_f32_16x16x32_bf16 v[160:163], v[216:219], a[104:107], 0
    buffer_load_dwordx4 v28, s[28:31], s53 offen offset:0  lds
    v_mfma_f32_16x16x32_bf16 v[168:171], v[216:219], a[108:111], 0
    ds_read_b64_tr_b16 v[214:215], v12 offset:17544
    v_mfma_f32_16x16x32_bf16 v[176:179], v[216:219], a[112:115], 0
    buffer_load_dwordx4 v29, s[28:31], s53 offen offset:1032  lds
    v_mfma_f32_16x16x32_bf16 v[184:187], v[216:219], a[116:119], 0
    v_mfma_f32_16x16x32_bf16 v[156:159], v[220:223], a[100:103], 0
    ds_read_b64_tr_b16 v[216:217], v12 offset:17088
    v_mfma_f32_16x16x32_bf16 v[164:167], v[220:223], a[104:107], 0
    buffer_load_dwordx4 v30, s[28:31], s53 offen offset:2112  lds
    v_mfma_f32_16x16x32_bf16 v[172:175], v[220:223], a[108:111], 0
    ds_read_b64_tr_b16 v[218:219], v12 offset:17600
    v_mfma_f32_16x16x32_bf16 v[180:183], v[220:223], a[112:115], 0
    v_mfma_f32_16x16x32_bf16 v[188:191], v[220:223], a[116:119], 0
    s_waitcnt lgkmcnt(10)
    v_mfma_f32_16x16x32_bf16 v[32:35], v[192:195], a[120:123], v[32:35]
    buffer_load_dwordx4 v31, s[28:31], s53 offen offset:3144  lds
    v_mfma_f32_16x16x32_bf16 v[40:43], v[192:195], a[124:127], v[40:43]
    ds_read_b64_tr_b16 v[220:221], v12 offset:17096
    v_mfma_f32_16x16x32_bf16 v[48:51], v[192:195], a[128:131], v[48:51]
    s_add_u32 s51, s53, 65536
    s_add_u32 m0, s49, 38016
    v_mfma_f32_16x16x32_bf16 v[56:59], v[192:195], a[132:135], v[56:59]
    buffer_load_dwordx4 v28, s[28:31], s51 offen offset:0  lds
    v_mfma_f32_16x16x32_bf16 v[64:67], v[192:195], a[136:139], v[64:67]
    ds_read_b64_tr_b16 v[222:223], v12 offset:17608
    v_mfma_f32_16x16x32_bf16 v[36:39], v[196:199], a[120:123], v[36:39]
    buffer_load_dwordx4 v29, s[28:31], s51 offen offset:1032  lds
    v_mfma_f32_16x16x32_bf16 v[44:47], v[196:199], a[124:127], v[44:47]
    v_mfma_f32_16x16x32_bf16 v[52:55], v[196:199], a[128:131], v[52:55]
    v_mfma_f32_16x16x32_bf16 v[60:63], v[196:199], a[132:135], v[60:63]
    buffer_load_dwordx4 v30, s[28:31], s51 offen offset:2112  lds
    v_mfma_f32_16x16x32_bf16 v[68:71], v[196:199], a[136:139], v[68:71]
    s_waitcnt lgkmcnt(8)
    v_mfma_f32_16x16x32_bf16 v[72:75], v[200:203], a[120:123], v[72:75]
    v_mfma_f32_16x16x32_bf16 v[80:83], v[200:203], a[124:127], v[80:83]
    buffer_load_dwordx4 v31, s[28:31], s51 offen offset:3144  lds
    v_mfma_f32_16x16x32_bf16 v[88:91], v[200:203], a[128:131], v[88:91]
    v_mfma_f32_16x16x32_bf16 v[96:99], v[200:203], a[132:135], v[96:99]
    v_mfma_f32_16x16x32_bf16 v[104:107], v[200:203], a[136:139], v[104:107]
    s_bitcmp1_b32 s56, 0
    s_cselect_b32 s54, 3, 2
    s_lshl_b32 s53, s54, 19
    v_mfma_f32_16x16x32_bf16 v[76:79], v[204:207], a[120:123], v[76:79]
    s_lshl_b32 s54, s54, 7
    s_add_u32 m0, s50, 142336
    v_mfma_f32_16x16x32_bf16 v[84:87], v[204:207], a[124:127], v[84:87]
    buffer_load_dwordx4 v224, s[24:27], s54 offen offset:0  lds
    v_mfma_f32_16x16x32_bf16 v[92:95], v[204:207], a[128:131], v[92:95]
    v_mfma_f32_16x16x32_bf16 v[100:103], v[204:207], a[132:135], v[100:103]
    buffer_load_dwordx4 v225, s[24:27], s54 offen offset:1024  lds
    v_mfma_f32_16x16x32_bf16 v[108:111], v[204:207], a[136:139], v[108:111]
    s_waitcnt vmcnt(2) lgkmcnt(0)
    s_barrier
    v_mfma_f32_16x16x32_bf16 v[112:115], v[208:211], a[120:123], v[112:115]
    ds_read_b128 a[100:103], v14 offset:20480
    v_add_u32 v12, 33792, v6
    v_mfma_f32_16x16x32_bf16 v[120:123], v[208:211], a[124:127], v[120:123]
    ds_read_b64_tr_b16 v[192:193], v12 offset:0
    v_mfma_f32_16x16x32_bf16 v[128:131], v[208:211], a[128:131], v[128:131]
    ds_read_b64_tr_b16 v[194:195], v12 offset:512
    v_mfma_f32_16x16x32_bf16 v[136:139], v[208:211], a[132:135], v[136:139]
    ds_read_b64_tr_b16 v[196:197], v12 offset:8
    v_mfma_f32_16x16x32_bf16 v[144:147], v[208:211], a[136:139], v[144:147]
    ds_read_b64_tr_b16 v[198:199], v12 offset:520
    v_mfma_f32_16x16x32_bf16 v[116:119], v[212:215], a[120:123], v[116:119]
    buffer_load_dwordx4 v226, s[24:27], s54 offen offset:2048  lds
    v_mfma_f32_16x16x32_bf16 v[124:127], v[212:215], a[124:127], v[124:127]
    ds_read_b128 a[104:107], v14 offset:22528
    v_mfma_f32_16x16x32_bf16 v[132:135], v[212:215], a[128:131], v[132:135]
    ds_read_b128 a[108:111], v14 offset:24576
    v_mfma_f32_16x16x32_bf16 v[140:143], v[212:215], a[132:135], v[140:143]
    ds_read_b128 a[112:115], v14 offset:26624
    v_mfma_f32_16x16x32_bf16 v[148:151], v[212:215], a[136:139], v[148:151]
    ds_read_b128 a[116:119], v14 offset:28672
    v_mfma_f32_16x16x32_bf16 v[152:155], v[216:219], a[120:123], v[152:155]
    buffer_load_dwordx4 v227, s[24:27], s54 offen offset:3072  lds
    v_mfma_f32_16x16x32_bf16 v[160:163], v[216:219], a[124:127], v[160:163]
    s_add_u32 m0, s50, 146432
    ds_read_b64_tr_b16 v[200:201], v12 offset:64
    v_mfma_f32_16x16x32_bf16 v[168:171], v[216:219], a[128:131], v[168:171]
    buffer_load_dwordx4 v228, s[24:27], s54 offen  lds
    v_mfma_f32_16x16x32_bf16 v[176:179], v[216:219], a[132:135], v[176:179]
    ds_read_b64_tr_b16 v[202:203], v12 offset:576
    s_add_u32 m0, s49, 67584
    v_mfma_f32_16x16x32_bf16 v[184:187], v[216:219], a[136:139], v[184:187]
    ds_read_b64_tr_b16 v[204:205], v12 offset:72
    v_mfma_f32_16x16x32_bf16 v[156:159], v[220:223], a[120:123], v[156:159]
    ds_read_b64_tr_b16 v[206:207], v12 offset:584
    v_mfma_f32_16x16x32_bf16 v[164:167], v[220:223], a[124:127], v[164:167]
    buffer_load_dwordx4 v28, s[28:31], s53 offen offset:0  lds
    v_mfma_f32_16x16x32_bf16 v[172:175], v[220:223], a[128:131], v[172:175]
    ds_read_b64_tr_b16 v[208:209], v12 offset:128
    v_mfma_f32_16x16x32_bf16 v[180:183], v[220:223], a[132:135], v[180:183]
    buffer_load_dwordx4 v29, s[28:31], s53 offen offset:1032  lds
    v_mfma_f32_16x16x32_bf16 v[188:191], v[220:223], a[136:139], v[188:191]
    s_waitcnt lgkmcnt(5)
    ds_read_b64_tr_b16 v[210:211], v12 offset:640
    v_mfma_f32_16x16x32_bf16 v[32:35], v[192:195], a[100:103], v[32:35]
    ds_read_b64_tr_b16 v[212:213], v12 offset:136
    v_mfma_f32_16x16x32_bf16 v[40:43], v[192:195], a[104:107], v[40:43]
    ds_read_b64_tr_b16 v[214:215], v12 offset:648
    v_mfma_f32_16x16x32_bf16 v[48:51], v[192:195], a[108:111], v[48:51]
    buffer_load_dwordx4 v30, s[28:31], s53 offen offset:2112  lds
    v_mfma_f32_16x16x32_bf16 v[56:59], v[192:195], a[112:115], v[56:59]
    ds_read_b64_tr_b16 v[216:217], v12 offset:192
    v_mfma_f32_16x16x32_bf16 v[64:67], v[192:195], a[116:119], v[64:67]
    ds_read_b64_tr_b16 v[218:219], v12 offset:704
    v_mfma_f32_16x16x32_bf16 v[36:39], v[196:199], a[100:103], v[36:39]
    ds_read_b64_tr_b16 v[220:221], v12 offset:200
    v_mfma_f32_16x16x32_bf16 v[44:47], v[196:199], a[104:107], v[44:47]
    buffer_load_dwordx4 v31, s[28:31], s53 offen offset:3144  lds
    v_mfma_f32_16x16x32_bf16 v[52:55], v[196:199], a[108:111], v[52:55]
    ds_read_b64_tr_b16 v[222:223], v12 offset:712
    v_mfma_f32_16x16x32_bf16 v[60:63], v[196:199], a[112:115], v[60:63]
    s_add_u32 s51, s53, 65536
    s_add_u32 m0, s49, 71808
    v_mfma_f32_16x16x32_bf16 v[68:71], v[196:199], a[116:119], v[68:71]
    s_waitcnt lgkmcnt(8)
    ds_read_b128 a[120:123], v15 offset:20480
    v_mfma_f32_16x16x32_bf16 v[72:75], v[200:203], a[100:103], v[72:75]
    buffer_load_dwordx4 v28, s[28:31], s51 offen offset:0  lds
    v_mfma_f32_16x16x32_bf16 v[80:83], v[200:203], a[104:107], v[80:83]
    ds_read_b128 a[124:127], v15 offset:22528
    v_mfma_f32_16x16x32_bf16 v[88:91], v[200:203], a[108:111], v[88:91]
    ds_read_b128 a[128:131], v15 offset:24576
    v_mfma_f32_16x16x32_bf16 v[96:99], v[200:203], a[112:115], v[96:99]
    ds_read_b128 a[132:135], v15 offset:26624
    v_mfma_f32_16x16x32_bf16 v[104:107], v[200:203], a[116:119], v[104:107]
    buffer_load_dwordx4 v29, s[28:31], s51 offen offset:1032  lds
    v_mfma_f32_16x16x32_bf16 v[76:79], v[204:207], a[100:103], v[76:79]
    ds_read_b128 a[136:139], v15 offset:28672
    v_mfma_f32_16x16x32_bf16 v[84:87], v[204:207], a[104:107], v[84:87]
    ds_read_b64_tr_b16 v[192:193], v12 offset:16896
    v_mfma_f32_16x16x32_bf16 v[92:95], v[204:207], a[108:111], v[92:95]
    ds_read_b64_tr_b16 v[194:195], v12 offset:17408
    v_mfma_f32_16x16x32_bf16 v[100:103], v[204:207], a[112:115], v[100:103]
    buffer_load_dwordx4 v30, s[28:31], s51 offen offset:2112  lds
    v_mfma_f32_16x16x32_bf16 v[108:111], v[204:207], a[116:119], v[108:111]
    s_waitcnt lgkmcnt(11)
    ds_read_b64_tr_b16 v[196:197], v12 offset:16904
    v_mfma_f32_16x16x32_bf16 v[112:115], v[208:211], a[100:103], v[112:115]
    ds_read_b64_tr_b16 v[198:199], v12 offset:17416
    v_mfma_f32_16x16x32_bf16 v[120:123], v[208:211], a[104:107], v[120:123]
    ds_read_b64_tr_b16 v[200:201], v12 offset:16960
    v_mfma_f32_16x16x32_bf16 v[128:131], v[208:211], a[108:111], v[128:131]
    buffer_load_dwordx4 v31, s[28:31], s51 offen offset:3144  lds
    v_mfma_f32_16x16x32_bf16 v[136:139], v[208:211], a[112:115], v[136:139]
    s_mov_b32 s6, 0
    ds_read_b64_tr_b16 v[202:203], v12 offset:17472
    v_mfma_f32_16x16x32_bf16 v[144:147], v[208:211], a[116:119], v[144:147]
    buffer_load_dwordx4 a[80:83], v3, s[36:39], s6 offen offset:3584 nt
    v_mfma_f32_16x16x32_bf16 v[116:119], v[212:215], a[100:103], v[116:119]
    s_mov_b32 s6, 32768
    ds_read_b64_tr_b16 v[204:205], v12 offset:16968
    v_mfma_f32_16x16x32_bf16 v[124:127], v[212:215], a[104:107], v[124:127]
    buffer_load_dwordx4 a[84:87], v3, s[36:39], s6 offen offset:3584 nt
    v_mfma_f32_16x16x32_bf16 v[132:135], v[212:215], a[108:111], v[132:135]
    s_mov_b32 s6, 65536
    ds_read_b64_tr_b16 v[206:207], v12 offset:17480
    v_mfma_f32_16x16x32_bf16 v[140:143], v[212:215], a[112:115], v[140:143]
    buffer_load_dwordx4 a[88:91], v3, s[36:39], s6 offen offset:3584 nt
    v_mfma_f32_16x16x32_bf16 v[148:151], v[212:215], a[116:119], v[148:151]
    s_waitcnt lgkmcnt(13)
    s_mov_b32 s6, 98304
    v_mfma_f32_16x16x32_bf16 v[152:155], v[216:219], a[100:103], v[152:155]
    buffer_load_dwordx4 a[92:95], v3, s[36:39], s6 offen offset:3584 nt
    v_mfma_f32_16x16x32_bf16 v[160:163], v[216:219], a[104:107], v[160:163]
    ds_read_b64_tr_b16 v[208:209], v12 offset:17024
    v_mfma_f32_16x16x32_bf16 v[168:171], v[216:219], a[108:111], v[168:171]
    s_bitcmp1_b32 s56, 0
    s_cselect_b32 s54, 2, 3
    s_lshl_b32 s53, s54, 19
    v_mfma_f32_16x16x32_bf16 v[176:179], v[216:219], a[112:115], v[176:179]
    s_lshl_b32 s54, s54, 7
    s_add_u32 m0, s50, 101376
    v_mfma_f32_16x16x32_bf16 v[184:187], v[216:219], a[116:119], v[184:187]
    buffer_load_dwordx4 v224, s[24:27], s54 offen offset:0  lds
    v_mfma_f32_16x16x32_bf16 v[156:159], v[220:223], a[100:103], v[156:159]
    ds_read_b64_tr_b16 v[210:211], v12 offset:17536
    v_mfma_f32_16x16x32_bf16 v[164:167], v[220:223], a[104:107], v[164:167]
    ds_read_b64_tr_b16 v[212:213], v12 offset:17032
    v_mfma_f32_16x16x32_bf16 v[172:175], v[220:223], a[108:111], v[172:175]
    buffer_load_dwordx4 v225, s[24:27], s54 offen offset:1024  lds
    v_mfma_f32_16x16x32_bf16 v[180:183], v[220:223], a[112:115], v[180:183]
    ds_read_b64_tr_b16 v[214:215], v12 offset:17544
    v_mfma_f32_16x16x32_bf16 v[188:191], v[220:223], a[116:119], v[188:191]
    s_waitcnt lgkmcnt(8)
    ds_read_b64_tr_b16 v[216:217], v12 offset:17088
    v_mfma_f32_16x16x32_bf16 v[32:35], v[192:195], a[120:123], v[32:35]
    ds_read_b64_tr_b16 v[218:219], v12 offset:17600
    v_mfma_f32_16x16x32_bf16 v[40:43], v[192:195], a[124:127], v[40:43]
    ds_read_b64_tr_b16 v[220:221], v12 offset:17096
    v_mfma_f32_16x16x32_bf16 v[48:51], v[192:195], a[128:131], v[48:51]
    buffer_load_dwordx4 v226, s[24:27], s54 offen offset:2048  lds
    v_mfma_f32_16x16x32_bf16 v[56:59], v[192:195], a[132:135], v[56:59]
    ds_read_b64_tr_b16 v[222:223], v12 offset:17608
    v_mfma_f32_16x16x32_bf16 v[64:67], v[192:195], a[136:139], v[64:67]
    v_mfma_f32_16x16x32_bf16 v[36:39], v[196:199], a[120:123], v[36:39]
    v_mfma_f32_16x16x32_bf16 v[44:47], v[196:199], a[124:127], v[44:47]
    v_mfma_f32_16x16x32_bf16 v[52:55], v[196:199], a[128:131], v[52:55]
    buffer_load_dwordx4 v227, s[24:27], s54 offen offset:3072  lds
    v_mfma_f32_16x16x32_bf16 v[60:63], v[196:199], a[132:135], v[60:63]
    v_mfma_f32_16x16x32_bf16 v[68:71], v[196:199], a[136:139], v[68:71]
    s_waitcnt lgkmcnt(8)
    v_mfma_f32_16x16x32_bf16 v[72:75], v[200:203], a[120:123], v[72:75]
    s_add_u32 m0, s50, 105472
    v_mfma_f32_16x16x32_bf16 v[80:83], v[200:203], a[124:127], v[80:83]
    v_mfma_f32_16x16x32_bf16 v[88:91], v[200:203], a[128:131], v[88:91]
    buffer_load_dwordx4 v228, s[24:27], s54 offen  lds
    v_mfma_f32_16x16x32_bf16 v[96:99], v[200:203], a[132:135], v[96:99]
    v_mfma_f32_16x16x32_bf16 v[104:107], v[200:203], a[136:139], v[104:107]
    v_mfma_f32_16x16x32_bf16 v[76:79], v[204:207], a[120:123], v[76:79]
    s_add_u32 m0, s49, 0
    v_mfma_f32_16x16x32_bf16 v[84:87], v[204:207], a[124:127], v[84:87]
    v_mfma_f32_16x16x32_bf16 v[92:95], v[204:207], a[128:131], v[92:95]
    buffer_load_dwordx4 v28, s[28:31], s53 offen offset:0  lds
    v_mfma_f32_16x16x32_bf16 v[100:103], v[204:207], a[132:135], v[100:103]
    v_mfma_f32_16x16x32_bf16 v[108:111], v[204:207], a[136:139], v[108:111]
    s_waitcnt vmcnt(10) lgkmcnt(0)
    s_barrier
    v_mfma_f32_16x16x32_bf16 v[112:115], v[208:211], a[120:123], v[112:115]
    ds_read_b128 a[100:103], v14 offset:40960
    v_add_u32 v12, 67584, v6
    v_mfma_f32_16x16x32_bf16 v[120:123], v[208:211], a[124:127], v[120:123]
    ds_read_b64_tr_b16 v[192:193], v12 offset:0
    v_mfma_f32_16x16x32_bf16 v[128:131], v[208:211], a[128:131], v[128:131]
    ds_read_b64_tr_b16 v[194:195], v12 offset:512
    v_mfma_f32_16x16x32_bf16 v[136:139], v[208:211], a[132:135], v[136:139]
    ds_read_b64_tr_b16 v[196:197], v12 offset:8
    v_mfma_f32_16x16x32_bf16 v[144:147], v[208:211], a[136:139], v[144:147]
    ds_read_b64_tr_b16 v[198:199], v12 offset:520
    v_mfma_f32_16x16x32_bf16 v[116:119], v[212:215], a[120:123], v[116:119]
    buffer_load_dwordx4 v29, s[28:31], s53 offen offset:1032  lds
    v_mfma_f32_16x16x32_bf16 v[124:127], v[212:215], a[124:127], v[124:127]
    ds_read_b128 a[104:107], v14 offset:43008
    v_mfma_f32_16x16x32_bf16 v[132:135], v[212:215], a[128:131], v[132:135]
    ds_read_b128 a[108:111], v14 offset:45056
    v_mfma_f32_16x16x32_bf16 v[140:143], v[212:215], a[132:135], v[140:143]
    ds_read_b128 a[112:115], v14 offset:47104
    v_mfma_f32_16x16x32_bf16 v[148:151], v[212:215], a[136:139], v[148:151]
    ds_read_b128 a[116:119], v14 offset:49152
    v_mfma_f32_16x16x32_bf16 v[152:155], v[216:219], a[120:123], v[152:155]
    buffer_load_dwordx4 v30, s[28:31], s53 offen offset:2112  lds
    v_mfma_f32_16x16x32_bf16 v[160:163], v[216:219], a[124:127], v[160:163]
    ds_read_b64_tr_b16 v[200:201], v12 offset:64
    v_mfma_f32_16x16x32_bf16 v[168:171], v[216:219], a[128:131], v[168:171]
    ds_read_b64_tr_b16 v[202:203], v12 offset:576
    v_mfma_f32_16x16x32_bf16 v[176:179], v[216:219], a[132:135], v[176:179]
    ds_read_b64_tr_b16 v[204:205], v12 offset:72
    v_mfma_f32_16x16x32_bf16 v[184:187], v[216:219], a[136:139], v[184:187]
    ds_read_b64_tr_b16 v[206:207], v12 offset:584
    v_mfma_f32_16x16x32_bf16 v[156:159], v[220:223], a[120:123], v[156:159]
    buffer_load_dwordx4 v31, s[28:31], s53 offen offset:3144  lds
    v_mfma_f32_16x16x32_bf16 v[164:167], v[220:223], a[124:127], v[164:167]
    s_add_u32 s51, s53, 65536
    s_add_u32 m0, s49, 4224
    v_mfma_f32_16x16x32_bf16 v[172:175], v[220:223], a[128:131], v[172:175]
    buffer_load_dwordx4 v28, s[28:31], s51 offen offset:0  lds
    v_mfma_f32_16x16x32_bf16 v[180:183], v[220:223], a[132:135], v[180:183]
    ds_read_b64_tr_b16 v[208:209], v12 offset:128
    v_mfma_f32_16x16x32_bf16 v[188:191], v[220:223], a[136:139], v[188:191]
    s_waitcnt lgkmcnt(5)
    ds_read_b64_tr_b16 v[210:211], v12 offset:640
    v_mfma_f32_16x16x32_bf16 v[32:35], v[192:195], a[100:103], v[32:35]
    ds_read_b64_tr_b16 v[212:213], v12 offset:136
    v_mfma_f32_16x16x32_bf16 v[40:43], v[192:195], a[104:107], v[40:43]
    ds_read_b64_tr_b16 v[214:215], v12 offset:648
    v_mfma_f32_16x16x32_bf16 v[48:51], v[192:195], a[108:111], v[48:51]
    buffer_load_dwordx4 v29, s[28:31], s51 offen offset:1032  lds
    v_mfma_f32_16x16x32_bf16 v[56:59], v[192:195], a[112:115], v[56:59]
    ds_read_b64_tr_b16 v[216:217], v12 offset:192
    v_mfma_f32_16x16x32_bf16 v[64:67], v[192:195], a[116:119], v[64:67]
    ds_read_b64_tr_b16 v[218:219], v12 offset:704
    v_mfma_f32_16x16x32_bf16 v[36:39], v[196:199], a[100:103], v[36:39]
    ds_read_b64_tr_b16 v[220:221], v12 offset:200
    v_mfma_f32_16x16x32_bf16 v[44:47], v[196:199], a[104:107], v[44:47]
    ds_read_b64_tr_b16 v[222:223], v12 offset:712
    v_mfma_f32_16x16x32_bf16 v[52:55], v[196:199], a[108:111], v[52:55]
    buffer_load_dwordx4 v30, s[28:31], s51 offen offset:2112  lds
    v_mfma_f32_16x16x32_bf16 v[60:63], v[196:199], a[112:115], v[60:63]
    ds_read_b128 a[120:123], v15 offset:40960
    v_mfma_f32_16x16x32_bf16 v[68:71], v[196:199], a[116:119], v[68:71]
    s_waitcnt lgkmcnt(9)
    ds_read_b128 a[124:127], v15 offset:43008
    v_mfma_f32_16x16x32_bf16 v[72:75], v[200:203], a[100:103], v[72:75]
    ds_read_b128 a[128:131], v15 offset:45056
    v_mfma_f32_16x16x32_bf16 v[80:83], v[200:203], a[104:107], v[80:83]
    ds_read_b128 a[132:135], v15 offset:47104
    v_mfma_f32_16x16x32_bf16 v[88:91], v[200:203], a[108:111], v[88:91]
    buffer_load_dwordx4 v31, s[28:31], s51 offen offset:3144  lds
    v_mfma_f32_16x16x32_bf16 v[96:99], v[200:203], a[112:115], v[96:99]
    ds_read_b128 a[136:139], v15 offset:49152
    v_mfma_f32_16x16x32_bf16 v[104:107], v[200:203], a[116:119], v[104:107]
    s_bitcmp1_b32 s56, 0
    s_cselect_b32 s54, 5, 4
    s_lshl_b32 s53, s54, 19
    v_mfma_f32_16x16x32_bf16 v[76:79], v[204:207], a[100:103], v[76:79]
    s_lshl_b32 s54, s54, 7
    s_add_u32 m0, s50, 121856
    v_mfma_f32_16x16x32_bf16 v[84:87], v[204:207], a[104:107], v[84:87]
    buffer_load_dwordx4 v224, s[24:27], s54 offen offset:0  lds
    v_mfma_f32_16x16x32_bf16 v[92:95], v[204:207], a[108:111], v[92:95]
    ds_read_b64_tr_b16 v[192:193], v12 offset:16896
    v_mfma_f32_16x16x32_bf16 v[100:103], v[204:207], a[112:115], v[100:103]
    ds_read_b64_tr_b16 v[194:195], v12 offset:17408
    v_mfma_f32_16x16x32_bf16 v[108:111], v[204:207], a[116:119], v[108:111]
    s_waitcnt lgkmcnt(11)
    ds_read_b64_tr_b16 v[196:197], v12 offset:16904
    v_mfma_f32_16x16x32_bf16 v[112:115], v[208:211], a[100:103], v[112:115]
    buffer_load_dwordx4 v225, s[24:27], s54 offen offset:1024  lds
    v_mfma_f32_16x16x32_bf16 v[120:123], v[208:211], a[104:107], v[120:123]
    ds_read_b64_tr_b16 v[198:199], v12 offset:17416
    v_mfma_f32_16x16x32_bf16 v[128:131], v[208:211], a[108:111], v[128:131]
    ds_read_b64_tr_b16 v[200:201], v12 offset:16960
    v_mfma_f32_16x16x32_bf16 v[136:139], v[208:211], a[112:115], v[136:139]
    ds_read_b64_tr_b16 v[202:203], v12 offset:17472
    v_mfma_f32_16x16x32_bf16 v[144:147], v[208:211], a[116:119], v[144:147]
    buffer_load_dwordx4 v226, s[24:27], s54 offen offset:2048  lds
    v_mfma_f32_16x16x32_bf16 v[116:119], v[212:215], a[100:103], v[116:119]
    ds_read_b64_tr_b16 v[204:205], v12 offset:16968
    v_mfma_f32_16x16x32_bf16 v[124:127], v[212:215], a[104:107], v[124:127]
    ds_read_b64_tr_b16 v[206:207], v12 offset:17480
    v_mfma_f32_16x16x32_bf16 v[132:135], v[212:215], a[108:111], v[132:135]
    ds_read_b64_tr_b16 v[208:209], v12 offset:17024
    v_mfma_f32_16x16x32_bf16 v[140:143], v[212:215], a[112:115], v[140:143]
    ds_read_b64_tr_b16 v[210:211], v12 offset:17536
    v_mfma_f32_16x16x32_bf16 v[148:151], v[212:215], a[116:119], v[148:151]
    s_waitcnt lgkmcnt(15)
    v_mfma_f32_16x16x32_bf16 v[152:155], v[216:219], a[100:103], v[152:155]
    buffer_load_dwordx4 v227, s[24:27], s54 offen offset:3072  lds
    v_mfma_f32_16x16x32_bf16 v[160:163], v[216:219], a[104:107], v[160:163]
    ds_read_b64_tr_b16 v[212:213], v12 offset:17032
    v_mfma_f32_16x16x32_bf16 v[168:171], v[216:219], a[108:111], v[168:171]
    s_add_u32 m0, s50, 125952
    ds_read_b64_tr_b16 v[214:215], v12 offset:17544
    v_mfma_f32_16x16x32_bf16 v[176:179], v[216:219], a[112:115], v[176:179]
    v_mfma_f32_16x16x32_bf16 v[184:187], v[216:219], a[116:119], v[184:187]
    buffer_load_dwordx4 v228, s[24:27], s54 offen  lds
    v_mfma_f32_16x16x32_bf16 v[156:159], v[220:223], a[100:103], v[156:159]
    ds_read_b64_tr_b16 v[216:217], v12 offset:17088
    v_mfma_f32_16x16x32_bf16 v[164:167], v[220:223], a[104:107], v[164:167]
    ds_read_b64_tr_b16 v[218:219], v12 offset:17600
    v_mfma_f32_16x16x32_bf16 v[172:175], v[220:223], a[108:111], v[172:175]
    s_add_u32 m0, s49, 33792
    v_mfma_f32_16x16x32_bf16 v[180:183], v[220:223], a[112:115], v[180:183]
    v_mfma_f32_16x16x32_bf16 v[188:191], v[220:223], a[116:119], v[188:191]
    s_waitcnt lgkmcnt(10)
    v_mfma_f32_16x16x32_bf16 v[32:35], v[192:195], a[120:123], v[32:35]
    buffer_load_dwordx4 v28, s[28:31], s53 offen offset:0  lds
    v_mfma_f32_16x16x32_bf16 v[40:43], v[192:195], a[124:127], v[40:43]
    ds_read_b64_tr_b16 v[220:221], v12 offset:17096
    v_mfma_f32_16x16x32_bf16 v[48:51], v[192:195], a[128:131], v[48:51]
    ds_read_b64_tr_b16 v[222:223], v12 offset:17608
    v_mfma_f32_16x16x32_bf16 v[56:59], v[192:195], a[132:135], v[56:59]
    v_mfma_f32_16x16x32_bf16 v[64:67], v[192:195], a[136:139], v[64:67]
    buffer_load_dwordx4 v29, s[28:31], s53 offen offset:1032  lds
    v_mfma_f32_16x16x32_bf16 v[36:39], v[196:199], a[120:123], v[36:39]
    v_mfma_f32_16x16x32_bf16 v[44:47], v[196:199], a[124:127], v[44:47]
    v_mfma_f32_16x16x32_bf16 v[52:55], v[196:199], a[128:131], v[52:55]
    v_mfma_f32_16x16x32_bf16 v[60:63], v[196:199], a[132:135], v[60:63]
    v_mfma_f32_16x16x32_bf16 v[68:71], v[196:199], a[136:139], v[68:71]
    s_waitcnt lgkmcnt(8)
    v_mfma_f32_16x16x32_bf16 v[72:75], v[200:203], a[120:123], v[72:75]
    buffer_load_dwordx4 v30, s[28:31], s53 offen offset:2112  lds
    v_mfma_f32_16x16x32_bf16 v[80:83], v[200:203], a[124:127], v[80:83]
    v_mfma_f32_16x16x32_bf16 v[88:91], v[200:203], a[128:131], v[88:91]
    v_mfma_f32_16x16x32_bf16 v[96:99], v[200:203], a[132:135], v[96:99]
    v_mfma_f32_16x16x32_bf16 v[104:107], v[200:203], a[136:139], v[104:107]
    buffer_load_dwordx4 v31, s[28:31], s53 offen offset:3144  lds
    v_mfma_f32_16x16x32_bf16 v[76:79], v[204:207], a[120:123], v[76:79]
    v_mfma_f32_16x16x32_bf16 v[84:87], v[204:207], a[124:127], v[84:87]
    v_mfma_f32_16x16x32_bf16 v[92:95], v[204:207], a[128:131], v[92:95]
    s_add_u32 s51, s53, 65536
    s_add_u32 m0, s49, 38016
    v_mfma_f32_16x16x32_bf16 v[100:103], v[204:207], a[132:135], v[100:103]
    v_mfma_f32_16x16x32_bf16 v[108:111], v[204:207], a[136:139], v[108:111]
    buffer_load_dwordx4 v28, s[28:31], s51 offen offset:0  lds
    s_waitcnt vmcnt(10) lgkmcnt(0)
    s_barrier
    v_mfma_f32_16x16x32_bf16 v[112:115], v[208:211], a[120:123], v[112:115]
    ds_read_b128 a[100:103], v14 offset:0
    v_add_u32 v12, 0, v6
    v_mfma_f32_16x16x32_bf16 v[120:123], v[208:211], a[124:127], v[120:123]
    ds_read_b64_tr_b16 v[192:193], v12 offset:0
    v_mfma_f32_16x16x32_bf16 v[128:131], v[208:211], a[128:131], v[128:131]
    ds_read_b64_tr_b16 v[194:195], v12 offset:512
    v_mfma_f32_16x16x32_bf16 v[136:139], v[208:211], a[132:135], v[136:139]
    ds_read_b64_tr_b16 v[196:197], v12 offset:8
    v_mfma_f32_16x16x32_bf16 v[144:147], v[208:211], a[136:139], v[144:147]
    ds_read_b64_tr_b16 v[198:199], v12 offset:520
    v_mfma_f32_16x16x32_bf16 v[116:119], v[212:215], a[120:123], v[116:119]
    ds_read_b128 a[104:107], v14 offset:2048
    v_mfma_f32_16x16x32_bf16 v[124:127], v[212:215], a[124:127], v[124:127]
    ds_read_b128 a[108:111], v14 offset:4096
    v_mfma_f32_16x16x32_bf16 v[132:135], v[212:215], a[128:131], v[132:135]
    ds_read_b128 a[112:115], v14 offset:6144
    v_mfma_f32_16x16x32_bf16 v[140:143], v[212:215], a[132:135], v[140:143]
    ds_read_b128 a[116:119], v14 offset:8192
    v_mfma_f32_16x16x32_bf16 v[148:151], v[212:215], a[136:139], v[148:151]
    ds_read_b64_tr_b16 v[200:201], v12 offset:64
    v_mfma_f32_16x16x32_bf16 v[152:155], v[216:219], a[120:123], v[152:155]
    buffer_load_dwordx4 v29, s[28:31], s51 offen offset:1032  lds
    v_mfma_f32_16x16x32_bf16 v[160:163], v[216:219], a[124:127], v[160:163]
    buffer_load_dwordx4 v30, s[28:31], s51 offen offset:2112  lds
    v_mfma_f32_16x16x32_bf16 v[168:171], v[216:219], a[128:131], v[168:171]
    ds_read_b64_tr_b16 v[202:203], v12 offset:576
    v_mfma_f32_16x16x32_bf16 v[176:179], v[216:219], a[132:135], v[176:179]
    ds_read_b64_tr_b16 v[204:205], v12 offset:72
    v_mfma_f32_16x16x32_bf16 v[184:187], v[216:219], a[136:139], v[184:187]
    ds_read_b64_tr_b16 v[206:207], v12 offset:584
    v_mfma_f32_16x16x32_bf16 v[156:159], v[220:223], a[120:123], v[156:159]
    buffer_load_dwordx4 v31, s[28:31], s51 offen offset:3144  lds
    v_mfma_f32_16x16x32_bf16 v[164:167], v[220:223], a[124:127], v[164:167]
    s_mov_b32 s6, 131072
    ds_read_b64_tr_b16 v[208:209], v12 offset:128
    v_mfma_f32_16x16x32_bf16 v[172:175], v[220:223], a[128:131], v[172:175]
    buffer_load_dwordx4 a[96:99], v3, s[36:39], s6 offen offset:3584 nt
    v_mfma_f32_16x16x32_bf16 v[180:183], v[220:223], a[132:135], v[180:183]
    s_mov_b32 s6, 163840
    ds_read_b64_tr_b16 v[210:211], v12 offset:640
    v_mfma_f32_16x16x32_bf16 v[188:191], v[220:223], a[136:139], v[188:191]
    s_waitcnt lgkmcnt(6)
    ds_read_b64_tr_b16 v[212:213], v12 offset:136
    v_mfma_f32_16x16x32_bf16 v[32:35], v[192:195], a[100:103], v[32:35]
    buffer_load_dwordx4 a[244:247], v3, s[36:39], s6 offen offset:3584 nt
    v_mfma_f32_16x16x32_bf16 v[40:43], v[192:195], a[104:107], v[40:43]
    s_mov_b32 s6, 196608
    ds_read_b64_tr_b16 v[214:215], v12 offset:648
    v_mfma_f32_16x16x32_bf16 v[48:51], v[192:195], a[108:111], v[48:51]
    buffer_load_dwordx4 a[248:251], v3, s[36:39], s6 offen offset:3584 nt
    v_mfma_f32_16x16x32_bf16 v[56:59], v[192:195], a[112:115], v[56:59]
    s_mov_b32 s6, 229376
    ds_read_b64_tr_b16 v[216:217], v12 offset:192
    v_mfma_f32_16x16x32_bf16 v[64:67], v[192:195], a[116:119], v[64:67]
    buffer_load_dwordx4 a[252:255], v3, s[36:39], s6 offen offset:3584 nt
    v_mfma_f32_16x16x32_bf16 v[36:39], v[196:199], a[100:103], v[36:39]
    s_bitcmp1_b32 s56, 0
    s_cselect_b32 s54, 4, 5
    s_lshl_b32 s53, s54, 19
    v_mfma_f32_16x16x32_bf16 v[44:47], v[196:199], a[104:107], v[44:47]
    s_lshl_b32 s54, s54, 7
    s_add_u32 m0, s50, 142336
    v_mfma_f32_16x16x32_bf16 v[52:55], v[196:199], a[108:111], v[52:55]
    buffer_load_dwordx4 v224, s[24:27], s54 offen offset:0  lds
    v_mfma_f32_16x16x32_bf16 v[60:63], v[196:199], a[112:115], v[60:63]
    ds_read_b64_tr_b16 v[218:219], v12 offset:704
    v_mfma_f32_16x16x32_bf16 v[68:71], v[196:199], a[116:119], v[68:71]
    s_waitcnt lgkmcnt(6)
    ds_read_b64_tr_b16 v[220:221], v12 offset:200
    v_mfma_f32_16x16x32_bf16 v[72:75], v[200:203], a[100:103], v[72:75]
    buffer_load_dwordx4 v225, s[24:27], s54 offen offset:1024  lds
    v_mfma_f32_16x16x32_bf16 v[80:83], v[200:203], a[104:107], v[80:83]
    ds_read_b64_tr_b16 v[222:223], v12 offset:712
    v_mfma_f32_16x16x32_bf16 v[88:91], v[200:203], a[108:111], v[88:91]
    ds_read_b128 a[120:123], v15 offset:0
    v_mfma_f32_16x16x32_bf16 v[96:99], v[200:203], a[112:115], v[96:99]
    ds_read_b128 a[124:127], v15 offset:2048
    v_mfma_f32_16x16x32_bf16 v[104:107], v[200:203], a[116:119], v[104:107]
    buffer_load_dwordx4 v226, s[24:27], s54 offen offset:2048  lds
    v_mfma_f32_16x16x32_bf16 v[76:79], v[204:207], a[100:103], v[76:79]
    ds_read_b128 a[128:131], v15 offset:4096
    v_mfma_f32_16x16x32_bf16 v[84:87], v[204:207], a[104:107], v[84:87]
    ds_read_b128 a[132:135], v15 offset:6144
    v_mfma_f32_16x16x32_bf16 v[92:95], v[204:207], a[108:111], v[92:95]
    ds_read_b128 a[136:139], v15 offset:8192
    v_mfma_f32_16x16x32_bf16 v[100:103], v[204:207], a[112:115], v[100:103]
    ds_read_b64_tr_b16 v[192:193], v12 offset:16896
    v_mfma_f32_16x16x32_bf16 v[108:111], v[204:207], a[116:119], v[108:111]
    s_waitcnt lgkmcnt(10)
    ds_read_b64_tr_b16 v[194:195], v12 offset:17408
    v_mfma_f32_16x16x32_bf16 v[112:115], v[208:211], a[100:103], v[112:115]
    buffer_load_dwordx4 v227, s[24:27], s54 offen offset:3072  lds
    v_mfma_f32_16x16x32_bf16 v[120:123], v[208:211], a[104:107], v[120:123]
    ds_read_b64_tr_b16 v[196:197], v12 offset:16904
    v_mfma_f32_16x16x32_bf16 v[128:131], v[208:211], a[108:111], v[128:131]
    ds_read_b64_tr_b16 v[198:199], v12 offset:17416
    s_add_u32 m0, s50, 146432
    v_mfma_f32_16x16x32_bf16 v[136:139], v[208:211], a[112:115], v[136:139]
    ds_read_b64_tr_b16 v[200:201], v12 offset:16960
    v_mfma_f32_16x16x32_bf16 v[144:147], v[208:211], a[116:119], v[144:147]
    buffer_load_dwordx4 v228, s[24:27], s54 offen  lds
    v_mfma_f32_16x16x32_bf16 v[116:119], v[212:215], a[100:103], v[116:119]
    ds_read_b64_tr_b16 v[202:203], v12 offset:17472
    v_mfma_f32_16x16x32_bf16 v[124:127], v[212:215], a[104:107], v[124:127]
    ds_read_b64_tr_b16 v[204:205], v12 offset:16968
    v_mfma_f32_16x16x32_bf16 v[132:135], v[212:215], a[108:111], v[132:135]
    s_add_u32 m0, s49, 67584
    ds_read_b64_tr_b16 v[206:207], v12 offset:17480
    v_mfma_f32_16x16x32_bf16 v[140:143], v[212:215], a[112:115], v[140:143]
    ds_read_b64_tr_b16 v[208:209], v12 offset:17024
    v_mfma_f32_16x16x32_bf16 v[148:151], v[212:215], a[116:119], v[148:151]
    s_waitcnt lgkmcnt(14)
    ds_read_b64_tr_b16 v[210:211], v12 offset:17536
    v_mfma_f32_16x16x32_bf16 v[152:155], v[216:219], a[100:103], v[152:155]
    buffer_load_dwordx4 v28, s[28:31], s53 offen offset:0  lds
    v_mfma_f32_16x16x32_bf16 v[160:163], v[216:219], a[104:107], v[160:163]
    ds_read_b64_tr_b16 v[212:213], v12 offset:17032
    v_mfma_f32_16x16x32_bf16 v[168:171], v[216:219], a[108:111], v[168:171]
    ds_read_b64_tr_b16 v[214:215], v12 offset:17544
    v_mfma_f32_16x16x32_bf16 v[176:179], v[216:219], a[112:115], v[176:179]
    v_mfma_f32_16x16x32_bf16 v[184:187], v[216:219], a[116:119], v[184:187]
    buffer_load_dwordx4 v29, s[28:31], s53 offen offset:1032  lds
    v_mfma_f32_16x16x32_bf16 v[156:159], v[220:223], a[100:103], v[156:159]
    ds_read_b64_tr_b16 v[216:217], v12 offset:17088
    v_mfma_f32_16x16x32_bf16 v[164:167], v[220:223], a[104:107], v[164:167]
    ds_read_b64_tr_b16 v[218:219], v12 offset:17600
    v_mfma_f32_16x16x32_bf16 v[172:175], v[220:223], a[108:111], v[172:175]
    v_mfma_f32_16x16x32_bf16 v[180:183], v[220:223], a[112:115], v[180:183]
    v_mfma_f32_16x16x32_bf16 v[188:191], v[220:223], a[116:119], v[188:191]
    s_waitcnt lgkmcnt(10)
    v_mfma_f32_16x16x32_bf16 v[32:35], v[192:195], a[120:123], v[32:35]
    buffer_load_dwordx4 v30, s[28:31], s53 offen offset:2112  lds
    v_mfma_f32_16x16x32_bf16 v[40:43], v[192:195], a[124:127], v[40:43]
    ds_read_b64_tr_b16 v[220:221], v12 offset:17096
    v_mfma_f32_16x16x32_bf16 v[48:51], v[192:195], a[128:131], v[48:51]
    ds_read_b64_tr_b16 v[222:223], v12 offset:17608
    v_mfma_f32_16x16x32_bf16 v[56:59], v[192:195], a[132:135], v[56:59]
    v_mfma_f32_16x16x32_bf16 v[64:67], v[192:195], a[136:139], v[64:67]
    buffer_load_dwordx4 v31, s[28:31], s53 offen offset:3144  lds
    v_mfma_f32_16x16x32_bf16 v[36:39], v[196:199], a[120:123], v[36:39]
    v_mfma_f32_16x16x32_bf16 v[44:47], v[196:199], a[124:127], v[44:47]
    v_mfma_f32_16x16x32_bf16 v[52:55], v[196:199], a[128:131], v[52:55]
    s_add_u32 s51, s53, 65536
    s_add_u32 m0, s49, 71808
    v_mfma_f32_16x16x32_bf16 v[60:63], v[196:199], a[132:135], v[60:63]
    v_mfma_f32_16x16x32_bf16 v[68:71], v[196:199], a[136:139], v[68:71]
    s_waitcnt lgkmcnt(8)
    v_mfma_f32_16x16x32_bf16 v[72:75], v[200:203], a[120:123], v[72:75]
    buffer_load_dwordx4 v28, s[28:31], s51 offen offset:0  lds
    v_mfma_f32_16x16x32_bf16 v[80:83], v[200:203], a[124:127], v[80:83]
    v_mfma_f32_16x16x32_bf16 v[88:91], v[200:203], a[128:131], v[88:91]
    v_mfma_f32_16x16x32_bf16 v[96:99], v[200:203], a[132:135], v[96:99]
    v_mfma_f32_16x16x32_bf16 v[104:107], v[200:203], a[136:139], v[104:107]
    buffer_load_dwordx4 v29, s[28:31], s51 offen offset:1032  lds
    v_mfma_f32_16x16x32_bf16 v[76:79], v[204:207], a[120:123], v[76:79]
    v_mfma_f32_16x16x32_bf16 v[84:87], v[204:207], a[124:127], v[84:87]
    v_mfma_f32_16x16x32_bf16 v[92:95], v[204:207], a[128:131], v[92:95]
    v_mfma_f32_16x16x32_bf16 v[100:103], v[204:207], a[132:135], v[100:103]
    v_mfma_f32_16x16x32_bf16 v[108:111], v[204:207], a[136:139], v[108:111]
    buffer_load_dwordx4 v30, s[28:31], s51 offen offset:2112  lds
    s_waitcnt vmcnt(16) lgkmcnt(0)
    s_barrier
    v_mfma_f32_16x16x32_bf16 v[112:115], v[208:211], a[120:123], v[112:115]
    ds_read_b128 a[100:103], v14 offset:20480
    v_add_u32 v12, 33792, v6
    v_mfma_f32_16x16x32_bf16 v[120:123], v[208:211], a[124:127], v[120:123]
    ds_read_b64_tr_b16 v[192:193], v12 offset:0
    v_mfma_f32_16x16x32_bf16 v[128:131], v[208:211], a[128:131], v[128:131]
    ds_read_b64_tr_b16 v[194:195], v12 offset:512
    v_mfma_f32_16x16x32_bf16 v[136:139], v[208:211], a[132:135], v[136:139]
    ds_read_b64_tr_b16 v[196:197], v12 offset:8
    v_mfma_f32_16x16x32_bf16 v[144:147], v[208:211], a[136:139], v[144:147]
    ds_read_b64_tr_b16 v[198:199], v12 offset:520
    v_mfma_f32_16x16x32_bf16 v[116:119], v[212:215], a[120:123], v[116:119]
    ds_read_b128 a[104:107], v14 offset:22528
    v_mfma_f32_16x16x32_bf16 v[124:127], v[212:215], a[124:127], v[124:127]
    ds_read_b128 a[108:111], v14 offset:24576
    v_mfma_f32_16x16x32_bf16 v[132:135], v[212:215], a[128:131], v[132:135]
    ds_read_b128 a[112:115], v14 offset:26624
    v_mfma_f32_16x16x32_bf16 v[140:143], v[212:215], a[132:135], v[140:143]
    ds_read_b128 a[116:119], v14 offset:28672
    v_mfma_f32_16x16x32_bf16 v[148:151], v[212:215], a[136:139], v[148:151]
    ds_read_b64_tr_b16 v[200:201], v12 offset:64
    v_mfma_f32_16x16x32_bf16 v[152:155], v[216:219], a[120:123], v[152:155]
    buffer_load_dwordx4 v31, s[28:31], s51 offen offset:3144  lds
    v_mfma_f32_16x16x32_bf16 v[160:163], v[216:219], a[124:127], v[160:163]
    s_mov_b32 s53, 3145728
    s_mov_b32 s54, 768
    s_add_u32 m0, s50, 101376
    v_mfma_f32_16x16x32_bf16 v[168:171], v[216:219], a[128:131], v[168:171]
    buffer_load_dwordx4 v224, s[24:27], s54 offen offset:0  lds
    v_mfma_f32_16x16x32_bf16 v[176:179], v[216:219], a[132:135], v[176:179]
    ds_read_b64_tr_b16 v[202:203], v12 offset:576
    v_mfma_f32_16x16x32_bf16 v[184:187], v[216:219], a[136:139], v[184:187]
    ds_read_b64_tr_b16 v[204:205], v12 offset:72
    v_mfma_f32_16x16x32_bf16 v[156:159], v[220:223], a[120:123], v[156:159]
    ds_read_b64_tr_b16 v[206:207], v12 offset:584
    v_mfma_f32_16x16x32_bf16 v[164:167], v[220:223], a[124:127], v[164:167]
    buffer_load_dwordx4 v225, s[24:27], s54 offen offset:1024  lds
    v_mfma_f32_16x16x32_bf16 v[172:175], v[220:223], a[128:131], v[172:175]
    buffer_load_dwordx4 v226, s[24:27], s54 offen offset:2048  lds
    v_mfma_f32_16x16x32_bf16 v[180:183], v[220:223], a[132:135], v[180:183]
    ds_read_b64_tr_b16 v[208:209], v12 offset:128
    v_mfma_f32_16x16x32_bf16 v[188:191], v[220:223], a[136:139], v[188:191]
    s_waitcnt lgkmcnt(5)
    ds_read_b64_tr_b16 v[210:211], v12 offset:640
    v_mfma_f32_16x16x32_bf16 v[32:35], v[192:195], a[100:103], v[32:35]
    ds_read_b64_tr_b16 v[212:213], v12 offset:136
    v_mfma_f32_16x16x32_bf16 v[40:43], v[192:195], a[104:107], v[40:43]
    ds_read_b64_tr_b16 v[214:215], v12 offset:648
    v_mfma_f32_16x16x32_bf16 v[48:51], v[192:195], a[108:111], v[48:51]
    buffer_load_dwordx4 v227, s[24:27], s54 offen offset:3072  lds
    v_mfma_f32_16x16x32_bf16 v[56:59], v[192:195], a[112:115], v[56:59]
    ds_read_b64_tr_b16 v[216:217], v12 offset:192
    v_mfma_f32_16x16x32_bf16 v[64:67], v[192:195], a[116:119], v[64:67]
    s_add_u32 m0, s50, 105472
    ds_read_b64_tr_b16 v[218:219], v12 offset:704
    v_mfma_f32_16x16x32_bf16 v[36:39], v[196:199], a[100:103], v[36:39]
    ds_read_b64_tr_b16 v[220:221], v12 offset:200
    v_mfma_f32_16x16x32_bf16 v[44:47], v[196:199], a[104:107], v[44:47]
    buffer_load_dwordx4 v228, s[24:27], s54 offen  lds
    v_mfma_f32_16x16x32_bf16 v[52:55], v[196:199], a[108:111], v[52:55]
    ds_read_b64_tr_b16 v[222:223], v12 offset:712
    v_mfma_f32_16x16x32_bf16 v[60:63], v[196:199], a[112:115], v[60:63]
    ds_read_b128 a[120:123], v15 offset:20480
    v_mfma_f32_16x16x32_bf16 v[68:71], v[196:199], a[116:119], v[68:71]
    s_waitcnt lgkmcnt(9)
    s_add_u32 m0, s49, 0
    v_mfma_f32_16x16x32_bf16 v[72:75], v[200:203], a[100:103], v[72:75]
    ds_read_b128 a[124:127], v15 offset:22528
    v_mov_b32 v238, 0
    v_mfma_f32_16x16x32_bf16 v[80:83], v[200:203], a[104:107], v[80:83]
    buffer_load_dwordx4 v28, s[28:31], s53 offen offset:0  lds
    v_mfma_f32_16x16x32_bf16 v[88:91], v[200:203], a[108:111], v[88:91]
    ds_read_b128 a[128:131], v15 offset:24576
    v_lshlrev_b32 v239, 2, v0
    v_mfma_f32_16x16x32_bf16 v[96:99], v[200:203], a[112:115], v[96:99]
    ds_read_b128 a[132:135], v15 offset:26624
    v_mfma_f32_16x16x32_bf16 v[104:107], v[200:203], a[116:119], v[104:107]
    ds_read_b128 a[136:139], v15 offset:28672
    v_mfma_f32_16x16x32_bf16 v[76:79], v[204:207], a[100:103], v[76:79]
    ds_read_b64_tr_b16 v[192:193], v12 offset:16896
    v_mfma_f32_16x16x32_bf16 v[84:87], v[204:207], a[104:107], v[84:87]
    buffer_load_dwordx4 v29, s[28:31], s53 offen offset:1032  lds
    v_mfma_f32_16x16x32_bf16 v[92:95], v[204:207], a[108:111], v[92:95]
    ds_read_b64_tr_b16 v[194:195], v12 offset:17408
    v_mfma_f32_16x16x32_bf16 v[100:103], v[204:207], a[112:115], v[100:103]
    ds_read_b64_tr_b16 v[196:197], v12 offset:16904
    v_mfma_f32_16x16x32_bf16 v[108:111], v[204:207], a[116:119], v[108:111]
    s_waitcnt lgkmcnt(12)
    ds_read_b64_tr_b16 v[198:199], v12 offset:17416
    v_mfma_f32_16x16x32_bf16 v[112:115], v[208:211], a[100:103], v[112:115]
    ds_read_b64_tr_b16 v[200:201], v12 offset:16960
    v_mfma_f32_16x16x32_bf16 v[120:123], v[208:211], a[104:107], v[120:123]
    buffer_load_dwordx4 v30, s[28:31], s53 offen offset:2112  lds
    v_mfma_f32_16x16x32_bf16 v[128:131], v[208:211], a[108:111], v[128:131]
    ds_read_b64_tr_b16 v[202:203], v12 offset:17472
    v_mfma_f32_16x16x32_bf16 v[136:139], v[208:211], a[112:115], v[136:139]
    ds_read_b64_tr_b16 v[204:205], v12 offset:16968
    v_mfma_f32_16x16x32_bf16 v[144:147], v[208:211], a[116:119], v[144:147]
    ds_read_b64_tr_b16 v[206:207], v12 offset:17480
    v_mfma_f32_16x16x32_bf16 v[116:119], v[212:215], a[100:103], v[116:119]
    s_lshl_b32 s58, s62, 10
    s_lshl_b32 s59, s48, 8
    s_add_u32 s58, s58, s59
    s_lshl_b32 s59, s5, 20
    s_add_u32 s58, s58, s59
    v_mfma_f32_16x16x32_bf16 v[124:127], v[212:215], a[104:107], v[124:127]
    buffer_load_dwordx4 v31, s[28:31], s53 offen offset:3144  lds
    v_mfma_f32_16x16x32_bf16 v[132:135], v[212:215], a[108:111], v[132:135]
    buffer_store_dword v238, v239, s[8:11], s58 offen sc1
    v_mfma_f32_16x16x32_bf16 v[140:143], v[212:215], a[112:115], v[140:143]
    s_add_u32 s59, s48, s5
    s_lshl_b32 s59, s59, 12
    s_add_u32 s59, s59, s62
    s_lshl_b32 s59, s59, 8
    s_add_u32 s59, s59, 16384
    v_mfma_f32_16x16x32_bf16 v[148:151], v[212:215], a[116:119], v[148:151]
    s_waitcnt lgkmcnt(13)
    s_add_u32 s51, s53, 65536
    s_add_u32 m0, s49, 4224
    v_mfma_f32_16x16x32_bf16 v[152:155], v[216:219], a[100:103], v[152:155]
    buffer_store_dword v238, v239, s[8:11], s59 offen sc1
    v_mfma_f32_16x16x32_bf16 v[160:163], v[216:219], a[104:107], v[160:163]
    buffer_load_dwordx4 v28, s[28:31], s51 offen offset:0  lds
    v_mfma_f32_16x16x32_bf16 v[168:171], v[216:219], a[108:111], v[168:171]
    ds_read_b64_tr_b16 v[208:209], v12 offset:17024
    v_mfma_f32_16x16x32_bf16 v[176:179], v[216:219], a[112:115], v[176:179]
    ds_read_b64_tr_b16 v[210:211], v12 offset:17536
    v_mfma_f32_16x16x32_bf16 v[184:187], v[216:219], a[116:119], v[184:187]
    ds_read_b64_tr_b16 v[212:213], v12 offset:17032
    v_mfma_f32_16x16x32_bf16 v[156:159], v[220:223], a[100:103], v[156:159]
    ds_read_b64_tr_b16 v[214:215], v12 offset:17544
    v_mfma_f32_16x16x32_bf16 v[164:167], v[220:223], a[104:107], v[164:167]
    buffer_load_dwordx4 v29, s[28:31], s51 offen offset:1032  lds
    v_mfma_f32_16x16x32_bf16 v[172:175], v[220:223], a[108:111], v[172:175]
    ds_read_b64_tr_b16 v[216:217], v12 offset:17088
    v_mfma_f32_16x16x32_bf16 v[180:183], v[220:223], a[112:115], v[180:183]
    ds_read_b64_tr_b16 v[218:219], v12 offset:17600
    v_mfma_f32_16x16x32_bf16 v[188:191], v[220:223], a[116:119], v[188:191]
    s_waitcnt lgkmcnt(10)
    v_mfma_f32_16x16x32_bf16 v[32:35], v[192:195], a[120:123], v[32:35]
    ds_read_b64_tr_b16 v[220:221], v12 offset:17096
    v_mfma_f32_16x16x32_bf16 v[40:43], v[192:195], a[124:127], v[40:43]
    buffer_load_dwordx4 v30, s[28:31], s51 offen offset:2112  lds
    v_mfma_f32_16x16x32_bf16 v[48:51], v[192:195], a[128:131], v[48:51]
    ds_read_b64_tr_b16 v[222:223], v12 offset:17608
    v_mfma_f32_16x16x32_bf16 v[56:59], v[192:195], a[132:135], v[56:59]
    v_mfma_f32_16x16x32_bf16 v[64:67], v[192:195], a[136:139], v[64:67]
    v_mfma_f32_16x16x32_bf16 v[36:39], v[196:199], a[120:123], v[36:39]
    v_mfma_f32_16x16x32_bf16 v[44:47], v[196:199], a[124:127], v[44:47]
    buffer_load_dwordx4 v31, s[28:31], s51 offen offset:3144  lds
    v_mfma_f32_16x16x32_bf16 v[52:55], v[196:199], a[128:131], v[52:55]
    v_mfma_f32_16x16x32_bf16 v[60:63], v[196:199], a[132:135], v[60:63]
    v_mfma_f32_16x16x32_bf16 v[68:71], v[196:199], a[136:139], v[68:71]
    s_waitcnt lgkmcnt(8)
    v_mfma_f32_16x16x32_bf16 v[72:75], v[200:203], a[120:123], v[72:75]
    v_mfma_f32_16x16x32_bf16 v[80:83], v[200:203], a[124:127], v[80:83]
    v_mfma_f32_16x16x32_bf16 v[88:91], v[200:203], a[128:131], v[88:91]
    v_mfma_f32_16x16x32_bf16 v[96:99], v[200:203], a[132:135], v[96:99]
    v_mfma_f32_16x16x32_bf16 v[104:107], v[200:203], a[136:139], v[104:107]
    v_mfma_f32_16x16x32_bf16 v[76:79], v[204:207], a[120:123], v[76:79]
    v_mfma_f32_16x16x32_bf16 v[84:87], v[204:207], a[124:127], v[84:87]
    v_mfma_f32_16x16x32_bf16 v[92:95], v[204:207], a[128:131], v[92:95]
    v_mfma_f32_16x16x32_bf16 v[100:103], v[204:207], a[132:135], v[100:103]
    v_mfma_f32_16x16x32_bf16 v[108:111], v[204:207], a[136:139], v[108:111]
    s_waitcnt vmcnt(15) lgkmcnt(0)
    s_barrier
    v_mfma_f32_16x16x32_bf16 v[112:115], v[208:211], a[120:123], v[112:115]
    ds_read_b128 a[100:103], v14 offset:40960
    v_add_u32 v28, 0, v2
    v_mfma_f32_16x16x32_bf16 v[120:123], v[208:211], a[124:127], v[120:123]
    ds_read_b128 a[104:107], v14 offset:43008
    v_subrev_u32 v29, 544, v2
    v_mfma_f32_16x16x32_bf16 v[128:131], v[208:211], a[128:131], v[128:131]
    ds_read_b128 a[108:111], v14 offset:45056
    v_subrev_u32 v30, 1088, v2
    v_mfma_f32_16x16x32_bf16 v[136:139], v[208:211], a[132:135], v[136:139]
    ds_read_b128 a[112:115], v14 offset:47104
    v_subrev_u32 v31, 1632, v2
    v_mfma_f32_16x16x32_bf16 v[144:147], v[208:211], a[136:139], v[144:147]
    s_mov_b32 s51, 0
    s_add_u32 m0, s49, 33792
    v_add_u32 v12, 67584, v6
    v_mfma_f32_16x16x32_bf16 v[116:119], v[212:215], a[120:123], v[116:119]
    buffer_load_dwordx4 v28, s[32:35], s51 offen offset:0 nt lds
    v_mfma_f32_16x16x32_bf16 v[124:127], v[212:215], a[124:127], v[124:127]
    ds_read_b64_tr_b16 v[192:193], v12 offset:0
    v_mfma_f32_16x16x32_bf16 v[132:135], v[212:215], a[128:131], v[132:135]
    ds_read_b64_tr_b16 v[194:195], v12 offset:512
    v_mfma_f32_16x16x32_bf16 v[140:143], v[212:215], a[132:135], v[140:143]
    ds_read_b64_tr_b16 v[196:197], v12 offset:8
    v_mfma_f32_16x16x32_bf16 v[148:151], v[212:215], a[136:139], v[148:151]
    ds_read_b64_tr_b16 v[198:199], v12 offset:520
    v_mfma_f32_16x16x32_bf16 v[152:155], v[216:219], a[120:123], v[152:155]
    ds_read_b128 a[116:119], v14 offset:49152
    v_mfma_f32_16x16x32_bf16 v[160:163], v[216:219], a[124:127], v[160:163]
    buffer_load_dwordx4 v29, s[32:35], s51 offen offset:1056 nt lds
    v_mfma_f32_16x16x32_bf16 v[168:171], v[216:219], a[128:131], v[168:171]
    ds_read_b64_tr_b16 v[200:201], v12 offset:64
    v_mfma_f32_16x16x32_bf16 v[176:179], v[216:219], a[132:135], v[176:179]
    ds_read_b64_tr_b16 v[202:203], v12 offset:576
    v_mfma_f32_16x16x32_bf16 v[184:187], v[216:219], a[136:139], v[184:187]
    ds_read_b64_tr_b16 v[204:205], v12 offset:72
    v_mfma_f32_16x16x32_bf16 v[156:159], v[220:223], a[120:123], v[156:159]
    ds_read_b64_tr_b16 v[206:207], v12 offset:584
    v_mfma_f32_16x16x32_bf16 v[164:167], v[220:223], a[124:127], v[164:167]
    buffer_load_dwordx4 v30, s[32:35], s51 offen offset:2112 nt lds
    v_mfma_f32_16x16x32_bf16 v[172:175], v[220:223], a[128:131], v[172:175]
    ds_read_b64_tr_b16 v[208:209], v12 offset:128
    v_mfma_f32_16x16x32_bf16 v[180:183], v[220:223], a[132:135], v[180:183]
    buffer_load_dwordx4 v31, s[32:35], s51 offen offset:3168 nt lds
    v_mfma_f32_16x16x32_bf16 v[188:191], v[220:223], a[136:139], v[188:191]
    s_waitcnt lgkmcnt(5)
    ds_read_b64_tr_b16 v[210:211], v12 offset:640
    v_mfma_f32_16x16x32_bf16 v[32:35], v[192:195], a[100:103], v[32:35]
    ds_read_b64_tr_b16 v[212:213], v12 offset:136
    v_mfma_f32_16x16x32_bf16 v[40:43], v[192:195], a[104:107], v[40:43]
    ds_read_b64_tr_b16 v[214:215], v12 offset:648
    v_mfma_f32_16x16x32_bf16 v[48:51], v[192:195], a[108:111], v[48:51]
    s_add_u32 s51, s51, 4096
    s_add_u32 m0, s49, 38016
    v_mfma_f32_16x16x32_bf16 v[56:59], v[192:195], a[112:115], v[56:59]
    ds_read_b64_tr_b16 v[216:217], v12 offset:192
    v_mfma_f32_16x16x32_bf16 v[64:67], v[192:195], a[116:119], v[64:67]
    buffer_load_dwordx4 v28, s[32:35], s51 offen offset:0 nt lds
    v_mfma_f32_16x16x32_bf16 v[36:39], v[196:199], a[100:103], v[36:39]
    ds_read_b64_tr_b16 v[218:219], v12 offset:704
    v_mfma_f32_16x16x32_bf16 v[44:47], v[196:199], a[104:107], v[44:47]
    ds_read_b64_tr_b16 v[220:221], v12 offset:200
    v_mfma_f32_16x16x32_bf16 v[52:55], v[196:199], a[108:111], v[52:55]
    ds_read_b64_tr_b16 v[222:223], v12 offset:712
    v_mfma_f32_16x16x32_bf16 v[60:63], v[196:199], a[112:115], v[60:63]
    ds_read_b128 a[120:123], v15 offset:40960
    v_mfma_f32_16x16x32_bf16 v[68:71], v[196:199], a[116:119], v[68:71]
    s_waitcnt lgkmcnt(9)
    ds_read_b128 a[124:127], v15 offset:43008
    v_mfma_f32_16x16x32_bf16 v[72:75], v[200:203], a[100:103], v[72:75]
    buffer_load_dwordx4 v29, s[32:35], s51 offen offset:1056 nt lds
    v_mfma_f32_16x16x32_bf16 v[80:83], v[200:203], a[104:107], v[80:83]
    ds_read_b128 a[128:131], v15 offset:45056
    v_mfma_f32_16x16x32_bf16 v[88:91], v[200:203], a[108:111], v[88:91]
    ds_read_b128 a[132:135], v15 offset:47104
    v_mfma_f32_16x16x32_bf16 v[96:99], v[200:203], a[112:115], v[96:99]
    ds_read_b128 a[136:139], v15 offset:49152
    v_mfma_f32_16x16x32_bf16 v[104:107], v[200:203], a[116:119], v[104:107]
    ds_read_b64_tr_b16 v[192:193], v12 offset:16896
    v_mfma_f32_16x16x32_bf16 v[76:79], v[204:207], a[100:103], v[76:79]
    ds_read_b64_tr_b16 v[194:195], v12 offset:17408
    v_mfma_f32_16x16x32_bf16 v[84:87], v[204:207], a[104:107], v[84:87]
    buffer_load_dwordx4 v30, s[32:35], s51 offen offset:2112 nt lds
    v_mfma_f32_16x16x32_bf16 v[92:95], v[204:207], a[108:111], v[92:95]
    ds_read_b64_tr_b16 v[196:197], v12 offset:16904
    v_mfma_f32_16x16x32_bf16 v[100:103], v[204:207], a[112:115], v[100:103]
    ds_read_b64_tr_b16 v[198:199], v12 offset:17416
    v_mfma_f32_16x16x32_bf16 v[108:111], v[204:207], a[116:119], v[108:111]
    s_waitcnt lgkmcnt(13)
    ds_read_b64_tr_b16 v[200:201], v12 offset:16960
    v_mfma_f32_16x16x32_bf16 v[112:115], v[208:211], a[100:103], v[112:115]
    ds_read_b64_tr_b16 v[202:203], v12 offset:17472
    v_mfma_f32_16x16x32_bf16 v[120:123], v[208:211], a[104:107], v[120:123]
    ds_read_b64_tr_b16 v[204:205], v12 offset:16968
    v_mfma_f32_16x16x32_bf16 v[128:131], v[208:211], a[108:111], v[128:131]
    buffer_load_dwordx4 v31, s[32:35], s51 offen offset:3168 nt lds
    v_mfma_f32_16x16x32_bf16 v[136:139], v[208:211], a[112:115], v[136:139]
    ds_read_b64_tr_b16 v[206:207], v12 offset:17480
    v_mfma_f32_16x16x32_bf16 v[144:147], v[208:211], a[116:119], v[144:147]
    v_mfma_f32_16x16x32_bf16 v[116:119], v[212:215], a[100:103], v[116:119]
    ds_read_b64_tr_b16 v[208:209], v12 offset:17024
    v_mfma_f32_16x16x32_bf16 v[124:127], v[212:215], a[104:107], v[124:127]
    ds_read_b64_tr_b16 v[210:211], v12 offset:17536
    v_mfma_f32_16x16x32_bf16 v[132:135], v[212:215], a[108:111], v[132:135]
    v_mfma_f32_16x16x32_bf16 v[140:143], v[212:215], a[112:115], v[140:143]
    v_mfma_f32_16x16x32_bf16 v[148:151], v[212:215], a[116:119], v[148:151]
    s_waitcnt lgkmcnt(15)
    v_mfma_f32_16x16x32_bf16 v[152:155], v[216:219], a[100:103], v[152:155]
    ds_read_b64_tr_b16 v[212:213], v12 offset:17032
    v_mfma_f32_16x16x32_bf16 v[160:163], v[216:219], a[104:107], v[160:163]
    ds_read_b64_tr_b16 v[214:215], v12 offset:17544
    v_mfma_f32_16x16x32_bf16 v[168:171], v[216:219], a[108:111], v[168:171]
    v_mfma_f32_16x16x32_bf16 v[176:179], v[216:219], a[112:115], v[176:179]
    v_mfma_f32_16x16x32_bf16 v[184:187], v[216:219], a[116:119], v[184:187]
    v_mfma_f32_16x16x32_bf16 v[156:159], v[220:223], a[100:103], v[156:159]
    ds_read_b64_tr_b16 v[216:217], v12 offset:17088
    v_mfma_f32_16x16x32_bf16 v[164:167], v[220:223], a[104:107], v[164:167]
    ds_read_b64_tr_b16 v[218:219], v12 offset:17600
    v_mfma_f32_16x16x32_bf16 v[172:175], v[220:223], a[108:111], v[172:175]
    v_mfma_f32_16x16x32_bf16 v[180:183], v[220:223], a[112:115], v[180:183]
    v_mfma_f32_16x16x32_bf16 v[188:191], v[220:223], a[116:119], v[188:191]
    s_waitcnt lgkmcnt(10)
    v_mfma_f32_16x16x32_bf16 v[32:35], v[192:195], a[120:123], v[32:35]
    ds_read_b64_tr_b16 v[220:221], v12 offset:17096
    v_mfma_f32_16x16x32_bf16 v[40:43], v[192:195], a[124:127], v[40:43]
    ds_read_b64_tr_b16 v[222:223], v12 offset:17608
    v_mfma_f32_16x16x32_bf16 v[48:51], v[192:195], a[128:131], v[48:51]
    v_mfma_f32_16x16x32_bf16 v[56:59], v[192:195], a[132:135], v[56:59]
    v_mfma_f32_16x16x32_bf16 v[64:67], v[192:195], a[136:139], v[64:67]
    v_mfma_f32_16x16x32_bf16 v[36:39], v[196:199], a[120:123], v[36:39]
    v_mfma_f32_16x16x32_bf16 v[44:47], v[196:199], a[124:127], v[44:47]
    v_mfma_f32_16x16x32_bf16 v[52:55], v[196:199], a[128:131], v[52:55]
    v_mfma_f32_16x16x32_bf16 v[60:63], v[196:199], a[132:135], v[60:63]
    v_mfma_f32_16x16x32_bf16 v[68:71], v[196:199], a[136:139], v[68:71]
    s_waitcnt lgkmcnt(8)
    v_mfma_f32_16x16x32_bf16 v[72:75], v[200:203], a[120:123], v[72:75]
    v_mfma_f32_16x16x32_bf16 v[80:83], v[200:203], a[124:127], v[80:83]
    v_mfma_f32_16x16x32_bf16 v[88:91], v[200:203], a[128:131], v[88:91]
    v_mfma_f32_16x16x32_bf16 v[96:99], v[200:203], a[132:135], v[96:99]
    v_mfma_f32_16x16x32_bf16 v[104:107], v[200:203], a[136:139], v[104:107]
    v_mfma_f32_16x16x32_bf16 v[76:79], v[204:207], a[120:123], v[76:79]
    v_mfma_f32_16x16x32_bf16 v[84:87], v[204:207], a[124:127], v[84:87]
    v_mfma_f32_16x16x32_bf16 v[92:95], v[204:207], a[128:131], v[92:95]
    v_mfma_f32_16x16x32_bf16 v[100:103], v[204:207], a[132:135], v[100:103]
    v_mfma_f32_16x16x32_bf16 v[108:111], v[204:207], a[136:139], v[108:111]
    s_waitcnt vmcnt(8) lgkmcnt(0)
    s_barrier
    v_mfma_f32_16x16x32_bf16 v[112:115], v[208:211], a[120:123], v[112:115]
    s_mov_b32 s51, 32768
    s_add_u32 m0, s49, 67584
    v_add_u32 v12, 0, v6
    v_mfma_f32_16x16x32_bf16 v[120:123], v[208:211], a[124:127], v[120:123]
    buffer_load_dwordx4 v28, s[32:35], s51 offen offset:0 nt lds
    v_mfma_f32_16x16x32_bf16 v[128:131], v[208:211], a[128:131], v[128:131]
    ds_read_b64_tr_b16 v[192:193], v12 offset:0
    v_mfma_f32_16x16x32_bf16 v[136:139], v[208:211], a[132:135], v[136:139]
    ds_read_b64_tr_b16 v[194:195], v12 offset:512
    v_mfma_f32_16x16x32_bf16 v[144:147], v[208:211], a[136:139], v[144:147]
    ds_read_b64_tr_b16 v[196:197], v12 offset:8
    v_mfma_f32_16x16x32_bf16 v[116:119], v[212:215], a[120:123], v[116:119]
    ds_read_b64_tr_b16 v[198:199], v12 offset:520
    v_mfma_f32_16x16x32_bf16 v[124:127], v[212:215], a[124:127], v[124:127]
    ds_read_b128 a[100:103], v14 offset:0
    v_mfma_f32_16x16x32_bf16 v[132:135], v[212:215], a[128:131], v[132:135]
    ds_read_b128 a[104:107], v14 offset:2048
    v_mfma_f32_16x16x32_bf16 v[140:143], v[212:215], a[132:135], v[140:143]
    ds_read_b128 a[108:111], v14 offset:4096
    v_mfma_f32_16x16x32_bf16 v[148:151], v[212:215], a[136:139], v[148:151]
    ds_read_b128 a[112:115], v14 offset:6144
    v_mfma_f32_16x16x32_bf16 v[152:155], v[216:219], a[120:123], v[152:155]
    ds_read_b128 a[116:119], v14 offset:8192
    v_mfma_f32_16x16x32_bf16 v[160:163], v[216:219], a[124:127], v[160:163]
    buffer_load_dwordx4 v29, s[32:35], s51 offen offset:1056 nt lds
    v_mfma_f32_16x16x32_bf16 v[168:171], v[216:219], a[128:131], v[168:171]
    ds_read_b64_tr_b16 v[200:201], v12 offset:64
    v_mfma_f32_16x16x32_bf16 v[176:179], v[216:219], a[132:135], v[176:179]
    ds_read_b64_tr_b16 v[202:203], v12 offset:576
    v_mfma_f32_16x16x32_bf16 v[184:187], v[216:219], a[136:139], v[184:187]
    ds_read_b64_tr_b16 v[204:205], v12 offset:72
    v_mfma_f32_16x16x32_bf16 v[156:159], v[220:223], a[120:123], v[156:159]
    ds_read_b64_tr_b16 v[206:207], v12 offset:584
    v_mfma_f32_16x16x32_bf16 v[164:167], v[220:223], a[124:127], v[164:167]
    buffer_load_dwordx4 v30, s[32:35], s51 offen offset:2112 nt lds
    v_mfma_f32_16x16x32_bf16 v[172:175], v[220:223], a[128:131], v[172:175]
    ds_read_b64_tr_b16 v[208:209], v12 offset:16896
    v_mfma_f32_16x16x32_bf16 v[180:183], v[220:223], a[132:135], v[180:183]
    buffer_load_dwordx4 v31, s[32:35], s51 offen offset:3168 nt lds
    v_mfma_f32_16x16x32_bf16 v[188:191], v[220:223], a[136:139], v[188:191]
    s_waitcnt lgkmcnt(5)
    ds_read_b64_tr_b16 v[210:211], v12 offset:17408
    v_mfma_f32_16x16x32_bf16 v[32:35], v[192:195], a[100:103], v[32:35]
    ds_read_b128 a[120:123], v15 offset:0
    v_mfma_f32_16x16x32_bf16 v[40:43], v[192:195], a[104:107], v[40:43]
    ds_read_b128 a[124:127], v15 offset:2048
    v_mfma_f32_16x16x32_bf16 v[48:51], v[192:195], a[108:111], v[48:51]
    ds_read_b128 a[128:131], v15 offset:4096
    s_add_u32 s51, s51, 4096
    v_mfma_f32_16x16x32_bf16 v[56:59], v[192:195], a[112:115], v[56:59]
    ds_read_b128 a[132:135], v15 offset:6144
    s_add_u32 m0, s49, 71808
    v_mfma_f32_16x16x32_bf16 v[64:67], v[192:195], a[116:119], v[64:67]
    ds_read_b128 a[136:139], v15 offset:8192
    v_mfma_f32_16x16x32_bf16 v[36:39], v[196:199], a[100:103], v[36:39]
    ds_read_b64_tr_b16 v[212:213], v12 offset:16904
    v_mfma_f32_16x16x32_bf16 v[44:47], v[196:199], a[104:107], v[44:47]
    ds_read_b64_tr_b16 v[214:215], v12 offset:17416
    v_mfma_f32_16x16x32_bf16 v[52:55], v[196:199], a[108:111], v[52:55]
    buffer_load_dwordx4 v28, s[32:35], s51 offen offset:0 nt lds
    v_mfma_f32_16x16x32_bf16 v[60:63], v[196:199], a[112:115], v[60:63]
    ds_read_b64_tr_b16 v[216:217], v12 offset:16960
    v_mfma_f32_16x16x32_bf16 v[68:71], v[196:199], a[116:119], v[68:71]
    s_waitcnt lgkmcnt(10)
    ds_read_b64_tr_b16 v[218:219], v12 offset:17472
    v_mfma_f32_16x16x32_bf16 v[72:75], v[200:203], a[100:103], v[72:75]
    buffer_load_dwordx4 v29, s[32:35], s51 offen offset:1056 nt lds
    v_mfma_f32_16x16x32_bf16 v[80:83], v[200:203], a[104:107], v[80:83]
    ds_read_b64_tr_b16 v[220:221], v12 offset:16968
    v_mfma_f32_16x16x32_bf16 v[88:91], v[200:203], a[108:111], v[88:91]
    ds_read_b64_tr_b16 v[222:223], v12 offset:17480
    v_mfma_f32_16x16x32_bf16 v[96:99], v[200:203], a[112:115], v[96:99]
    ds_read_b64_tr_b16 v[192:193], v12 offset:128
    v_mfma_f32_16x16x32_bf16 v[104:107], v[200:203], a[116:119], v[104:107]
    ds_read_b64_tr_b16 v[194:195], v12 offset:640
    v_mfma_f32_16x16x32_bf16 v[76:79], v[204:207], a[100:103], v[76:79]
    ds_read_b64_tr_b16 v[196:197], v12 offset:136
    v_mfma_f32_16x16x32_bf16 v[84:87], v[204:207], a[104:107], v[84:87]
    buffer_load_dwordx4 v30, s[32:35], s51 offen offset:2112 nt lds
    v_mfma_f32_16x16x32_bf16 v[92:95], v[204:207], a[108:111], v[92:95]
    ds_read_b64_tr_b16 v[198:199], v12 offset:648
    v_mfma_f32_16x16x32_bf16 v[100:103], v[204:207], a[112:115], v[100:103]
    ds_read_b64_tr_b16 v[200:201], v12 offset:17024
    v_mfma_f32_16x16x32_bf16 v[108:111], v[204:207], a[116:119], v[108:111]
    s_waitcnt lgkmcnt(9)
    ds_read_b64_tr_b16 v[202:203], v12 offset:17536
    v_mfma_f32_16x16x32_bf16 v[32:35], v[208:211], a[120:123], v[32:35]
    ds_read_b64_tr_b16 v[204:205], v12 offset:17032
    v_mfma_f32_16x16x32_bf16 v[40:43], v[208:211], a[124:127], v[40:43]
    ds_read_b64_tr_b16 v[206:207], v12 offset:17544
    v_mfma_f32_16x16x32_bf16 v[48:51], v[208:211], a[128:131], v[48:51]
    buffer_load_dwordx4 v31, s[32:35], s51 offen offset:3168 nt lds
    v_mfma_f32_16x16x32_bf16 v[56:59], v[208:211], a[132:135], v[56:59]
    v_mfma_f32_16x16x32_bf16 v[64:67], v[208:211], a[136:139], v[64:67]
    v_mfma_f32_16x16x32_bf16 v[36:39], v[212:215], a[120:123], v[36:39]
    ds_read_b64_tr_b16 v[208:209], v12 offset:192
    v_mfma_f32_16x16x32_bf16 v[44:47], v[212:215], a[124:127], v[44:47]
    ds_read_b64_tr_b16 v[210:211], v12 offset:704
    v_mfma_f32_16x16x32_bf16 v[52:55], v[212:215], a[128:131], v[52:55]
    v_mfma_f32_16x16x32_bf16 v[60:63], v[212:215], a[132:135], v[60:63]
    v_mfma_f32_16x16x32_bf16 v[68:71], v[212:215], a[136:139], v[68:71]
    s_waitcnt lgkmcnt(10)
    v_cvt_pk_bf16_f32 v32, v32, v33
    v_cvt_pk_bf16_f32 v33, v34, v35
    v_mfma_f32_16x16x32_bf16 v[72:75], v[216:219], a[120:123], v[72:75]
    ds_read_b64_tr_b16 v[212:213], v12 offset:200
    v_cvt_pk_bf16_f32 v34, v36, v37
    v_mfma_f32_16x16x32_bf16 v[80:83], v[216:219], a[124:127], v[80:83]
    ds_read_b64_tr_b16 v[214:215], v12 offset:712
    v_cvt_pk_bf16_f32 v35, v38, v39
    v_mfma_f32_16x16x32_bf16 v[88:91], v[216:219], a[128:131], v[88:91]
    v_cvt_pk_bf16_f32 v40, v40, v41
    v_cvt_pk_bf16_f32 v41, v42, v43
    v_mfma_f32_16x16x32_bf16 v[96:99], v[216:219], a[132:135], v[96:99]
    v_cvt_pk_bf16_f32 v42, v44, v45
    v_cvt_pk_bf16_f32 v43, v46, v47
    v_mfma_f32_16x16x32_bf16 v[104:107], v[216:219], a[136:139], v[104:107]
    ds_write_b128 v17, v[32:35] offset:20480
    v_mfma_f32_16x16x32_bf16 v[76:79], v[220:223], a[120:123], v[76:79]
    ds_read_b64_tr_b16 v[216:217], v12 offset:17088
    v_cvt_pk_bf16_f32 v48, v48, v49
    v_mfma_f32_16x16x32_bf16 v[84:87], v[220:223], a[124:127], v[84:87]
    ds_read_b64_tr_b16 v[218:219], v12 offset:17600
    v_cvt_pk_bf16_f32 v49, v50, v51
    v_mfma_f32_16x16x32_bf16 v[92:95], v[220:223], a[128:131], v[92:95]
    v_mfma_f32_16x16x32_bf16 v[100:103], v[220:223], a[132:135], v[100:103]
    ds_write_b128 v17, v[40:43] offset:21504
    v_mfma_f32_16x16x32_bf16 v[108:111], v[220:223], a[136:139], v[108:111]
    s_waitcnt lgkmcnt(12)
    v_cvt_pk_bf16_f32 v50, v52, v53
    v_cvt_pk_bf16_f32 v51, v54, v55
    v_cvt_pk_bf16_f32 v56, v56, v57
    v_mfma_f32_16x16x32_bf16 v[112:115], v[192:195], a[100:103], v[112:115]
    ds_read_b64_tr_b16 v[220:221], v12 offset:17096
    v_cvt_pk_bf16_f32 v57, v58, v59
    v_mfma_f32_16x16x32_bf16 v[120:123], v[192:195], a[104:107], v[120:123]
    ds_read_b64_tr_b16 v[222:223], v12 offset:17608
    v_cvt_pk_bf16_f32 v58, v60, v61
    v_cvt_pk_bf16_f32 v59, v62, v63
    v_cvt_pk_bf16_f32 v64, v64, v65
    v_mfma_f32_16x16x32_bf16 v[128:131], v[192:195], a[108:111], v[128:131]
    v_cvt_pk_bf16_f32 v65, v66, v67
    v_mfma_f32_16x16x32_bf16 v[136:139], v[192:195], a[112:115], v[136:139]
    ds_write_b128 v17, v[48:51] offset:22528
    v_cvt_pk_bf16_f32 v66, v68, v69
    v_cvt_pk_bf16_f32 v67, v70, v71
    v_cvt_pk_bf16_f32 v72, v72, v73
    v_cvt_pk_bf16_f32 v73, v74, v75
    v_cvt_pk_bf16_f32 v74, v76, v77
    v_cvt_pk_bf16_f32 v75, v78, v79
    v_mfma_f32_16x16x32_bf16 v[144:147], v[192:195], a[116:119], v[144:147]
    v_mfma_f32_16x16x32_bf16 v[116:119], v[196:199], a[100:103], v[116:119]
    v_cvt_pk_bf16_f32 v80, v80, v81
    v_cvt_pk_bf16_f32 v81, v82, v83
    v_mfma_f32_16x16x32_bf16 v[124:127], v[196:199], a[104:107], v[124:127]
    ds_write_b128 v17, v[56:59] offset:23552
    v_cvt_pk_bf16_f32 v82, v84, v85
    v_cvt_pk_bf16_f32 v83, v86, v87
    v_mfma_f32_16x16x32_bf16 v[132:135], v[196:199], a[108:111], v[132:135]
    v_cvt_pk_bf16_f32 v88, v88, v89
    v_cvt_pk_bf16_f32 v89, v90, v91
    v_mfma_f32_16x16x32_bf16 v[140:143], v[196:199], a[112:115], v[140:143]
    v_mfma_f32_16x16x32_bf16 v[148:151], v[196:199], a[116:119], v[148:151]
    s_waitcnt lgkmcnt(12)
    v_cvt_pk_bf16_f32 v90, v92, v93
    v_cvt_pk_bf16_f32 v91, v94, v95
    v_mfma_f32_16x16x32_bf16 v[112:115], v[200:203], a[120:123], v[112:115]
    ds_write_b128 v17, v[64:67] offset:24576
    v_mfma_f32_16x16x32_bf16 v[120:123], v[200:203], a[124:127], v[120:123]
    v_cvt_pk_bf16_f32 v96, v96, v97
    v_cvt_pk_bf16_f32 v97, v98, v99
    v_mfma_f32_16x16x32_bf16 v[128:131], v[200:203], a[128:131], v[128:131]
    v_cvt_pk_bf16_f32 v98, v100, v101
    v_cvt_pk_bf16_f32 v99, v102, v103
    v_mfma_f32_16x16x32_bf16 v[136:139], v[200:203], a[132:135], v[136:139]
    v_cvt_pk_bf16_f32 v104, v104, v105
    v_cvt_pk_bf16_f32 v105, v106, v107
    v_mfma_f32_16x16x32_bf16 v[144:147], v[200:203], a[136:139], v[144:147]
    ds_write_b128 v17, v[72:75] offset:40960
    v_mfma_f32_16x16x32_bf16 v[116:119], v[204:207], a[120:123], v[116:119]
    v_cvt_pk_bf16_f32 v106, v108, v109
    v_cvt_pk_bf16_f32 v107, v110, v111
    v_mfma_f32_16x16x32_bf16 v[124:127], v[204:207], a[124:127], v[124:127]
    v_mfma_f32_16x16x32_bf16 v[132:135], v[204:207], a[128:131], v[132:135]
    v_mfma_f32_16x16x32_bf16 v[140:143], v[204:207], a[132:135], v[140:143]
    ds_write_b128 v17, v[80:83] offset:41984
    v_mfma_f32_16x16x32_bf16 v[148:151], v[204:207], a[136:139], v[148:151]
    v_cvt_pk_bf16_f32 v112, v112, v113
    s_waitcnt vmcnt(8) lgkmcnt(0)
    s_barrier
    v_mfma_f32_16x16x32_bf16 v[152:155], v[208:211], a[100:103], v[152:155]
    s_mov_b32 s51, 65536
    v_cvt_pk_bf16_f32 v113, v114, v115
    v_cvt_pk_bf16_f32 v114, v116, v117
    v_mfma_f32_16x16x32_bf16 v[160:163], v[208:211], a[104:107], v[160:163]
    s_add_u32 m0, s49, 0
    v_cvt_pk_bf16_f32 v115, v118, v119
    v_cvt_pk_bf16_f32 v120, v120, v121
    v_mfma_f32_16x16x32_bf16 v[168:171], v[208:211], a[108:111], v[168:171]
    buffer_load_dwordx4 v28, s[32:35], s51 offen offset:0 nt lds
    v_mfma_f32_16x16x32_bf16 v[176:179], v[208:211], a[112:115], v[176:179]
    ds_read_b128 a[160:163], v252 offset:20480
    v_cvt_pk_bf16_f32 v121, v122, v123
    v_mfma_f32_16x16x32_bf16 v[184:187], v[208:211], a[116:119], v[184:187]
    ds_read_b128 a[164:167], v252 offset:21504
    v_cvt_pk_bf16_f32 v122, v124, v125
    v_mfma_f32_16x16x32_bf16 v[156:159], v[212:215], a[100:103], v[156:159]
    ds_read_b128 a[168:171], v252 offset:22528
    v_cvt_pk_bf16_f32 v123, v126, v127
    v_mfma_f32_16x16x32_bf16 v[164:167], v[212:215], a[104:107], v[164:167]
    buffer_load_dwordx4 v29, s[32:35], s51 offen offset:1056 nt lds
    v_mfma_f32_16x16x32_bf16 v[172:175], v[212:215], a[108:111], v[172:175]
    ds_read_b128 a[172:175], v252 offset:23552
    v_add_u32 v12, 33792, v7
    v_mfma_f32_16x16x32_bf16 v[180:183], v[212:215], a[112:115], v[180:183]
    ds_read_b128 a[176:179], v252 offset:24576
    v_add_u32 v13, 33792, v8
    v_cvt_pk_bf16_f32 v128, v128, v129
    v_cvt_pk_bf16_f32 v129, v130, v131
    v_mfma_f32_16x16x32_bf16 v[188:191], v[212:215], a[116:119], v[188:191]
    ds_read_b128 v[192:195], v12 offset:0
    ds_read_b128 v[196:199], v12 offset:8448
    v_cvt_pk_bf16_f32 v130, v132, v133
    v_cvt_pk_bf16_f32 v131, v134, v135
    v_mfma_f32_16x16x32_bf16 v[152:155], v[216:219], a[120:123], v[152:155]
    ds_read_b128 v[200:203], v12 offset:64
    v_cvt_pk_bf16_f32 v136, v136, v137
    v_mfma_f32_16x16x32_bf16 v[160:163], v[216:219], a[124:127], v[160:163]
    ds_read_b128 v[204:207], v12 offset:8512
    v_cvt_pk_bf16_f32 v137, v138, v139
    v_mfma_f32_16x16x32_bf16 v[168:171], v[216:219], a[128:131], v[168:171]
    buffer_load_dwordx4 v30, s[32:35], s51 offen offset:2112 nt lds
    v_cvt_pk_bf16_f32 v138, v140, v141
    v_cvt_pk_bf16_f32 v139, v142, v143
    v_mfma_f32_16x16x32_bf16 v[176:179], v[216:219], a[132:135], v[176:179]
    ds_read_b128 v[208:211], v12 offset:128
    v_cvt_pk_bf16_f32 v144, v144, v145
    v_mfma_f32_16x16x32_bf16 v[184:187], v[216:219], a[136:139], v[184:187]
    ds_read_b128 v[212:215], v12 offset:8576
    v_cvt_pk_bf16_f32 v145, v146, v147
    v_mfma_f32_16x16x32_bf16 v[156:159], v[220:223], a[120:123], v[156:159]
    ds_read_b128 v[216:219], v12 offset:192
    v_cvt_pk_bf16_f32 v146, v148, v149
    v_cvt_pk_bf16_f32 v147, v150, v151
    v_mfma_f32_16x16x32_bf16 v[164:167], v[220:223], a[124:127], v[164:167]
    v_mfma_f32_16x16x32_bf16 v[172:175], v[220:223], a[128:131], v[172:175]
    ds_write_b128 v17, v[88:91] offset:43008
    v_mfma_f32_16x16x32_bf16 v[180:183], v[220:223], a[132:135], v[180:183]
    buffer_load_dwordx4 v31, s[32:35], s51 offen offset:3168 nt lds
    v_mfma_f32_16x16x32_bf16 v[188:191], v[220:223], a[136:139], v[188:191]
    s_waitcnt lgkmcnt(6)
    v_cvt_pk_bf16_f32 v152, v152, v153
    v_cvt_pk_bf16_f32 v153, v154, v155
    v_mfma_f32_16x16x32_bf16 v[36:39], v[192:195], v[32:35], 0
    ds_read_b128 v[220:223], v12 offset:8640
    v_cvt_pk_bf16_f32 v154, v156, v157
    v_mfma_f32_16x16x32_bf16 v[44:47], v[192:195], v[40:43], 0
    v_mfma_f32_16x16x32_bf16 v[52:55], v[192:195], v[48:51], 0
    s_add_u32 s51, s51, 4096
    v_cvt_pk_bf16_f32 v155, v158, v159
    v_cvt_pk_bf16_f32 v160, v160, v161
    v_mfma_f32_16x16x32_bf16 v[60:63], v[192:195], v[56:59], 0
    s_add_u32 m0, s49, 4224
    v_cvt_pk_bf16_f32 v161, v162, v163
    v_cvt_pk_bf16_f32 v162, v164, v165
    v_mfma_f32_16x16x32_bf16 v[68:71], v[192:195], v[64:67], 0
    buffer_load_dwordx4 v28, s[32:35], s51 offen offset:0 nt lds
    s_barrier
    v_mfma_f32_16x16x32_bf16 v[76:79], v[196:199], v[32:35], 0
    ds_read_b128 v[192:195], v13 offset:0
    v_cvt_pk_bf16_f32 v163, v166, v167
    v_mfma_f32_16x16x32_bf16 v[84:87], v[196:199], v[40:43], 0
    ds_write_b128 v17, v[96:99] offset:44032
    v_mfma_f32_16x16x32_bf16 v[92:95], v[196:199], v[48:51], 0
    v_mfma_f32_16x16x32_bf16 v[100:103], v[196:199], v[56:59], 0
    ds_write_b128 v17, v[104:107] offset:45056
    v_mfma_f32_16x16x32_bf16 v[108:111], v[196:199], v[64:67], 0
    s_waitcnt lgkmcnt(8)
    v_cvt_pk_bf16_f32 v168, v168, v169
    v_cvt_pk_bf16_f32 v169, v170, v171
    v_cvt_pk_bf16_f32 v170, v172, v173
    v_cvt_pk_bf16_f32 v171, v174, v175
    v_mfma_f32_16x16x32_bf16 v[36:39], v[200:203], v[72:75], v[36:39]
    buffer_load_dwordx4 v29, s[32:35], s51 offen offset:1056 nt lds
    v_mfma_f32_16x16x32_bf16 v[44:47], v[200:203], v[80:83], v[44:47]
    ds_read_b128 v[196:199], v13 offset:8448
    v_cvt_pk_bf16_f32 v176, v176, v177
    v_mfma_f32_16x16x32_bf16 v[52:55], v[200:203], v[88:91], v[52:55]
    v_cvt_pk_bf16_f32 v177, v178, v179
    v_cvt_pk_bf16_f32 v178, v180, v181
    v_cvt_pk_bf16_f32 v179, v182, v183
    v_mfma_f32_16x16x32_bf16 v[60:63], v[200:203], v[96:99], v[60:63]
    ds_write_b128 v17, v[112:115] offset:0
    v_mfma_f32_16x16x32_bf16 v[68:71], v[200:203], v[104:107], v[68:71]
    v_mfma_f32_16x16x32_bf16 v[76:79], v[204:207], v[72:75], v[76:79]
    ds_write_b128 v17, v[120:123] offset:1024
    v_cvt_pk_bf16_f32 v184, v184, v185
    v_cvt_pk_bf16_f32 v185, v186, v187
    v_cvt_pk_bf16_f32 v186, v188, v189
    v_cvt_pk_bf16_f32 v187, v190, v191
    v_mfma_f32_16x16x32_bf16 v[84:87], v[204:207], v[80:83], v[84:87]
    buffer_load_dwordx4 v30, s[32:35], s51 offen offset:2112 nt lds
    v_mfma_f32_16x16x32_bf16 v[92:95], v[204:207], v[88:91], v[92:95]
    v_mfma_f32_16x16x32_bf16 v[100:103], v[204:207], v[96:99], v[100:103]
    ds_write_b128 v17, v[128:131] offset:2048
    v_mfma_f32_16x16x32_bf16 v[108:111], v[204:207], v[104:107], v[108:111]
    s_waitcnt lgkmcnt(10)
    ds_read_b128 v[200:203], v13 offset:64
    v_mfma_f32_16x16x32_bf16 v[36:39], v[208:211], v[112:115], v[36:39]
    v_mfma_f32_16x16x32_bf16 v[44:47], v[208:211], v[120:123], v[44:47]
    ds_write_b128 v17, v[136:139] offset:3072
    v_mfma_f32_16x16x32_bf16 v[52:55], v[208:211], v[128:131], v[52:55]
    buffer_load_dwordx4 v31, s[32:35], s51 offen offset:3168 nt lds
    v_mfma_f32_16x16x32_bf16 v[60:63], v[208:211], v[136:139], v[60:63]
    v_mfma_f32_16x16x32_bf16 v[68:71], v[208:211], v[144:147], v[68:71]
    ds_write_b128 v17, v[144:147] offset:4096
    v_mfma_f32_16x16x32_bf16 v[76:79], v[212:215], v[112:115], v[76:79]
    v_mfma_f32_16x16x32_bf16 v[84:87], v[212:215], v[120:123], v[84:87]
    ds_write_b128 v17, v[152:155] offset:20480
    v_mfma_f32_16x16x32_bf16 v[92:95], v[212:215], v[128:131], v[92:95]
    v_mfma_f32_16x16x32_bf16 v[100:103], v[212:215], v[136:139], v[100:103]
    ds_write_b128 v17, v[160:163] offset:21504
    v_mfma_f32_16x16x32_bf16 v[108:111], v[212:215], v[144:147], v[108:111]
    s_waitcnt lgkmcnt(12)
    v_mfma_f32_16x16x32_bf16 v[36:39], v[216:219], v[152:155], v[36:39]
    ds_write_b128 v17, v[168:171] offset:22528
    v_mfma_f32_16x16x32_bf16 v[44:47], v[216:219], v[160:163], v[44:47]
    ds_read_b128 v[204:207], v13 offset:8512
    v_mfma_f32_16x16x32_bf16 v[52:55], v[216:219], v[168:171], v[52:55]
    ds_write_b128 v17, v[176:179] offset:23552
    v_mfma_f32_16x16x32_bf16 v[60:63], v[216:219], v[176:179], v[60:63]
    ds_write_b128 v17, v[184:187] offset:24576
    v_mfma_f32_16x16x32_bf16 v[68:71], v[216:219], v[184:187], v[68:71]
    ds_read_b128 v[208:211], v13 offset:128
    s_waitcnt lgkmcnt(1)
    s_barrier
    v_mfma_f32_16x16x32_bf16 v[76:79], v[220:223], v[152:155], v[76:79]
    ds_read_b128 a[180:183], v252 offset:40960
    v_mfma_f32_16x16x32_bf16 v[84:87], v[220:223], v[160:163], v[84:87]
    ds_read_b128 a[184:187], v252 offset:41984
    v_mfma_f32_16x16x32_bf16 v[92:95], v[220:223], v[168:171], v[92:95]
    ds_read_b128 a[188:191], v252 offset:43008
    v_mfma_f32_16x16x32_bf16 v[100:103], v[220:223], v[176:179], v[100:103]
    ds_read_b128 a[192:195], v252 offset:44032
    v_mfma_f32_16x16x32_bf16 v[108:111], v[220:223], v[184:187], v[108:111]
    ds_read_b128 a[196:199], v252 offset:45056
    v_mfma_f32_16x16x32_bf16 v[36:39], v[192:195], a[160:163], v[36:39]
    ds_read_b128 v[212:215], v13 offset:8576
    v_mfma_f32_16x16x32_bf16 v[44:47], v[192:195], a[164:167], v[44:47]
    ds_read_b128 v[216:219], v13 offset:192
    v_mfma_f32_16x16x32_bf16 v[52:55], v[192:195], a[168:171], v[52:55]
    ds_read_b128 v[220:223], v13 offset:8640
    v_mfma_f32_16x16x32_bf16 v[60:63], v[192:195], a[172:175], v[60:63]
    ds_read_b128 a[200:203], v252 offset:0
    v_mfma_f32_16x16x32_bf16 v[68:71], v[192:195], a[176:179], v[68:71]
    ds_read_b128 a[204:207], v252 offset:1024
    v_mfma_f32_16x16x32_bf16 v[76:79], v[196:199], a[160:163], v[76:79]
    ds_read_b128 a[208:211], v252 offset:2048
    v_mfma_f32_16x16x32_bf16 v[84:87], v[196:199], a[164:167], v[84:87]
    ds_read_b128 a[212:215], v252 offset:3072
    v_mfma_f32_16x16x32_bf16 v[92:95], v[196:199], a[168:171], v[92:95]
    ds_read_b128 a[216:219], v252 offset:4096
    v_mfma_f32_16x16x32_bf16 v[100:103], v[196:199], a[172:175], v[100:103]
    ds_read_b128 a[220:223], v252 offset:20480
    v_mfma_f32_16x16x32_bf16 v[108:111], v[196:199], a[176:179], v[108:111]
    s_waitcnt lgkmcnt(9)
    ds_read_b128 a[224:227], v252 offset:21504
    v_mfma_f32_16x16x32_bf16 v[36:39], v[200:203], a[180:183], v[36:39]
    ds_read_b128 a[228:231], v252 offset:22528
    v_mfma_f32_16x16x32_bf16 v[44:47], v[200:203], a[184:187], v[44:47]
    ds_read_b128 a[232:235], v252 offset:23552
    v_mfma_f32_16x16x32_bf16 v[52:55], v[200:203], a[188:191], v[52:55]
    ds_read_b128 a[236:239], v252 offset:24576
    v_mfma_f32_16x16x32_bf16 v[60:63], v[200:203], a[192:195], v[60:63]
    v_mfma_f32_16x16x32_bf16 v[68:71], v[200:203], a[196:199], v[68:71]
    v_mfma_f32_16x16x32_bf16 v[76:79], v[204:207], a[180:183], v[76:79]
    v_mfma_f32_16x16x32_bf16 v[84:87], v[204:207], a[184:187], v[84:87]
    v_mfma_f32_16x16x32_bf16 v[92:95], v[204:207], a[188:191], v[92:95]
    v_mfma_f32_16x16x32_bf16 v[100:103], v[204:207], a[192:195], v[100:103]
    v_mfma_f32_16x16x32_bf16 v[108:111], v[204:207], a[196:199], v[108:111]
    s_waitcnt vmcnt(8) lgkmcnt(0)
    s_waitcnt vmcnt(3)
    s_barrier
    v_mfma_f32_16x16x32_bf16 v[36:39], v[208:211], a[200:203], v[36:39]
    s_mov_b32 s51, 98304
    s_add_u32 m0, s49, 33792
    v_add_u32 v12, 67584, v7
    v_mfma_f32_16x16x32_bf16 v[44:47], v[208:211], a[204:207], v[44:47]
    buffer_load_dwordx4 v28, s[32:35], s51 offen offset:0 nt lds
    v_mfma_f32_16x16x32_bf16 v[52:55], v[208:211], a[208:211], v[52:55]
    v_add_u32 v13, 67584, v8
    v_mfma_f32_16x16x32_bf16 v[60:63], v[208:211], a[212:215], v[60:63]
    ds_read_b128 v[192:195], v12 offset:0
    v_mfma_f32_16x16x32_bf16 v[68:71], v[208:211], a[216:219], v[68:71]
    ds_read_b128 v[196:199], v12 offset:8448
    v_mfma_f32_16x16x32_bf16 v[76:79], v[212:215], a[200:203], v[76:79]
    ds_read_b128 v[200:203], v12 offset:64
    v_mfma_f32_16x16x32_bf16 v[84:87], v[212:215], a[204:207], v[84:87]
    buffer_load_dwordx4 v29, s[32:35], s51 offen offset:1056 nt lds
    v_mfma_f32_16x16x32_bf16 v[92:95], v[212:215], a[208:211], v[92:95]
    ds_read_b128 v[204:207], v12 offset:8512
    v_mfma_f32_16x16x32_bf16 v[100:103], v[212:215], a[212:215], v[100:103]
    ds_read_b128 v[208:211], v12 offset:128
    v_mfma_f32_16x16x32_bf16 v[108:111], v[212:215], a[216:219], v[108:111]
    v_mfma_f32_16x16x32_bf16 v[36:39], v[216:219], a[220:223], v[36:39]
    ds_read_b128 v[212:215], v12 offset:8576
    v_mfma_f32_16x16x32_bf16 v[44:47], v[216:219], a[224:227], v[44:47]
    v_mfma_f32_16x16x32_bf16 v[52:55], v[216:219], a[228:231], v[52:55]
    buffer_load_dwordx4 v30, s[32:35], s51 offen offset:2112 nt lds
    v_mfma_f32_16x16x32_bf16 v[60:63], v[216:219], a[232:235], v[60:63]
    v_mfma_f32_16x16x32_bf16 v[68:71], v[216:219], a[236:239], v[68:71]
    v_mfma_f32_16x16x32_bf16 v[76:79], v[220:223], a[220:223], v[76:79]
    ds_read_b128 v[216:219], v12 offset:192
    v_mfma_f32_16x16x32_bf16 v[84:87], v[220:223], a[224:227], v[84:87]
    v_mfma_f32_16x16x32_bf16 v[92:95], v[220:223], a[228:231], v[92:95]
    v_mfma_f32_16x16x32_bf16 v[100:103], v[220:223], a[232:235], v[100:103]
    buffer_load_dwordx4 v31, s[32:35], s51 offen offset:3168 nt lds
    v_mfma_f32_16x16x32_bf16 v[108:111], v[220:223], a[236:239], v[108:111]
    s_waitcnt lgkmcnt(5)
    v_mfma_f32_16x16x32_bf16 v[116:119], v[192:195], v[32:35], 0
    ds_read_b128 v[220:223], v12 offset:8640
    v_mfma_f32_16x16x32_bf16 v[124:127], v[192:195], v[40:43], 0
    v_mfma_f32_16x16x32_bf16 v[132:135], v[192:195], v[48:51], 0
    s_add_u32 s51, s51, 4096
    s_add_u32 m0, s49, 38016
    v_mfma_f32_16x16x32_bf16 v[140:143], v[192:195], v[56:59], 0
    v_max3_f32 v23, v23, v36, v37
    v_max3_f32 v23, v23, v38, v39
    v_max3_f32 v24, v24, v44, v45
    v_mfma_f32_16x16x32_bf16 v[148:151], v[192:195], v[64:67], 0
    buffer_load_dwordx4 v28, s[32:35], s51 offen offset:0 nt lds
    v_max3_f32 v24, v24, v46, v47
    v_mfma_f32_16x16x32_bf16 v[156:159], v[196:199], v[32:35], 0
    ds_read_b128 v[192:195], v13 offset:0
    v_max3_f32 v25, v25, v52, v53
    v_max3_f32 v25, v25, v54, v55
    v_mfma_f32_16x16x32_bf16 v[164:167], v[196:199], v[40:43], 0
    v_max3_f32 v26, v26, v60, v61
    v_max3_f32 v26, v26, v62, v63
    v_max3_f32 v27, v27, v68, v69
    v_mfma_f32_16x16x32_bf16 v[172:175], v[196:199], v[48:51], 0
    v_max3_f32 v27, v27, v70, v71
    v_max3_f32 v23, v23, v76, v77
    v_max3_f32 v23, v23, v78, v79
    v_mfma_f32_16x16x32_bf16 v[180:183], v[196:199], v[56:59], 0
    v_max3_f32 v24, v24, v84, v85
    v_max3_f32 v24, v24, v86, v87
    v_max3_f32 v25, v25, v92, v93
    v_mfma_f32_16x16x32_bf16 v[188:191], v[196:199], v[64:67], 0
    s_waitcnt lgkmcnt(5)
    v_max3_f32 v25, v25, v94, v95
    v_max3_f32 v26, v26, v100, v101
    v_max3_f32 v26, v26, v102, v103
    v_mfma_f32_16x16x32_bf16 v[116:119], v[200:203], v[72:75], v[116:119]
    buffer_load_dwordx4 v29, s[32:35], s51 offen offset:1056 nt lds
    v_max3_f32 v27, v27, v108, v109
    v_mfma_f32_16x16x32_bf16 v[124:127], v[200:203], v[80:83], v[124:127]
    ds_read_b128 v[196:199], v13 offset:8448
    v_max3_f32 v27, v27, v110, v111
    ds_write_b32 v21, v23 offset:0
    v_mfma_f32_16x16x32_bf16 v[132:135], v[200:203], v[88:91], v[132:135]
    ds_write_b32 v21, v24 offset:512
    ds_write_b32 v21, v25 offset:1024
    v_mfma_f32_16x16x32_bf16 v[140:143], v[200:203], v[96:99], v[140:143]
    ds_write_b32 v21, v26 offset:1536
    ds_write_b32 v21, v27 offset:2048
    v_mfma_f32_16x16x32_bf16 v[148:151], v[200:203], v[104:107], v[148:151]
    s_waitcnt lgkmcnt(0)
    s_barrier
    v_mfma_f32_16x16x32_bf16 v[156:159], v[204:207], v[72:75], v[156:159]
    ds_read_b128 v[232:235], v22 offset:0
    ds_read_b128 v[236:239], v22 offset:16
    v_mfma_f32_16x16x32_bf16 v[164:167], v[204:207], v[80:83], v[164:167]
    buffer_load_dwordx4 v30, s[32:35], s51 offen offset:2112 nt lds
    v_mfma_f32_16x16x32_bf16 v[172:175], v[204:207], v[88:91], v[172:175]
    ds_read_b128 v[224:227], v22 offset:512
    ds_read_b128 v[228:231], v22 offset:528
    v_mfma_f32_16x16x32_bf16 v[180:183], v[204:207], v[96:99], v[180:183]
    s_waitcnt lgkmcnt(2)
    v_max3_f32 v232, v232, v233, v234
    v_max3_f32 v235, v235, v236, v237
    v_max3_f32 v232, v232, v238, v239
    v_mfma_f32_16x16x32_bf16 v[188:191], v[204:207], v[104:107], v[188:191]
    v_max_f32 v232, v232, v235
    v_mul_f32 v240, -v232, s60
    v_mfma_f32_16x16x32_bf16 v[116:119], v[208:211], v[112:115], v[116:119]
    ds_read_b128 v[232:235], v22 offset:1024
    ds_read_b128 v[236:239], v22 offset:1040
    v_mfma_f32_16x16x32_bf16 v[124:127], v[208:211], v[120:123], v[124:127]
    s_waitcnt lgkmcnt(2)
    v_max3_f32 v224, v224, v225, v226
    v_max3_f32 v227, v227, v228, v229
    v_mfma_f32_16x16x32_bf16 v[132:135], v[208:211], v[128:131], v[132:135]
    buffer_load_dwordx4 v31, s[32:35], s51 offen offset:3168 nt lds
    v_max3_f32 v224, v224, v230, v231
    v_mfma_f32_16x16x32_bf16 v[140:143], v[208:211], v[136:139], v[140:143]
    ds_read_b128 v[200:203], v13 offset:64
    v_max_f32 v224, v224, v227
    v_mul_f32 v241, -v224, s60
    v_mfma_f32_16x16x32_bf16 v[148:151], v[208:211], v[144:147], v[148:151]
    ds_read_b128 v[224:227], v22 offset:1536
    v_mfma_f32_16x16x32_bf16 v[156:159], v[212:215], v[112:115], v[156:159]
    ds_read_b128 v[228:231], v22 offset:1552
    s_waitcnt lgkmcnt(3)
    v_max3_f32 v232, v232, v233, v234
    v_mfma_f32_16x16x32_bf16 v[164:167], v[212:215], v[120:123], v[164:167]
    ds_read_b128 v[204:207], v13 offset:8512
    v_max3_f32 v235, v235, v236, v237
    v_max3_f32 v232, v232, v238, v239
    v_mfma_f32_16x16x32_bf16 v[172:175], v[212:215], v[128:131], v[172:175]
    ds_read_b128 v[208:211], v13 offset:128
    v_max_f32 v232, v232, v235
    v_mfma_f32_16x16x32_bf16 v[180:183], v[212:215], v[136:139], v[180:183]
    v_mul_f32 v242, -v232, s60
    ds_read_b128 v[232:235], v22 offset:2048
    v_mfma_f32_16x16x32_bf16 v[188:191], v[212:215], v[144:147], v[188:191]
    ds_read_b128 v[236:239], v22 offset:2064
    s_waitcnt lgkmcnt(4)
    v_mfma_f32_16x16x32_bf16 v[116:119], v[216:219], v[152:155], v[116:119]
    ds_read_b128 v[212:215], v13 offset:8576
    v_max3_f32 v224, v224, v225, v226
    v_mfma_f32_16x16x32_bf16 v[124:127], v[216:219], v[160:163], v[124:127]
    v_max3_f32 v227, v227, v228, v229
    v_max3_f32 v224, v224, v230, v231
    v_max_f32 v224, v224, v227
    v_mfma_f32_16x16x32_bf16 v[132:135], v[216:219], v[168:171], v[132:135]
    v_mul_f32 v243, -v224, s60
    s_waitcnt lgkmcnt(1)
    v_max3_f32 v232, v232, v233, v234
    v_mfma_f32_16x16x32_bf16 v[140:143], v[216:219], v[176:179], v[140:143]
    v_max3_f32 v235, v235, v236, v237
    v_max3_f32 v232, v232, v238, v239
    v_max_f32 v232, v232, v235
    v_mfma_f32_16x16x32_bf16 v[148:151], v[216:219], v[184:187], v[148:151]
    v_mul_f32 v244, -v232, s60
    v_fma_f32 v36, v36, s60, v240
    v_mfma_f32_16x16x32_bf16 v[156:159], v[220:223], v[152:155], v[156:159]
    ds_read_b128 v[216:219], v13 offset:192
    v_fma_f32 v37, v37, s60, v240
    v_fma_f32 v38, v38, s60, v240
    v_mfma_f32_16x16x32_bf16 v[164:167], v[220:223], v[160:163], v[164:167]
    v_fma_f32 v39, v39, s60, v240
    v_exp_f32 v36, v36
    v_mfma_f32_16x16x32_bf16 v[172:175], v[220:223], v[168:171], v[172:175]
    v_exp_f32 v37, v37
    v_mfma_f32_16x16x32_bf16 v[180:183], v[220:223], v[176:179], v[180:183]
    v_exp_f32 v38, v38
    v_mfma_f32_16x16x32_bf16 v[188:191], v[220:223], v[184:187], v[188:191]
    v_exp_f32 v39, v39
    v_cvt_pk_bf16_f32 v224, v36, v37
    v_cvt_pk_bf16_f32 v225, v38, v39
    v_mfma_f32_16x16x32_bf16 v[116:119], v[192:195], a[160:163], v[116:119]
    ds_read_b128 v[220:223], v13 offset:8640
    v_mfma_f32_16x16x32_bf16 v[124:127], v[192:195], a[164:167], v[124:127]
    ds_write_b64 v17, v[224:225] offset:0
    v_fma_f32 v76, v76, s60, v240
    v_mfma_f32_16x16x32_bf16 v[132:135], v[192:195], a[168:171], v[132:135]
    v_fma_f32 v77, v77, s60, v240
    v_fma_f32 v78, v78, s60, v240
    v_fma_f32 v79, v79, s60, v240
    v_mfma_f32_16x16x32_bf16 v[140:143], v[192:195], a[172:175], v[140:143]
    v_exp_f32 v76, v76
    v_mfma_f32_16x16x32_bf16 v[148:151], v[192:195], a[176:179], v[148:151]
    v_exp_f32 v77, v77
    v_mfma_f32_16x16x32_bf16 v[156:159], v[196:199], a[160:163], v[156:159]
    v_exp_f32 v78, v78
    v_exp_f32 v79, v79
    v_mfma_f32_16x16x32_bf16 v[164:167], v[196:199], a[164:167], v[164:167]
    v_cvt_pk_bf16_f32 v226, v76, v77
    v_cvt_pk_bf16_f32 v227, v78, v79
    v_mfma_f32_16x16x32_bf16 v[172:175], v[196:199], a[168:171], v[172:175]
    ds_write_b64 v17, v[226:227] offset:8
    v_fma_f32 v44, v44, s60, v241
    v_mfma_f32_16x16x32_bf16 v[180:183], v[196:199], a[172:175], v[180:183]
    v_fma_f32 v45, v45, s60, v241
    v_fma_f32 v46, v46, s60, v241
    v_mfma_f32_16x16x32_bf16 v[188:191], v[196:199], a[176:179], v[188:191]
    v_mfma_f32_16x16x32_bf16 a[140:143], a[240:243], v[224:227], 0
    v_fma_f32 v47, v47, s60, v241
    v_exp_f32 v44, v44
    v_mfma_f32_16x16x32_bf16 v[116:119], v[200:203], a[180:183], v[116:119]
    v_exp_f32 v45, v45
    v_exp_f32 v46, v46
    v_mfma_f32_16x16x32_bf16 v[124:127], v[200:203], a[184:187], v[124:127]
    v_exp_f32 v47, v47
    v_cvt_pk_bf16_f32 v228, v44, v45
    v_mfma_f32_16x16x32_bf16 v[132:135], v[200:203], a[188:191], v[132:135]
    v_cvt_pk_bf16_f32 v229, v46, v47
    v_mfma_f32_16x16x32_bf16 v[140:143], v[200:203], a[192:195], v[140:143]
    ds_write_b64 v17, v[228:229] offset:1024
    v_fma_f32 v84, v84, s60, v241
    v_mfma_f32_16x16x32_bf16 v[148:151], v[200:203], a[196:199], v[148:151]
    v_fma_f32 v85, v85, s60, v241
    v_fma_f32 v86, v86, s60, v241
    v_fma_f32 v87, v87, s60, v241
    v_mfma_f32_16x16x32_bf16 v[156:159], v[204:207], a[180:183], v[156:159]
    v_exp_f32 v84, v84
    v_mfma_f32_16x16x32_bf16 v[164:167], v[204:207], a[184:187], v[164:167]
    v_exp_f32 v85, v85
    v_exp_f32 v86, v86
    v_mfma_f32_16x16x32_bf16 v[172:175], v[204:207], a[188:191], v[172:175]
    v_exp_f32 v87, v87
    v_cvt_pk_bf16_f32 v230, v84, v85
    v_mfma_f32_16x16x32_bf16 v[180:183], v[204:207], a[192:195], v[180:183]
    v_cvt_pk_bf16_f32 v231, v86, v87
    v_mfma_f32_16x16x32_bf16 v[188:191], v[204:207], a[196:199], v[188:191]
    ds_write_b64 v17, v[230:231] offset:1032
    s_waitcnt vmcnt(8) lgkmcnt(0)
    s_waitcnt vmcnt(3)
    s_barrier
    v_mfma_f32_16x16x32_bf16 v[116:119], v[208:211], a[200:203], v[116:119]
    s_mov_b32 s51, 131072
    v_add_u32 v12, 0, v7
    v_add_u32 v13, 0, v8
    v_fma_f32 v52, v52, s60, v242
    v_fma_f32 v53, v53, s60, v242
    v_fma_f32 v54, v54, s60, v242
    v_mfma_f32_16x16x32_bf16 v[124:127], v[208:211], a[204:207], v[124:127]
    s_add_u32 m0, s49, 67584
    s_nop 0
    buffer_load_dwordx4 v28, s[32:35], s51 offen offset:0 nt lds
    v_mfma_f32_16x16x32_bf16 a[144:147], a[240:243], v[228:231], 0
    ds_read_b128 v[192:195], v12 offset:0
    v_fma_f32 v55, v55, s60, v242
    v_mfma_f32_16x16x32_bf16 v[132:135], v[208:211], a[208:211], v[132:135]
    ds_read_b128 v[196:199], v12 offset:8448
    v_exp_f32 v52, v52
    v_exp_f32 v53, v53
    v_mfma_f32_16x16x32_bf16 v[140:143], v[208:211], a[212:215], v[140:143]
    ds_read_b128 v[200:203], v12 offset:64
    v_exp_f32 v54, v54
    v_mfma_f32_16x16x32_bf16 v[148:151], v[208:211], a[216:219], v[148:151]
    ds_read_b128 v[204:207], v12 offset:8512
    v_exp_f32 v55, v55
    v_mfma_f32_16x16x32_bf16 v[156:159], v[212:215], a[200:203], v[156:159]
    ds_read_b128 v[208:211], v12 offset:128
    v_cvt_pk_bf16_f32 v224, v52, v53
    v_cvt_pk_bf16_f32 v225, v54, v55
    v_mfma_f32_16x16x32_bf16 v[164:167], v[212:215], a[204:207], v[164:167]
    buffer_load_dwordx4 v29, s[32:35], s51 offen offset:1056 nt lds
    v_mfma_f32_16x16x32_bf16 v[172:175], v[212:215], a[208:211], v[172:175]
    ds_write_b64 v17, v[224:225] offset:2048
    v_fma_f32 v92, v92, s60, v242
    v_fma_f32 v93, v93, s60, v242
    v_fma_f32 v94, v94, s60, v242
    v_mfma_f32_16x16x32_bf16 v[180:183], v[212:215], a[212:215], v[180:183]
    v_fma_f32 v95, v95, s60, v242
    v_exp_f32 v92, v92
    v_mfma_f32_16x16x32_bf16 v[188:191], v[212:215], a[216:219], v[188:191]
    v_exp_f32 v93, v93
    v_exp_f32 v94, v94
    v_mfma_f32_16x16x32_bf16 v[116:119], v[216:219], a[220:223], v[116:119]
    ds_read_b128 v[212:215], v12 offset:8576
    v_exp_f32 v95, v95
    v_mfma_f32_16x16x32_bf16 v[124:127], v[216:219], a[224:227], v[124:127]
    v_cvt_pk_bf16_f32 v226, v92, v93
    v_cvt_pk_bf16_f32 v227, v94, v95
    v_mfma_f32_16x16x32_bf16 v[132:135], v[216:219], a[228:231], v[132:135]
    buffer_load_dwordx4 v30, s[32:35], s51 offen offset:2112 nt lds
    ds_write_b64 v17, v[226:227] offset:2056
    v_mfma_f32_16x16x32_bf16 v[140:143], v[216:219], a[232:235], v[140:143]
    v_fma_f32 v60, v60, s60, v243
    v_fma_f32 v61, v61, s60, v243
    v_fma_f32 v62, v62, s60, v243
    v_mfma_f32_16x16x32_bf16 v[148:151], v[216:219], a[236:239], v[148:151]
    v_mfma_f32_16x16x32_bf16 a[148:151], a[240:243], v[224:227], 0
    v_fma_f32 v63, v63, s60, v243
    v_exp_f32 v60, v60
    v_exp_f32 v61, v61
    v_exp_f32 v62, v62
    v_mfma_f32_16x16x32_bf16 v[156:159], v[220:223], a[220:223], v[156:159]
    ds_read_b128 v[216:219], v12 offset:192
    v_exp_f32 v63, v63
    v_cvt_pk_bf16_f32 v228, v60, v61
    v_mfma_f32_16x16x32_bf16 v[164:167], v[220:223], a[224:227], v[164:167]
    v_cvt_pk_bf16_f32 v229, v62, v63
    v_mfma_f32_16x16x32_bf16 v[172:175], v[220:223], a[228:231], v[172:175]
    ds_write_b64 v17, v[228:229] offset:3072
    v_fma_f32 v100, v100, s60, v243
    v_fma_f32 v101, v101, s60, v243
    v_fma_f32 v102, v102, s60, v243
    v_fma_f32 v103, v103, s60, v243
    v_mfma_f32_16x16x32_bf16 v[180:183], v[220:223], a[232:235], v[180:183]
    buffer_load_dwordx4 v31, s[32:35], s51 offen offset:3168 nt lds
    v_exp_f32 v100, v100
    v_mfma_f32_16x16x32_bf16 v[188:191], v[220:223], a[236:239], v[188:191]
    s_waitcnt lgkmcnt(8)
    v_exp_f32 v101, v101
    v_exp_f32 v102, v102
    v_mfma_f32_16x16x32_bf16 v[36:39], v[192:195], v[32:35], 0
    ds_read_b128 v[220:223], v12 offset:8640
    v_exp_f32 v103, v103
    v_cvt_pk_bf16_f32 v230, v100, v101
    v_cvt_pk_bf16_f32 v231, v102, v103
    v_mfma_f32_16x16x32_bf16 v[44:47], v[192:195], v[40:43], 0
    ds_write_b64 v17, v[230:231] offset:3080
    v_fma_f32 v68, v68, s60, v244
    v_fma_f32 v69, v69, s60, v244
    v_fma_f32 v70, v70, s60, v244
    v_mfma_f32_16x16x32_bf16 v[52:55], v[192:195], v[48:51], 0
    s_add_u32 s51, s51, 4096
    s_add_u32 m0, s49, 71808
    v_mfma_f32_16x16x32_bf16 a[152:155], a[240:243], v[228:231], 0
    v_fma_f32 v71, v71, s60, v244
    v_exp_f32 v68, v68
    v_exp_f32 v69, v69
    v_exp_f32 v70, v70
    v_exp_f32 v71, v71
    v_cvt_pk_bf16_f32 v224, v68, v69
    v_cvt_pk_bf16_f32 v225, v70, v71
    v_mfma_f32_16x16x32_bf16 v[60:63], v[192:195], v[56:59], 0
    ds_write_b64 v17, v[224:225] offset:4096
    v_fma_f32 v108, v108, s60, v244
    v_fma_f32 v109, v109, s60, v244
    v_fma_f32 v110, v110, s60, v244
    v_fma_f32 v111, v111, s60, v244
    v_mfma_f32_16x16x32_bf16 v[68:71], v[192:195], v[64:67], 0
    buffer_load_dwordx4 v28, s[32:35], s51 offen offset:0 nt lds
    v_mfma_f32_16x16x32_bf16 v[76:79], v[196:199], v[32:35], 0
    ds_read_b128 v[192:195], v13 offset:0
    v_exp_f32 v108, v108
    v_mfma_f32_16x16x32_bf16 v[84:87], v[196:199], v[40:43], 0
    v_exp_f32 v109, v109
    v_exp_f32 v110, v110
    v_mfma_f32_16x16x32_bf16 v[92:95], v[196:199], v[48:51], 0
    v_exp_f32 v111, v111
    v_cvt_pk_bf16_f32 v226, v108, v109
    v_cvt_pk_bf16_f32 v227, v110, v111
    v_mfma_f32_16x16x32_bf16 v[100:103], v[196:199], v[56:59], 0
    ds_write_b64 v17, v[226:227] offset:4104
    v_mfma_f32_16x16x32_bf16 v[108:111], v[196:199], v[64:67], 0
    s_waitcnt lgkmcnt(11)
    s_nop 0
    v_mfma_f32_16x16x32_bf16 v[36:39], v[200:203], v[72:75], v[36:39]
    buffer_load_dwordx4 v29, s[32:35], s51 offen offset:1056 nt lds
    v_mfma_f32_16x16x32_bf16 a[156:159], a[240:243], v[224:227], 0
    ds_read_b128 v[196:199], v13 offset:8448
    v_max3_f32 v23, v23, v116, v117
    v_mfma_f32_16x16x32_bf16 v[44:47], v[200:203], v[80:83], v[44:47]
    v_max3_f32 v23, v23, v118, v119
    v_fma_f32 v116, v116, s60, v240
    v_mfma_f32_16x16x32_bf16 v[52:55], v[200:203], v[88:91], v[52:55]
    v_fma_f32 v117, v117, s60, v240
    v_fma_f32 v118, v118, s60, v240
    v_fma_f32 v119, v119, s60, v240
    v_mfma_f32_16x16x32_bf16 v[60:63], v[200:203], v[96:99], v[60:63]
    v_exp_f32 v116, v116
    v_mfma_f32_16x16x32_bf16 v[68:71], v[200:203], v[104:107], v[68:71]
    v_exp_f32 v117, v117
    v_mfma_f32_16x16x32_bf16 v[76:79], v[204:207], v[72:75], v[76:79]
    ds_read_b128 v[200:203], v13 offset:64
    v_mfma_f32_16x16x32_bf16 v[84:87], v[204:207], v[80:83], v[84:87]
    buffer_load_dwordx4 v30, s[32:35], s51 offen offset:2112 nt lds
    v_mfma_f32_16x16x32_bf16 v[92:95], v[204:207], v[88:91], v[92:95]
    v_exp_f32 v118, v118
    v_mfma_f32_16x16x32_bf16 v[100:103], v[204:207], v[96:99], v[100:103]
    v_exp_f32 v119, v119
    v_cvt_pk_bf16_f32 v224, v116, v117
    v_mfma_f32_16x16x32_bf16 v[108:111], v[204:207], v[104:107], v[108:111]
    s_waitcnt lgkmcnt(10)
    v_cvt_pk_bf16_f32 v225, v118, v119
    v_mfma_f32_16x16x32_bf16 v[36:39], v[208:211], v[112:115], v[36:39]
    ds_read_b128 v[204:207], v13 offset:8512
    v_mfma_f32_16x16x32_bf16 v[44:47], v[208:211], v[120:123], v[44:47]
    ds_write_b64 v17, v[224:225] offset:20480
    v_mfma_f32_16x16x32_bf16 v[52:55], v[208:211], v[128:131], v[52:55]
    buffer_load_dwordx4 v31, s[32:35], s51 offen offset:3168 nt lds
    v_mfma_f32_16x16x32_bf16 v[60:63], v[208:211], v[136:139], v[60:63]
    v_max3_f32 v23, v23, v156, v157
    v_max3_f32 v23, v23, v158, v159
    v_mfma_f32_16x16x32_bf16 v[68:71], v[208:211], v[144:147], v[68:71]
    v_fma_f32 v156, v156, s60, v240
    v_fma_f32 v157, v157, s60, v240
    v_fma_f32 v158, v158, s60, v240
    v_mfma_f32_16x16x32_bf16 v[76:79], v[212:215], v[112:115], v[76:79]
    ds_read_b128 v[208:211], v13 offset:128
    v_fma_f32 v159, v159, s60, v240
    v_mfma_f32_16x16x32_bf16 v[84:87], v[212:215], v[120:123], v[84:87]
    v_exp_f32 v156, v156
    v_mfma_f32_16x16x32_bf16 v[92:95], v[212:215], v[128:131], v[92:95]
    v_exp_f32 v157, v157
    v_mfma_f32_16x16x32_bf16 v[100:103], v[212:215], v[136:139], v[100:103]
    v_exp_f32 v158, v158
    v_mfma_f32_16x16x32_bf16 v[108:111], v[212:215], v[144:147], v[108:111]
    s_waitcnt lgkmcnt(9)
    v_exp_f32 v159, v159
    v_cvt_pk_bf16_f32 v226, v156, v157
    v_mfma_f32_16x16x32_bf16 v[36:39], v[216:219], v[152:155], v[36:39]
    ds_read_b128 v[212:215], v13 offset:8576
    v_cvt_pk_bf16_f32 v227, v158, v159
    v_mfma_f32_16x16x32_bf16 v[44:47], v[216:219], v[160:163], v[44:47]
    ds_write_b64 v17, v[226:227] offset:20488
    v_mfma_f32_16x16x32_bf16 v[52:55], v[216:219], v[168:171], v[52:55]
    v_max3_f32 v24, v24, v124, v125
    v_max3_f32 v24, v24, v126, v127
    v_fma_f32 v124, v124, s60, v241
    v_mfma_f32_16x16x32_bf16 v[60:63], v[216:219], v[176:179], v[60:63]
    v_mfma_f32_16x16x32_bf16 a[140:143], a[240:243], v[224:227], a[140:143]
    v_fma_f32 v125, v125, s60, v241
    v_fma_f32 v126, v126, s60, v241
    v_mfma_f32_16x16x32_bf16 v[68:71], v[216:219], v[184:187], v[68:71]
    v_fma_f32 v127, v127, s60, v241
    v_exp_f32 v124, v124
    v_mfma_f32_16x16x32_bf16 v[76:79], v[220:223], v[152:155], v[76:79]
    ds_read_b128 v[216:219], v13 offset:192
    v_mfma_f32_16x16x32_bf16 v[84:87], v[220:223], v[160:163], v[84:87]
    v_exp_f32 v125, v125
    v_mfma_f32_16x16x32_bf16 v[92:95], v[220:223], v[168:171], v[92:95]
    v_exp_f32 v126, v126
    v_mfma_f32_16x16x32_bf16 v[100:103], v[220:223], v[176:179], v[100:103]
    v_exp_f32 v127, v127
    v_cvt_pk_bf16_f32 v228, v124, v125
    v_cvt_pk_bf16_f32 v229, v126, v127
    v_mfma_f32_16x16x32_bf16 v[108:111], v[220:223], v[184:187], v[108:111]
    s_waitcnt lgkmcnt(7)
    v_mfma_f32_16x16x32_bf16 v[36:39], v[192:195], a[160:163], v[36:39]
    ds_read_b128 v[220:223], v13 offset:8640
    v_mfma_f32_16x16x32_bf16 v[44:47], v[192:195], a[164:167], v[44:47]
    ds_write_b64 v17, v[228:229] offset:21504
    v_mfma_f32_16x16x32_bf16 v[52:55], v[192:195], a[168:171], v[52:55]
    v_max3_f32 v24, v24, v164, v165
    v_max3_f32 v24, v24, v166, v167
    v_fma_f32 v164, v164, s60, v241
    v_mfma_f32_16x16x32_bf16 v[60:63], v[192:195], a[172:175], v[60:63]
    v_fma_f32 v165, v165, s60, v241
    v_fma_f32 v166, v166, s60, v241
    v_mfma_f32_16x16x32_bf16 v[68:71], v[192:195], a[176:179], v[68:71]
    v_fma_f32 v167, v167, s60, v241
    v_exp_f32 v164, v164
    v_mfma_f32_16x16x32_bf16 v[76:79], v[196:199], a[160:163], v[76:79]
    v_exp_f32 v165, v165
    v_mfma_f32_16x16x32_bf16 v[84:87], v[196:199], a[164:167], v[84:87]
    v_exp_f32 v166, v166
    v_mfma_f32_16x16x32_bf16 v[92:95], v[196:199], a[168:171], v[92:95]
    v_exp_f32 v167, v167
    v_cvt_pk_bf16_f32 v230, v164, v165
    v_mfma_f32_16x16x32_bf16 v[100:103], v[196:199], a[172:175], v[100:103]
    v_cvt_pk_bf16_f32 v231, v166, v167
    v_mfma_f32_16x16x32_bf16 v[108:111], v[196:199], a[176:179], v[108:111]
    s_waitcnt lgkmcnt(7)
    v_mfma_f32_16x16x32_bf16 v[36:39], v[200:203], a[180:183], v[36:39]
    ds_write_b64 v17, v[230:231] offset:21512
    v_max3_f32 v25, v25, v132, v133
    v_mfma_f32_16x16x32_bf16 v[44:47], v[200:203], a[184:187], v[44:47]
    v_max3_f32 v25, v25, v134, v135
    v_fma_f32 v132, v132, s60, v242
    v_mfma_f32_16x16x32_bf16 v[52:55], v[200:203], a[188:191], v[52:55]
    v_mfma_f32_16x16x32_bf16 a[144:147], a[240:243], v[228:231], a[144:147]
    v_fma_f32 v133, v133, s60, v242
    v_fma_f32 v134, v134, s60, v242
    v_fma_f32 v135, v135, s60, v242
    v_mfma_f32_16x16x32_bf16 v[60:63], v[200:203], a[192:195], v[60:63]
    v_exp_f32 v132, v132
    v_exp_f32 v133, v133
    v_mfma_f32_16x16x32_bf16 v[68:71], v[200:203], a[196:199], v[68:71]
    v_exp_f32 v134, v134
    v_mfma_f32_16x16x32_bf16 v[76:79], v[204:207], a[180:183], v[76:79]
    v_exp_f32 v135, v135
    v_cvt_pk_bf16_f32 v224, v132, v133
    v_mfma_f32_16x16x32_bf16 v[84:87], v[204:207], a[184:187], v[84:87]
    v_cvt_pk_bf16_f32 v225, v134, v135
    v_mfma_f32_16x16x32_bf16 v[92:95], v[204:207], a[188:191], v[92:95]
    ds_write_b64 v17, v[224:225] offset:22528
    v_mfma_f32_16x16x32_bf16 v[100:103], v[204:207], a[192:195], v[100:103]
    v_max3_f32 v25, v25, v172, v173
    v_max3_f32 v25, v25, v174, v175
    v_fma_f32 v172, v172, s60, v242
    v_mfma_f32_16x16x32_bf16 v[108:111], v[204:207], a[196:199], v[108:111]
    v_fma_f32 v173, v173, s60, v242
    v_fma_f32 v174, v174, s60, v242
    s_waitcnt vmcnt(8) lgkmcnt(0)
    s_waitcnt vmcnt(3)
    s_barrier
    v_mfma_f32_16x16x32_bf16 v[36:39], v[208:211], a[200:203], v[36:39]
    s_mov_b32 s51, 163840
    v_add_u32 v12, 33792, v7
    v_add_u32 v13, 33792, v8
    v_fma_f32 v175, v175, s60, v242
    s_add_u32 m0, s49, 0
    v_mfma_f32_16x16x32_bf16 v[44:47], v[208:211], a[204:207], v[44:47]
    buffer_load_dwordx4 v28, s[32:35], s51 offen offset:0 nt lds
    v_mfma_f32_16x16x32_bf16 v[52:55], v[208:211], a[208:211], v[52:55]
    ds_read_b128 v[192:195], v12 offset:0
    v_exp_f32 v172, v172
    v_mfma_f32_16x16x32_bf16 v[60:63], v[208:211], a[212:215], v[60:63]
    ds_read_b128 v[196:199], v12 offset:8448
    v_exp_f32 v173, v173
    v_exp_f32 v174, v174
    v_mfma_f32_16x16x32_bf16 v[68:71], v[208:211], a[216:219], v[68:71]
    ds_read_b128 v[200:203], v12 offset:64
    v_exp_f32 v175, v175
    v_mfma_f32_16x16x32_bf16 v[76:79], v[212:215], a[200:203], v[76:79]
    ds_read_b128 v[204:207], v12 offset:8512
    v_cvt_pk_bf16_f32 v226, v172, v173
    v_cvt_pk_bf16_f32 v227, v174, v175
    v_mfma_f32_16x16x32_bf16 v[84:87], v[212:215], a[204:207], v[84:87]
    buffer_load_dwordx4 v29, s[32:35], s51 offen offset:1056 nt lds
    v_mfma_f32_16x16x32_bf16 v[92:95], v[212:215], a[208:211], v[92:95]
    ds_write_b64 v17, v[226:227] offset:22536
    v_max3_f32 v26, v26, v140, v141
    v_mfma_f32_16x16x32_bf16 v[100:103], v[212:215], a[212:215], v[100:103]
    ds_read_b128 v[208:211], v12 offset:128
    v_max3_f32 v26, v26, v142, v143
    v_fma_f32 v140, v140, s60, v243
    v_mfma_f32_16x16x32_bf16 v[108:111], v[212:215], a[216:219], v[108:111]
    v_mfma_f32_16x16x32_bf16 a[148:151], a[240:243], v[224:227], a[148:151]
    v_fma_f32 v141, v141, s60, v243
    v_fma_f32 v142, v142, s60, v243
    v_fma_f32 v143, v143, s60, v243
    v_exp_f32 v140, v140
    v_mfma_f32_16x16x32_bf16 v[36:39], v[216:219], a[220:223], v[36:39]
    ds_read_b128 v[212:215], v12 offset:8576
    v_exp_f32 v141, v141
    v_mfma_f32_16x16x32_bf16 v[44:47], v[216:219], a[224:227], v[44:47]
    v_exp_f32 v142, v142
    v_mfma_f32_16x16x32_bf16 v[52:55], v[216:219], a[228:231], v[52:55]
    buffer_load_dwordx4 v30, s[32:35], s51 offen offset:2112 nt lds
    v_exp_f32 v143, v143
    v_cvt_pk_bf16_f32 v228, v140, v141
    v_mfma_f32_16x16x32_bf16 v[60:63], v[216:219], a[232:235], v[60:63]
    v_cvt_pk_bf16_f32 v229, v142, v143
    v_mfma_f32_16x16x32_bf16 v[68:71], v[216:219], a[236:239], v[68:71]
    ds_write_b64 v17, v[228:229] offset:23552
    v_max3_f32 v26, v26, v180, v181
    v_max3_f32 v26, v26, v182, v183
    v_mfma_f32_16x16x32_bf16 v[76:79], v[220:223], a[220:223], v[76:79]
    ds_read_b128 v[216:219], v12 offset:192
    v_fma_f32 v180, v180, s60, v243
    v_fma_f32 v181, v181, s60, v243
    v_fma_f32 v182, v182, s60, v243
    v_mfma_f32_16x16x32_bf16 v[84:87], v[220:223], a[224:227], v[84:87]
    v_fma_f32 v183, v183, s60, v243
    v_exp_f32 v180, v180
    v_mfma_f32_16x16x32_bf16 v[92:95], v[220:223], a[228:231], v[92:95]
    v_exp_f32 v181, v181
    v_exp_f32 v182, v182
    v_mfma_f32_16x16x32_bf16 v[100:103], v[220:223], a[232:235], v[100:103]
    buffer_load_dwordx4 v31, s[32:35], s51 offen offset:3168 nt lds
    v_exp_f32 v183, v183
    v_mfma_f32_16x16x32_bf16 v[108:111], v[220:223], a[236:239], v[108:111]
    s_waitcnt lgkmcnt(7)
    v_cvt_pk_bf16_f32 v230, v180, v181
    v_cvt_pk_bf16_f32 v231, v182, v183
    v_mfma_f32_16x16x32_bf16 v[116:119], v[192:195], v[32:35], 0
    ds_write_b64 v17, v[230:231] offset:23560
    v_max3_f32 v27, v27, v148, v149
    v_max3_f32 v27, v27, v150, v151
    v_fma_f32 v148, v148, s60, v244
    v_mfma_f32_16x16x32_bf16 v[124:127], v[192:195], v[40:43], 0
    ds_read_b128 v[220:223], v12 offset:8640
    v_mfma_f32_16x16x32_bf16 a[152:155], a[240:243], v[228:231], a[152:155]
    v_fma_f32 v149, v149, s60, v244
    v_fma_f32 v150, v150, s60, v244
    v_fma_f32 v151, v151, s60, v244
    v_exp_f32 v148, v148
    v_exp_f32 v149, v149
    v_exp_f32 v150, v150
    v_mfma_f32_16x16x32_bf16 v[132:135], v[192:195], v[48:51], 0
    s_add_u32 s51, s51, 4096
    v_exp_f32 v151, v151
    v_cvt_pk_bf16_f32 v224, v148, v149
    v_cvt_pk_bf16_f32 v225, v150, v151
    v_mfma_f32_16x16x32_bf16 v[140:143], v[192:195], v[56:59], 0
    ds_write_b64 v17, v[224:225] offset:24576
    v_max3_f32 v27, v27, v188, v189
    v_mfma_f32_16x16x32_bf16 v[148:151], v[192:195], v[64:67], 0
    s_add_u32 m0, s49, 4224
    v_max3_f32 v27, v27, v190, v191
    v_fma_f32 v188, v188, s60, v244
    v_fma_f32 v189, v189, s60, v244
    v_fma_f32 v190, v190, s60, v244
    v_mfma_f32_16x16x32_bf16 v[156:159], v[196:199], v[32:35], 0
    buffer_load_dwordx4 v28, s[32:35], s51 offen offset:0 nt lds
    v_fma_f32 v191, v191, s60, v244
    v_mfma_f32_16x16x32_bf16 v[164:167], v[196:199], v[40:43], 0
    ds_read_b128 v[192:195], v13 offset:0
    v_exp_f32 v188, v188
    v_exp_f32 v189, v189
    v_mfma_f32_16x16x32_bf16 v[172:175], v[196:199], v[48:51], 0
    v_exp_f32 v190, v190
    v_exp_f32 v191, v191
    v_cvt_pk_bf16_f32 v226, v188, v189
    v_cvt_pk_bf16_f32 v227, v190, v191
    v_mfma_f32_16x16x32_bf16 v[180:183], v[196:199], v[56:59], 0
    ds_write_b64 v17, v[226:227] offset:24584
    v_mfma_f32_16x16x32_bf16 v[188:191], v[196:199], v[64:67], 0
    s_waitcnt lgkmcnt(10)
    s_nop 0
    v_mfma_f32_16x16x32_bf16 v[116:119], v[200:203], v[72:75], v[116:119]
    buffer_load_dwordx4 v29, s[32:35], s51 offen offset:1056 nt lds
    v_mfma_f32_16x16x32_bf16 a[156:159], a[240:243], v[224:227], a[156:159]
    ds_read_b128 v[196:199], v13 offset:8448
    v_max3_f32 v23, v23, v36, v37
    v_max3_f32 v23, v23, v38, v39
    v_mfma_f32_16x16x32_bf16 v[124:127], v[200:203], v[80:83], v[124:127]
    v_fma_f32 v36, v36, s60, v240
    v_fma_f32 v37, v37, s60, v240
    v_mfma_f32_16x16x32_bf16 v[132:135], v[200:203], v[88:91], v[132:135]
    v_fma_f32 v38, v38, s60, v240
    v_fma_f32 v39, v39, s60, v240
    v_mfma_f32_16x16x32_bf16 v[140:143], v[200:203], v[96:99], v[140:143]
    v_exp_f32 v36, v36
    v_mfma_f32_16x16x32_bf16 v[148:151], v[200:203], v[104:107], v[148:151]
    v_exp_f32 v37, v37
    v_mfma_f32_16x16x32_bf16 v[156:159], v[204:207], v[72:75], v[156:159]
    ds_read_b128 v[200:203], v13 offset:64
    v_exp_f32 v38, v38
    v_mfma_f32_16x16x32_bf16 v[164:167], v[204:207], v[80:83], v[164:167]
    buffer_load_dwordx4 v30, s[32:35], s51 offen offset:2112 nt lds
    v_mfma_f32_16x16x32_bf16 v[172:175], v[204:207], v[88:91], v[172:175]
    v_exp_f32 v39, v39
    v_mfma_f32_16x16x32_bf16 v[180:183], v[204:207], v[96:99], v[180:183]
    v_cvt_pk_bf16_f32 v224, v36, v37
    v_cvt_pk_bf16_f32 v225, v38, v39
    v_mfma_f32_16x16x32_bf16 v[188:191], v[204:207], v[104:107], v[188:191]
    s_waitcnt lgkmcnt(9)
    v_mfma_f32_16x16x32_bf16 v[116:119], v[208:211], v[112:115], v[116:119]
    ds_read_b128 v[204:207], v13 offset:8512
    v_mfma_f32_16x16x32_bf16 v[124:127], v[208:211], v[120:123], v[124:127]
    ds_write_b64 v17, v[224:225] offset:40960
    v_mfma_f32_16x16x32_bf16 v[132:135], v[208:211], v[128:131], v[132:135]
    buffer_load_dwordx4 v31, s[32:35], s51 offen offset:3168 nt lds
    v_max3_f32 v23, v23, v76, v77
    v_mfma_f32_16x16x32_bf16 v[140:143], v[208:211], v[136:139], v[140:143]
    v_max3_f32 v23, v23, v78, v79
    v_fma_f32 v76, v76, s60, v240
    v_mfma_f32_16x16x32_bf16 v[148:151], v[208:211], v[144:147], v[148:151]
    v_fma_f32 v77, v77, s60, v240
    v_fma_f32 v78, v78, s60, v240
    v_mfma_f32_16x16x32_bf16 v[156:159], v[212:215], v[112:115], v[156:159]
    ds_read_b128 v[208:211], v13 offset:128
    v_fma_f32 v79, v79, s60, v240
    v_mfma_f32_16x16x32_bf16 v[164:167], v[212:215], v[120:123], v[164:167]
    v_exp_f32 v76, v76
    v_mfma_f32_16x16x32_bf16 v[172:175], v[212:215], v[128:131], v[172:175]
    v_exp_f32 v77, v77
    v_mfma_f32_16x16x32_bf16 v[180:183], v[212:215], v[136:139], v[180:183]
    v_exp_f32 v78, v78
    v_exp_f32 v79, v79
    v_mfma_f32_16x16x32_bf16 v[188:191], v[212:215], v[144:147], v[188:191]
    s_waitcnt lgkmcnt(8)
    v_cvt_pk_bf16_f32 v226, v76, v77
    v_cvt_pk_bf16_f32 v227, v78, v79
    v_mfma_f32_16x16x32_bf16 v[116:119], v[216:219], v[152:155], v[116:119]
    ds_read_b128 v[212:215], v13 offset:8576
    v_mfma_f32_16x16x32_bf16 v[124:127], v[216:219], v[160:163], v[124:127]
    ds_write_b64 v17, v[226:227] offset:40968
    v_mfma_f32_16x16x32_bf16 v[132:135], v[216:219], v[168:171], v[132:135]
    v_max3_f32 v24, v24, v44, v45
    v_max3_f32 v24, v24, v46, v47
    v_mfma_f32_16x16x32_bf16 v[140:143], v[216:219], v[176:179], v[140:143]
    v_fma_f32 v44, v44, s60, v241
    v_mfma_f32_16x16x32_bf16 v[148:151], v[216:219], v[184:187], v[148:151]
    v_mfma_f32_16x16x32_bf16 a[140:143], a[240:243], v[224:227], a[140:143]
    v_fma_f32 v45, v45, s60, v241
    v_fma_f32 v46, v46, s60, v241
    v_fma_f32 v47, v47, s60, v241
    v_mfma_f32_16x16x32_bf16 v[156:159], v[220:223], v[152:155], v[156:159]
    ds_read_b128 v[216:219], v13 offset:192
    v_exp_f32 v44, v44
    v_mfma_f32_16x16x32_bf16 v[164:167], v[220:223], v[160:163], v[164:167]
    v_exp_f32 v45, v45
    v_mfma_f32_16x16x32_bf16 v[172:175], v[220:223], v[168:171], v[172:175]
    v_exp_f32 v46, v46
    v_mfma_f32_16x16x32_bf16 v[180:183], v[220:223], v[176:179], v[180:183]
    v_exp_f32 v47, v47
    v_cvt_pk_bf16_f32 v228, v44, v45
    v_mfma_f32_16x16x32_bf16 v[188:191], v[220:223], v[184:187], v[188:191]
    s_waitcnt lgkmcnt(7)
    v_cvt_pk_bf16_f32 v229, v46, v47
    v_mfma_f32_16x16x32_bf16 v[116:119], v[192:195], a[160:163], v[116:119]
    ds_read_b128 v[220:223], v13 offset:8640
    v_mfma_f32_16x16x32_bf16 v[124:127], v[192:195], a[164:167], v[124:127]
    ds_write_b64 v17, v[228:229] offset:41984
    v_max3_f32 v24, v24, v84, v85
    v_mfma_f32_16x16x32_bf16 v[132:135], v[192:195], a[168:171], v[132:135]
    v_max3_f32 v24, v24, v86, v87
    v_fma_f32 v84, v84, s60, v241
    v_mfma_f32_16x16x32_bf16 v[140:143], v[192:195], a[172:175], v[140:143]
    v_fma_f32 v85, v85, s60, v241
    v_fma_f32 v86, v86, s60, v241
    v_fma_f32 v87, v87, s60, v241
    v_mfma_f32_16x16x32_bf16 v[148:151], v[192:195], a[176:179], v[148:151]
    v_exp_f32 v84, v84
    v_mfma_f32_16x16x32_bf16 v[156:159], v[196:199], a[160:163], v[156:159]
    v_exp_f32 v85, v85
    v_mfma_f32_16x16x32_bf16 v[164:167], v[196:199], a[164:167], v[164:167]
    v_exp_f32 v86, v86
    v_mfma_f32_16x16x32_bf16 v[172:175], v[196:199], a[168:171], v[172:175]
    v_exp_f32 v87, v87
    v_cvt_pk_bf16_f32 v230, v84, v85
    v_cvt_pk_bf16_f32 v231, v86, v87
    v_mfma_f32_16x16x32_bf16 v[180:183], v[196:199], a[172:175], v[180:183]
    ds_write_b64 v17, v[230:231] offset:41992
    v_mfma_f32_16x16x32_bf16 v[188:191], v[196:199], a[176:179], v[188:191]
    s_waitcnt lgkmcnt(8)
    v_max3_f32 v25, v25, v52, v53
    v_max3_f32 v25, v25, v54, v55
    v_fma_f32 v52, v52, s60, v242
    v_mfma_f32_16x16x32_bf16 v[116:119], v[200:203], a[180:183], v[116:119]
    v_mfma_f32_16x16x32_bf16 a[144:147], a[240:243], v[228:231], a[144:147]
    v_fma_f32 v53, v53, s60, v242
    v_fma_f32 v54, v54, s60, v242
    v_fma_f32 v55, v55, s60, v242
    v_mfma_f32_16x16x32_bf16 v[124:127], v[200:203], a[184:187], v[124:127]
    v_exp_f32 v52, v52
    v_mfma_f32_16x16x32_bf16 v[132:135], v[200:203], a[188:191], v[132:135]
    v_exp_f32 v53, v53
    v_mfma_f32_16x16x32_bf16 v[140:143], v[200:203], a[192:195], v[140:143]
    v_exp_f32 v54, v54
    v_exp_f32 v55, v55
    v_mfma_f32_16x16x32_bf16 v[148:151], v[200:203], a[196:199], v[148:151]
    v_cvt_pk_bf16_f32 v224, v52, v53
    v_cvt_pk_bf16_f32 v225, v54, v55
    v_mfma_f32_16x16x32_bf16 v[156:159], v[204:207], a[180:183], v[156:159]
    ds_write_b64 v17, v[224:225] offset:43008
    v_mfma_f32_16x16x32_bf16 v[164:167], v[204:207], a[184:187], v[164:167]
    v_max3_f32 v25, v25, v92, v93
    v_max3_f32 v25, v25, v94, v95
    v_mfma_f32_16x16x32_bf16 v[172:175], v[204:207], a[188:191], v[172:175]
    v_fma_f32 v92, v92, s60, v242
    v_fma_f32 v93, v93, s60, v242
    v_fma_f32 v94, v94, s60, v242
    v_mfma_f32_16x16x32_bf16 v[180:183], v[204:207], a[192:195], v[180:183]
    v_fma_f32 v95, v95, s60, v242
    v_exp_f32 v92, v92
    v_mfma_f32_16x16x32_bf16 v[188:191], v[204:207], a[196:199], v[188:191]
    v_exp_f32 v93, v93
    s_waitcnt vmcnt(8) lgkmcnt(0)
    s_waitcnt vmcnt(3)
    s_barrier
    v_mfma_f32_16x16x32_bf16 v[116:119], v[208:211], a[200:203], v[116:119]
    s_mov_b32 s51, 196608
    v_add_u32 v12, 67584, v7
    v_add_u32 v13, 67584, v8
    v_exp_f32 v94, v94
    v_mfma_f32_16x16x32_bf16 v[124:127], v[208:211], a[204:207], v[124:127]
    s_add_u32 m0, s49, 33792
    v_exp_f32 v95, v95
    v_mfma_f32_16x16x32_bf16 v[132:135], v[208:211], a[208:211], v[132:135]
    buffer_load_dwordx4 v28, s[32:35], s51 offen offset:0 nt lds
    v_cvt_pk_bf16_f32 v226, v92, v93
    v_mfma_f32_16x16x32_bf16 v[140:143], v[208:211], a[212:215], v[140:143]
    ds_read_b128 v[192:195], v12 offset:0
    v_cvt_pk_bf16_f32 v227, v94, v95
    v_mfma_f32_16x16x32_bf16 v[148:151], v[208:211], a[216:219], v[148:151]
    ds_read_b128 v[196:199], v12 offset:8448
    ds_read_b128 v[200:203], v12 offset:64
    v_mfma_f32_16x16x32_bf16 v[156:159], v[212:215], a[200:203], v[156:159]
    ds_read_b128 v[204:207], v12 offset:8512
    ds_read_b128 v[208:211], v12 offset:128
    v_mfma_f32_16x16x32_bf16 v[164:167], v[212:215], a[204:207], v[164:167]
    buffer_load_dwordx4 v29, s[32:35], s51 offen offset:1056 nt lds
    v_mfma_f32_16x16x32_bf16 v[172:175], v[212:215], a[208:211], v[172:175]
    ds_write_b64 v17, v[226:227] offset:43016
    v_max3_f32 v26, v26, v60, v61
    v_max3_f32 v26, v26, v62, v63
    v_mfma_f32_16x16x32_bf16 v[180:183], v[212:215], a[212:215], v[180:183]
    v_fma_f32 v60, v60, s60, v243
    v_mfma_f32_16x16x32_bf16 v[188:191], v[212:215], a[216:219], v[188:191]
    v_mfma_f32_16x16x32_bf16 a[148:151], a[240:243], v[224:227], a[148:151]
    v_fma_f32 v61, v61, s60, v243
    v_fma_f32 v62, v62, s60, v243
    v_fma_f32 v63, v63, s60, v243
    v_exp_f32 v60, v60
    v_mfma_f32_16x16x32_bf16 v[116:119], v[216:219], a[220:223], v[116:119]
    ds_read_b128 v[212:215], v12 offset:8576
    v_exp_f32 v61, v61
    v_mfma_f32_16x16x32_bf16 v[124:127], v[216:219], a[224:227], v[124:127]
    v_exp_f32 v62, v62
    v_exp_f32 v63, v63
    v_cvt_pk_bf16_f32 v228, v60, v61
    v_mfma_f32_16x16x32_bf16 v[132:135], v[216:219], a[228:231], v[132:135]
    buffer_load_dwordx4 v30, s[32:35], s51 offen offset:2112 nt lds
    v_cvt_pk_bf16_f32 v229, v62, v63
    v_mfma_f32_16x16x32_bf16 v[140:143], v[216:219], a[232:235], v[140:143]
    ds_write_b64 v17, v[228:229] offset:44032
    v_mfma_f32_16x16x32_bf16 v[148:151], v[216:219], a[236:239], v[148:151]
    v_max3_f32 v26, v26, v100, v101
    v_max3_f32 v26, v26, v102, v103
    v_fma_f32 v100, v100, s60, v243
    v_fma_f32 v101, v101, s60, v243
    v_mfma_f32_16x16x32_bf16 v[156:159], v[220:223], a[220:223], v[156:159]
    ds_read_b128 v[216:219], v12 offset:192
    v_fma_f32 v102, v102, s60, v243
    v_fma_f32 v103, v103, s60, v243
    v_mfma_f32_16x16x32_bf16 v[164:167], v[220:223], a[224:227], v[164:167]
    v_exp_f32 v100, v100
    v_exp_f32 v101, v101
    v_mfma_f32_16x16x32_bf16 v[172:175], v[220:223], a[228:231], v[172:175]
    v_exp_f32 v102, v102
    v_exp_f32 v103, v103
    v_mfma_f32_16x16x32_bf16 v[180:183], v[220:223], a[232:235], v[180:183]
    buffer_load_dwordx4 v31, s[32:35], s51 offen offset:3168 nt lds
    v_cvt_pk_bf16_f32 v230, v100, v101
    v_mfma_f32_16x16x32_bf16 v[188:191], v[220:223], a[236:239], v[188:191]
    s_waitcnt lgkmcnt(7)
    v_cvt_pk_bf16_f32 v231, v102, v103
    v_mfma_f32_16x16x32_bf16 v[36:39], v[192:195], v[32:35], 0
    ds_write_b64 v17, v[230:231] offset:44040
    v_max3_f32 v27, v27, v68, v69
    v_max3_f32 v27, v27, v70, v71
    v_fma_f32 v68, v68, s60, v244
    v_mfma_f32_16x16x32_bf16 v[44:47], v[192:195], v[40:43], 0
    ds_read_b128 v[220:223], v12 offset:8640
    v_mfma_f32_16x16x32_bf16 a[152:155], a[240:243], v[228:231], a[152:155]
    v_fma_f32 v69, v69, s60, v244
    v_fma_f32 v70, v70, s60, v244
    v_fma_f32 v71, v71, s60, v244
    v_exp_f32 v68, v68
    v_exp_f32 v69, v69
    v_exp_f32 v70, v70
    v_mfma_f32_16x16x32_bf16 v[52:55], v[192:195], v[48:51], 0
    s_add_u32 s51, s51, 4096
    v_exp_f32 v71, v71
    v_cvt_pk_bf16_f32 v224, v68, v69
    v_cvt_pk_bf16_f32 v225, v70, v71
    v_mfma_f32_16x16x32_bf16 v[60:63], v[192:195], v[56:59], 0
    ds_write_b64 v17, v[224:225] offset:45056
    v_max3_f32 v27, v27, v108, v109
    v_mfma_f32_16x16x32_bf16 v[68:71], v[192:195], v[64:67], 0
    s_add_u32 m0, s49, 38016
    v_max3_f32 v27, v27, v110, v111
    v_fma_f32 v108, v108, s60, v244
    v_fma_f32 v109, v109, s60, v244
    v_fma_f32 v110, v110, s60, v244
    v_mfma_f32_16x16x32_bf16 v[76:79], v[196:199], v[32:35], 0
    buffer_load_dwordx4 v28, s[32:35], s51 offen offset:0 nt lds
    v_fma_f32 v111, v111, s60, v244
    v_mfma_f32_16x16x32_bf16 v[84:87], v[196:199], v[40:43], 0
    ds_read_b128 v[192:195], v13 offset:0
    v_exp_f32 v108, v108
    v_exp_f32 v109, v109
    v_mfma_f32_16x16x32_bf16 v[92:95], v[196:199], v[48:51], 0
    v_exp_f32 v110, v110
    v_exp_f32 v111, v111
    v_cvt_pk_bf16_f32 v226, v108, v109
    v_cvt_pk_bf16_f32 v227, v110, v111
    v_mfma_f32_16x16x32_bf16 v[100:103], v[196:199], v[56:59], 0
    ds_write_b64 v17, v[226:227] offset:45064
    v_mfma_f32_16x16x32_bf16 v[108:111], v[196:199], v[64:67], 0
    s_waitcnt lgkmcnt(10)
    s_nop 0
    v_mfma_f32_16x16x32_bf16 v[36:39], v[200:203], v[72:75], v[36:39]
    buffer_load_dwordx4 v29, s[32:35], s51 offen offset:1056 nt lds
    v_mfma_f32_16x16x32_bf16 a[156:159], a[240:243], v[224:227], a[156:159]
    ds_read_b128 v[196:199], v13 offset:8448
    v_max3_f32 v23, v23, v116, v117
    v_mfma_f32_16x16x32_bf16 v[44:47], v[200:203], v[80:83], v[44:47]
    v_max3_f32 v23, v23, v118, v119
    v_fma_f32 v116, v116, s60, v240
    v_mfma_f32_16x16x32_bf16 v[52:55], v[200:203], v[88:91], v[52:55]
    v_fma_f32 v117, v117, s60, v240
    v_fma_f32 v118, v118, s60, v240
    v_fma_f32 v119, v119, s60, v240
    v_mfma_f32_16x16x32_bf16 v[60:63], v[200:203], v[96:99], v[60:63]
    v_exp_f32 v116, v116
    v_mfma_f32_16x16x32_bf16 v[68:71], v[200:203], v[104:107], v[68:71]
    v_exp_f32 v117, v117
    v_mfma_f32_16x16x32_bf16 v[76:79], v[204:207], v[72:75], v[76:79]
    ds_read_b128 v[200:203], v13 offset:64
    v_mfma_f32_16x16x32_bf16 v[84:87], v[204:207], v[80:83], v[84:87]
    buffer_load_dwordx4 v30, s[32:35], s51 offen offset:2112 nt lds
    v_mfma_f32_16x16x32_bf16 v[92:95], v[204:207], v[88:91], v[92:95]
    v_exp_f32 v118, v118
    v_mfma_f32_16x16x32_bf16 v[100:103], v[204:207], v[96:99], v[100:103]
    v_exp_f32 v119, v119
    v_cvt_pk_bf16_f32 v224, v116, v117
    v_mfma_f32_16x16x32_bf16 v[108:111], v[204:207], v[104:107], v[108:111]
    s_waitcnt lgkmcnt(9)
    v_cvt_pk_bf16_f32 v225, v118, v119
    v_accvgpr_write_b32 a0, v224
    v_mfma_f32_16x16x32_bf16 v[36:39], v[208:211], v[112:115], v[36:39]
    ds_read_b128 v[204:207], v13 offset:8512
    v_accvgpr_write_b32 a1, v225
    v_mfma_f32_16x16x32_bf16 v[44:47], v[208:211], v[120:123], v[44:47]
    v_max3_f32 v23, v23, v156, v157
    v_max3_f32 v23, v23, v158, v159
    v_fma_f32 v156, v156, s60, v240
    v_mfma_f32_16x16x32_bf16 v[52:55], v[208:211], v[128:131], v[52:55]
    buffer_load_dwordx4 v31, s[32:35], s51 offen offset:3168 nt lds
    v_mfma_f32_16x16x32_bf16 v[60:63], v[208:211], v[136:139], v[60:63]
    v_fma_f32 v157, v157, s60, v240
    v_fma_f32 v158, v158, s60, v240
    v_mfma_f32_16x16x32_bf16 v[68:71], v[208:211], v[144:147], v[68:71]
    v_fma_f32 v159, v159, s60, v240
    v_exp_f32 v156, v156
    v_mfma_f32_16x16x32_bf16 v[76:79], v[212:215], v[112:115], v[76:79]
    ds_read_b128 v[208:211], v13 offset:128
    v_mfma_f32_16x16x32_bf16 v[84:87], v[212:215], v[120:123], v[84:87]
    v_exp_f32 v157, v157
    v_mfma_f32_16x16x32_bf16 v[92:95], v[212:215], v[128:131], v[92:95]
    v_exp_f32 v158, v158
    v_mfma_f32_16x16x32_bf16 v[100:103], v[212:215], v[136:139], v[100:103]
    v_exp_f32 v159, v159
    v_cvt_pk_bf16_f32 v226, v156, v157
    v_mfma_f32_16x16x32_bf16 v[108:111], v[212:215], v[144:147], v[108:111]
    s_waitcnt lgkmcnt(7)
    v_cvt_pk_bf16_f32 v227, v158, v159
    v_accvgpr_write_b32 a2, v226
    v_mfma_f32_16x16x32_bf16 v[36:39], v[216:219], v[152:155], v[36:39]
    ds_read_b128 v[212:215], v13 offset:8576
    v_accvgpr_write_b32 a3, v227
    v_mfma_f32_16x16x32_bf16 v[44:47], v[216:219], v[160:163], v[44:47]
    v_max3_f32 v24, v24, v124, v125
    v_max3_f32 v24, v24, v126, v127
    v_fma_f32 v124, v124, s60, v241
    v_mfma_f32_16x16x32_bf16 v[52:55], v[216:219], v[168:171], v[52:55]
    v_mfma_f32_16x16x32_bf16 a[140:143], a[240:243], v[224:227], a[140:143]
    v_fma_f32 v125, v125, s60, v241
    v_fma_f32 v126, v126, s60, v241
    v_mfma_f32_16x16x32_bf16 v[60:63], v[216:219], v[176:179], v[60:63]
    v_fma_f32 v127, v127, s60, v241
    v_exp_f32 v124, v124
    v_mfma_f32_16x16x32_bf16 v[68:71], v[216:219], v[184:187], v[68:71]
    v_exp_f32 v125, v125
    v_mfma_f32_16x16x32_bf16 v[76:79], v[220:223], v[152:155], v[76:79]
    ds_read_b128 v[216:219], v13 offset:192
    v_exp_f32 v126, v126
    v_mfma_f32_16x16x32_bf16 v[84:87], v[220:223], v[160:163], v[84:87]
    v_exp_f32 v127, v127
    v_mfma_f32_16x16x32_bf16 v[92:95], v[220:223], v[168:171], v[92:95]
    v_cvt_pk_bf16_f32 v228, v124, v125
    v_cvt_pk_bf16_f32 v229, v126, v127
    v_mfma_f32_16x16x32_bf16 v[100:103], v[220:223], v[176:179], v[100:103]
    v_accvgpr_write_b32 a4, v228
    v_accvgpr_write_b32 a5, v229
    v_max3_f32 v24, v24, v164, v165
    v_mfma_f32_16x16x32_bf16 v[108:111], v[220:223], v[184:187], v[108:111]
    s_waitcnt lgkmcnt(5)
    v_max3_f32 v24, v24, v166, v167
    v_fma_f32 v164, v164, s60, v241
    v_mfma_f32_16x16x32_bf16 v[36:39], v[192:195], a[160:163], v[36:39]
    ds_read_b128 v[220:223], v13 offset:8640
    v_fma_f32 v165, v165, s60, v241
    v_mfma_f32_16x16x32_bf16 v[44:47], v[192:195], a[164:167], v[44:47]
    v_fma_f32 v166, v166, s60, v241
    v_fma_f32 v167, v167, s60, v241
    v_mfma_f32_16x16x32_bf16 v[52:55], v[192:195], a[168:171], v[52:55]
    v_exp_f32 v164, v164
    v_mfma_f32_16x16x32_bf16 v[60:63], v[192:195], a[172:175], v[60:63]
    v_exp_f32 v165, v165
    v_exp_f32 v166, v166
    v_mfma_f32_16x16x32_bf16 v[68:71], v[192:195], a[176:179], v[68:71]
    v_exp_f32 v167, v167
    v_mfma_f32_16x16x32_bf16 v[76:79], v[196:199], a[160:163], v[76:79]
    v_cvt_pk_bf16_f32 v230, v164, v165
    v_cvt_pk_bf16_f32 v231, v166, v167
    v_mfma_f32_16x16x32_bf16 v[84:87], v[196:199], a[164:167], v[84:87]
    v_accvgpr_write_b32 a6, v230
    v_accvgpr_write_b32 a7, v231
    v_max3_f32 v25, v25, v132, v133
    v_mfma_f32_16x16x32_bf16 v[92:95], v[196:199], a[168:171], v[92:95]
    v_max3_f32 v25, v25, v134, v135
    v_fma_f32 v132, v132, s60, v242
    v_mfma_f32_16x16x32_bf16 v[100:103], v[196:199], a[172:175], v[100:103]
    v_mfma_f32_16x16x32_bf16 a[144:147], a[240:243], v[228:231], a[144:147]
    v_fma_f32 v133, v133, s60, v242
    v_fma_f32 v134, v134, s60, v242
    v_fma_f32 v135, v135, s60, v242
    v_mfma_f32_16x16x32_bf16 v[108:111], v[196:199], a[176:179], v[108:111]
    s_waitcnt lgkmcnt(4)
    v_exp_f32 v132, v132
    v_mfma_f32_16x16x32_bf16 v[36:39], v[200:203], a[180:183], v[36:39]
    v_exp_f32 v133, v133
    v_mfma_f32_16x16x32_bf16 v[44:47], v[200:203], a[184:187], v[44:47]
    v_exp_f32 v134, v134
    v_mfma_f32_16x16x32_bf16 v[52:55], v[200:203], a[188:191], v[52:55]
    v_exp_f32 v135, v135
    v_cvt_pk_bf16_f32 v224, v132, v133
    v_cvt_pk_bf16_f32 v225, v134, v135
    v_mfma_f32_16x16x32_bf16 v[60:63], v[200:203], a[192:195], v[60:63]
    v_accvgpr_write_b32 a8, v224
    v_accvgpr_write_b32 a9, v225
    v_mfma_f32_16x16x32_bf16 v[68:71], v[200:203], a[196:199], v[68:71]
    v_max3_f32 v25, v25, v172, v173
    v_max3_f32 v25, v25, v174, v175
    v_fma_f32 v172, v172, s60, v242
    v_mfma_f32_16x16x32_bf16 v[76:79], v[204:207], a[180:183], v[76:79]
    v_fma_f32 v173, v173, s60, v242
    v_fma_f32 v174, v174, s60, v242
    v_mfma_f32_16x16x32_bf16 v[84:87], v[204:207], a[184:187], v[84:87]
    v_fma_f32 v175, v175, s60, v242
    v_exp_f32 v172, v172
    v_mfma_f32_16x16x32_bf16 v[92:95], v[204:207], a[188:191], v[92:95]
    v_exp_f32 v173, v173
    v_mfma_f32_16x16x32_bf16 v[100:103], v[204:207], a[192:195], v[100:103]
    v_exp_f32 v174, v174
    v_mfma_f32_16x16x32_bf16 v[108:111], v[204:207], a[196:199], v[108:111]
    v_exp_f32 v175, v175
    s_waitcnt vmcnt(8) lgkmcnt(0)
    s_waitcnt vmcnt(3)
    s_barrier
    v_mfma_f32_16x16x32_bf16 v[36:39], v[208:211], a[200:203], v[36:39]
    s_mov_b32 s51, 229376
    v_add_u32 v12, 0, v7
    v_add_u32 v13, 0, v8
    v_cvt_pk_bf16_f32 v226, v172, v173
    v_cvt_pk_bf16_f32 v227, v174, v175
    v_mfma_f32_16x16x32_bf16 v[44:47], v[208:211], a[204:207], v[44:47]
    s_add_u32 m0, s49, 67584
    v_accvgpr_write_b32 a10, v226
    v_accvgpr_write_b32 a11, v227
    v_max3_f32 v26, v26, v140, v141
    v_mfma_f32_16x16x32_bf16 v[52:55], v[208:211], a[208:211], v[52:55]
    buffer_load_dwordx4 v28, s[32:35], s51 offen offset:0 nt lds
    v_max3_f32 v26, v26, v142, v143
    v_mfma_f32_16x16x32_bf16 v[60:63], v[208:211], a[212:215], v[60:63]
    ds_read_b128 v[192:195], v12 offset:0
    v_fma_f32 v140, v140, s60, v243
    v_mfma_f32_16x16x32_bf16 v[68:71], v[208:211], a[216:219], v[68:71]
    ds_read_b128 v[196:199], v12 offset:8448
    ds_read_b128 v[200:203], v12 offset:64
    v_mfma_f32_16x16x32_bf16 a[148:151], a[240:243], v[224:227], a[148:151]
    ds_read_b128 v[204:207], v12 offset:8512
    v_fma_f32 v141, v141, s60, v243
    v_fma_f32 v142, v142, s60, v243
    v_mfma_f32_16x16x32_bf16 v[76:79], v[212:215], a[200:203], v[76:79]
    ds_read_b128 v[208:211], v12 offset:128
    v_fma_f32 v143, v143, s60, v243
    v_mfma_f32_16x16x32_bf16 v[84:87], v[212:215], a[204:207], v[84:87]
    buffer_load_dwordx4 v29, s[32:35], s51 offen offset:1056 nt lds
    v_mfma_f32_16x16x32_bf16 v[92:95], v[212:215], a[208:211], v[92:95]
    v_exp_f32 v140, v140
    v_exp_f32 v141, v141
    v_mfma_f32_16x16x32_bf16 v[100:103], v[212:215], a[212:215], v[100:103]
    v_exp_f32 v142, v142
    v_mfma_f32_16x16x32_bf16 v[108:111], v[212:215], a[216:219], v[108:111]
    v_exp_f32 v143, v143
    v_cvt_pk_bf16_f32 v228, v140, v141
    v_cvt_pk_bf16_f32 v229, v142, v143
    v_mfma_f32_16x16x32_bf16 v[36:39], v[216:219], a[220:223], v[36:39]
    ds_read_b128 v[212:215], v12 offset:8576
    v_accvgpr_write_b32 a12, v228
    v_accvgpr_write_b32 a13, v229
    v_mfma_f32_16x16x32_bf16 v[44:47], v[216:219], a[224:227], v[44:47]
    v_max3_f32 v26, v26, v180, v181
    v_max3_f32 v26, v26, v182, v183
    v_fma_f32 v180, v180, s60, v243
    v_mfma_f32_16x16x32_bf16 v[52:55], v[216:219], a[228:231], v[52:55]
    buffer_load_dwordx4 v30, s[32:35], s51 offen offset:2112 nt lds
    v_fma_f32 v181, v181, s60, v243
    v_mfma_f32_16x16x32_bf16 v[60:63], v[216:219], a[232:235], v[60:63]
    v_fma_f32 v182, v182, s60, v243
    v_fma_f32 v183, v183, s60, v243
    v_mfma_f32_16x16x32_bf16 v[68:71], v[216:219], a[236:239], v[68:71]
    v_exp_f32 v180, v180
    v_exp_f32 v181, v181
    v_mfma_f32_16x16x32_bf16 v[76:79], v[220:223], a[220:223], v[76:79]
    ds_read_b128 v[216:219], v12 offset:192
    v_exp_f32 v182, v182
    v_mfma_f32_16x16x32_bf16 v[84:87], v[220:223], a[224:227], v[84:87]
    v_exp_f32 v183, v183
    v_cvt_pk_bf16_f32 v230, v180, v181
    v_mfma_f32_16x16x32_bf16 v[92:95], v[220:223], a[228:231], v[92:95]
    v_cvt_pk_bf16_f32 v231, v182, v183
    v_accvgpr_write_b32 a14, v230
    v_accvgpr_write_b32 a15, v231
    v_max3_f32 v27, v27, v148, v149
    v_mfma_f32_16x16x32_bf16 v[100:103], v[220:223], a[232:235], v[100:103]
    buffer_load_dwordx4 v31, s[32:35], s51 offen offset:3168 nt lds
    v_max3_f32 v27, v27, v150, v151
    v_mfma_f32_16x16x32_bf16 v[108:111], v[220:223], a[236:239], v[108:111]
    s_waitcnt lgkmcnt(5)
    v_fma_f32 v148, v148, s60, v244
    v_mfma_f32_16x16x32_bf16 v[116:119], v[192:195], v[32:35], 0
    ds_read_b128 v[220:223], v12 offset:8640
    v_mfma_f32_16x16x32_bf16 a[152:155], a[240:243], v[228:231], a[152:155]
    v_fma_f32 v149, v149, s60, v244
    v_fma_f32 v150, v150, s60, v244
    v_fma_f32 v151, v151, s60, v244
    v_exp_f32 v148, v148
    v_exp_f32 v149, v149
    v_mfma_f32_16x16x32_bf16 v[124:127], v[192:195], v[40:43], 0
    v_exp_f32 v150, v150
    v_mfma_f32_16x16x32_bf16 v[132:135], v[192:195], v[48:51], 0
    s_add_u32 s51, s51, 4096
    v_exp_f32 v151, v151
    v_cvt_pk_bf16_f32 v224, v148, v149
    v_cvt_pk_bf16_f32 v225, v150, v151
    v_accvgpr_write_b32 a16, v224
    v_mfma_f32_16x16x32_bf16 v[140:143], v[192:195], v[56:59], 0
    s_add_u32 m0, s49, 71808
    v_accvgpr_write_b32 a17, v225
    v_max3_f32 v27, v27, v188, v189
    v_max3_f32 v27, v27, v190, v191
    v_fma_f32 v188, v188, s60, v244
    v_mfma_f32_16x16x32_bf16 v[148:151], v[192:195], v[64:67], 0
    buffer_load_dwordx4 v28, s[32:35], s51 offen offset:0 nt lds
    v_fma_f32 v189, v189, s60, v244
    v_mfma_f32_16x16x32_bf16 v[156:159], v[196:199], v[32:35], 0
    ds_read_b128 v[192:195], v13 offset:0
    v_fma_f32 v190, v190, s60, v244
    v_fma_f32 v191, v191, s60, v244
    v_mfma_f32_16x16x32_bf16 v[164:167], v[196:199], v[40:43], 0
    v_exp_f32 v188, v188
    v_exp_f32 v189, v189
    v_exp_f32 v190, v190
    v_mfma_f32_16x16x32_bf16 v[172:175], v[196:199], v[48:51], 0
    v_exp_f32 v191, v191
    v_cvt_pk_bf16_f32 v226, v188, v189
    v_cvt_pk_bf16_f32 v227, v190, v191
    v_mfma_f32_16x16x32_bf16 v[180:183], v[196:199], v[56:59], 0
    v_accvgpr_write_b32 a18, v226
    v_accvgpr_write_b32 a19, v227
    v_mfma_f32_16x16x32_bf16 v[188:191], v[196:199], v[64:67], 0
    s_waitcnt lgkmcnt(5)
    s_nop 0
    v_mfma_f32_16x16x32_bf16 v[116:119], v[200:203], v[72:75], v[116:119]
    buffer_load_dwordx4 v29, s[32:35], s51 offen offset:1056 nt lds
    v_mfma_f32_16x16x32_bf16 a[156:159], a[240:243], v[224:227], a[156:159]
    ds_read_b128 v[196:199], v13 offset:8448
    v_max3_f32 v23, v23, v36, v37
    v_max3_f32 v23, v23, v38, v39
    v_mfma_f32_16x16x32_bf16 v[124:127], v[200:203], v[80:83], v[124:127]
    v_fma_f32 v36, v36, s60, v240
    v_fma_f32 v37, v37, s60, v240
    v_mfma_f32_16x16x32_bf16 v[132:135], v[200:203], v[88:91], v[132:135]
    v_fma_f32 v38, v38, s60, v240
    v_fma_f32 v39, v39, s60, v240
    v_mfma_f32_16x16x32_bf16 v[140:143], v[200:203], v[96:99], v[140:143]
    v_exp_f32 v36, v36
    v_mfma_f32_16x16x32_bf16 v[148:151], v[200:203], v[104:107], v[148:151]
    v_exp_f32 v37, v37
    v_mfma_f32_16x16x32_bf16 v[156:159], v[204:207], v[72:75], v[156:159]
    ds_read_b128 v[200:203], v13 offset:64
    v_exp_f32 v38, v38
    v_mfma_f32_16x16x32_bf16 v[164:167], v[204:207], v[80:83], v[164:167]
    buffer_load_dwordx4 v30, s[32:35], s51 offen offset:2112 nt lds
    v_mfma_f32_16x16x32_bf16 v[172:175], v[204:207], v[88:91], v[172:175]
    v_exp_f32 v39, v39
    v_mfma_f32_16x16x32_bf16 v[180:183], v[204:207], v[96:99], v[180:183]
    v_cvt_pk_bf16_f32 v224, v36, v37
    v_cvt_pk_bf16_f32 v225, v38, v39
    v_mfma_f32_16x16x32_bf16 v[188:191], v[204:207], v[104:107], v[188:191]
    s_waitcnt lgkmcnt(5)
    v_accvgpr_write_b32 a20, v224
    v_accvgpr_write_b32 a21, v225
    v_mfma_f32_16x16x32_bf16 v[116:119], v[208:211], v[112:115], v[116:119]
    ds_read_b128 v[204:207], v13 offset:8512
    v_max3_f32 v23, v23, v76, v77
    v_max3_f32 v23, v23, v78, v79
    v_mfma_f32_16x16x32_bf16 v[124:127], v[208:211], v[120:123], v[124:127]
    v_fma_f32 v76, v76, s60, v240
    v_fma_f32 v77, v77, s60, v240
    v_mfma_f32_16x16x32_bf16 v[132:135], v[208:211], v[128:131], v[132:135]
    buffer_load_dwordx4 v31, s[32:35], s51 offen offset:3168 nt lds
    v_mfma_f32_16x16x32_bf16 v[140:143], v[208:211], v[136:139], v[140:143]
    v_fma_f32 v78, v78, s60, v240
    v_fma_f32 v79, v79, s60, v240
    v_mfma_f32_16x16x32_bf16 v[148:151], v[208:211], v[144:147], v[148:151]
    v_exp_f32 v76, v76
    v_mfma_f32_16x16x32_bf16 v[156:159], v[212:215], v[112:115], v[156:159]
    ds_read_b128 v[208:211], v13 offset:128
    v_exp_f32 v77, v77
    v_mfma_f32_16x16x32_bf16 v[164:167], v[212:215], v[120:123], v[164:167]
    v_exp_f32 v78, v78
    v_mfma_f32_16x16x32_bf16 v[172:175], v[212:215], v[128:131], v[172:175]
    v_exp_f32 v79, v79
    v_cvt_pk_bf16_f32 v226, v76, v77
    v_mfma_f32_16x16x32_bf16 v[180:183], v[212:215], v[136:139], v[180:183]
    v_cvt_pk_bf16_f32 v227, v78, v79
    v_accvgpr_write_b32 a22, v226
    v_mfma_f32_16x16x32_bf16 v[188:191], v[212:215], v[144:147], v[188:191]
    s_waitcnt lgkmcnt(5)
    v_accvgpr_write_b32 a23, v227
    v_max3_f32 v24, v24, v44, v45
    v_mfma_f32_16x16x32_bf16 v[116:119], v[216:219], v[152:155], v[116:119]
    ds_read_b128 v[212:215], v13 offset:8576
    v_max3_f32 v24, v24, v46, v47
    v_mfma_f32_16x16x32_bf16 v[124:127], v[216:219], v[160:163], v[124:127]
    v_fma_f32 v44, v44, s60, v241
    v_mfma_f32_16x16x32_bf16 v[132:135], v[216:219], v[168:171], v[132:135]
    v_mfma_f32_16x16x32_bf16 a[140:143], a[240:243], v[224:227], a[140:143]
    v_fma_f32 v45, v45, s60, v241
    v_fma_f32 v46, v46, s60, v241
    v_fma_f32 v47, v47, s60, v241
    v_mfma_f32_16x16x32_bf16 v[140:143], v[216:219], v[176:179], v[140:143]
    v_exp_f32 v44, v44
    v_mfma_f32_16x16x32_bf16 v[148:151], v[216:219], v[184:187], v[148:151]
    v_exp_f32 v45, v45
    v_mfma_f32_16x16x32_bf16 v[156:159], v[220:223], v[152:155], v[156:159]
    ds_read_b128 v[216:219], v13 offset:192
    v_exp_f32 v46, v46
    v_mfma_f32_16x16x32_bf16 v[164:167], v[220:223], v[160:163], v[164:167]
    v_exp_f32 v47, v47
    v_cvt_pk_bf16_f32 v228, v44, v45
    v_mfma_f32_16x16x32_bf16 v[172:175], v[220:223], v[168:171], v[172:175]
    v_cvt_pk_bf16_f32 v229, v46, v47
    v_accvgpr_write_b32 a24, v228
    v_mfma_f32_16x16x32_bf16 v[180:183], v[220:223], v[176:179], v[180:183]
    v_accvgpr_write_b32 a25, v229
    v_max3_f32 v24, v24, v84, v85
    v_max3_f32 v24, v24, v86, v87
    v_mfma_f32_16x16x32_bf16 v[188:191], v[220:223], v[184:187], v[188:191]
    s_waitcnt lgkmcnt(5)
    v_fma_f32 v84, v84, s60, v241
    v_fma_f32 v85, v85, s60, v241
    v_mfma_f32_16x16x32_bf16 v[116:119], v[192:195], a[160:163], v[116:119]
    ds_read_b128 v[220:223], v13 offset:8640
    v_fma_f32 v86, v86, s60, v241
    v_mfma_f32_16x16x32_bf16 v[124:127], v[192:195], a[164:167], v[124:127]
    v_fma_f32 v87, v87, s60, v241
    v_exp_f32 v84, v84
    v_mfma_f32_16x16x32_bf16 v[132:135], v[192:195], a[168:171], v[132:135]
    v_exp_f32 v85, v85
    v_mfma_f32_16x16x32_bf16 v[140:143], v[192:195], a[172:175], v[140:143]
    v_exp_f32 v86, v86
    v_mfma_f32_16x16x32_bf16 v[148:151], v[192:195], a[176:179], v[148:151]
    v_exp_f32 v87, v87
    v_cvt_pk_bf16_f32 v230, v84, v85
    v_mfma_f32_16x16x32_bf16 v[156:159], v[196:199], a[160:163], v[156:159]
    v_cvt_pk_bf16_f32 v231, v86, v87
    v_accvgpr_write_b32 a26, v230
    v_mfma_f32_16x16x32_bf16 v[164:167], v[196:199], a[164:167], v[164:167]
    v_accvgpr_write_b32 a27, v231
    v_max3_f32 v25, v25, v52, v53
    v_max3_f32 v25, v25, v54, v55
    v_mfma_f32_16x16x32_bf16 v[172:175], v[196:199], a[168:171], v[172:175]
    v_fma_f32 v52, v52, s60, v242
    v_mfma_f32_16x16x32_bf16 v[180:183], v[196:199], a[172:175], v[180:183]
    v_mfma_f32_16x16x32_bf16 a[144:147], a[240:243], v[228:231], a[144:147]
    v_fma_f32 v53, v53, s60, v242
    v_fma_f32 v54, v54, s60, v242
    v_fma_f32 v55, v55, s60, v242
    v_mfma_f32_16x16x32_bf16 v[188:191], v[196:199], a[176:179], v[188:191]
    s_waitcnt lgkmcnt(4)
    v_exp_f32 v52, v52
    v_mfma_f32_16x16x32_bf16 v[116:119], v[200:203], a[180:183], v[116:119]
    v_exp_f32 v53, v53
    v_mfma_f32_16x16x32_bf16 v[124:127], v[200:203], a[184:187], v[124:127]
    v_exp_f32 v54, v54
    v_mfma_f32_16x16x32_bf16 v[132:135], v[200:203], a[188:191], v[132:135]
    v_exp_f32 v55, v55
    v_cvt_pk_bf16_f32 v224, v52, v53
    v_cvt_pk_bf16_f32 v225, v54, v55
    v_mfma_f32_16x16x32_bf16 v[140:143], v[200:203], a[192:195], v[140:143]
    v_accvgpr_write_b32 a28, v224
    v_accvgpr_write_b32 a29, v225
    v_mfma_f32_16x16x32_bf16 v[148:151], v[200:203], a[196:199], v[148:151]
    v_max3_f32 v25, v25, v92, v93
    v_max3_f32 v25, v25, v94, v95
    v_fma_f32 v92, v92, s60, v242
    v_mfma_f32_16x16x32_bf16 v[156:159], v[204:207], a[180:183], v[156:159]
    v_fma_f32 v93, v93, s60, v242
    v_fma_f32 v94, v94, s60, v242
    v_mfma_f32_16x16x32_bf16 v[164:167], v[204:207], a[184:187], v[164:167]
    v_fma_f32 v95, v95, s60, v242
    v_mfma_f32_16x16x32_bf16 v[172:175], v[204:207], a[188:191], v[172:175]
    v_exp_f32 v92, v92
    v_mfma_f32_16x16x32_bf16 v[180:183], v[204:207], a[192:195], v[180:183]
    v_exp_f32 v93, v93
    v_exp_f32 v94, v94
    v_mfma_f32_16x16x32_bf16 v[188:191], v[204:207], a[196:199], v[188:191]
    v_exp_f32 v95, v95
    s_waitcnt vmcnt(8) lgkmcnt(0)
    s_waitcnt vmcnt(3)
    s_barrier
    v_mfma_f32_16x16x32_bf16 v[116:119], v[208:211], a[200:203], v[116:119]
    v_add_u32 v28, 0, v3
    v_subrev_u32 v29, 544, v3
    v_subrev_u32 v30, 1088, v3
    v_mfma_f32_16x16x32_bf16 v[124:127], v[208:211], a[204:207], v[124:127]
    v_subrev_u32 v31, 1632, v3
    v_add_u32 v12, 33792, v7
    v_add_u32 v13, 33792, v8
    v_mfma_f32_16x16x32_bf16 v[132:135], v[208:211], a[208:211], v[132:135]
    s_mov_b32 s51, 0
    v_cvt_pk_bf16_f32 v226, v92, v93
    v_cvt_pk_bf16_f32 v227, v94, v95
    v_accvgpr_write_b32 a30, v226
    v_mfma_f32_16x16x32_bf16 v[140:143], v[208:211], a[212:215], v[140:143]
    s_add_u32 m0, s49, 0
    v_accvgpr_write_b32 a31, v227
    v_max3_f32 v26, v26, v60, v61
    v_max3_f32 v26, v26, v62, v63
    v_mfma_f32_16x16x32_bf16 v[148:151], v[208:211], a[216:219], v[148:151]
    buffer_load_dwordx4 v28, s[36:39], s51 offen offset:0 nt lds
    v_fma_f32 v60, v60, s60, v243
    v_mfma_f32_16x16x32_bf16 v[156:159], v[212:215], a[200:203], v[156:159]
    ds_read_b128 v[192:195], v12 offset:0
    ds_read_b128 v[196:199], v12 offset:8448
    v_mfma_f32_16x16x32_bf16 a[148:151], a[240:243], v[224:227], a[148:151]
    ds_read_b128 v[200:203], v12 offset:64
    v_fma_f32 v61, v61, s60, v243
    v_fma_f32 v62, v62, s60, v243
    v_mfma_f32_16x16x32_bf16 v[164:167], v[212:215], a[204:207], v[164:167]
    buffer_load_dwordx4 v29, s[36:39], s51 offen offset:1056 nt lds
    v_fma_f32 v63, v63, s60, v243
    v_mfma_f32_16x16x32_bf16 v[172:175], v[212:215], a[208:211], v[172:175]
    ds_read_b128 v[204:207], v12 offset:8512
    v_exp_f32 v60, v60
    v_mfma_f32_16x16x32_bf16 v[180:183], v[212:215], a[212:215], v[180:183]
    ds_read_b128 v[208:211], v12 offset:128
    v_exp_f32 v61, v61
    v_mfma_f32_16x16x32_bf16 v[188:191], v[212:215], a[216:219], v[188:191]
    v_exp_f32 v62, v62
    v_mfma_f32_16x16x32_bf16 v[116:119], v[216:219], a[220:223], v[116:119]
    ds_read_b128 v[212:215], v12 offset:8576
    v_exp_f32 v63, v63
    v_cvt_pk_bf16_f32 v228, v60, v61
    v_mfma_f32_16x16x32_bf16 v[124:127], v[216:219], a[224:227], v[124:127]
    v_cvt_pk_bf16_f32 v229, v62, v63
    v_accvgpr_write_b32 a32, v228
    v_accvgpr_write_b32 a33, v229
    v_mfma_f32_16x16x32_bf16 v[132:135], v[216:219], a[228:231], v[132:135]
    buffer_load_dwordx4 v30, s[36:39], s51 offen offset:2112 nt lds
    v_max3_f32 v26, v26, v100, v101
    v_mfma_f32_16x16x32_bf16 v[140:143], v[216:219], a[232:235], v[140:143]
    v_max3_f32 v26, v26, v102, v103
    v_fma_f32 v100, v100, s60, v243
    v_fma_f32 v101, v101, s60, v243
    v_mfma_f32_16x16x32_bf16 v[148:151], v[216:219], a[236:239], v[148:151]
    v_fma_f32 v102, v102, s60, v243
    v_fma_f32 v103, v103, s60, v243
    v_exp_f32 v100, v100
    v_mfma_f32_16x16x32_bf16 v[156:159], v[220:223], a[220:223], v[156:159]
    ds_read_b128 v[216:219], v12 offset:192
    v_exp_f32 v101, v101
    v_mfma_f32_16x16x32_bf16 v[164:167], v[220:223], a[224:227], v[164:167]
    v_exp_f32 v102, v102
    v_mfma_f32_16x16x32_bf16 v[172:175], v[220:223], a[228:231], v[172:175]
    v_exp_f32 v103, v103
    v_cvt_pk_bf16_f32 v230, v100, v101
    v_cvt_pk_bf16_f32 v231, v102, v103
    v_accvgpr_write_b32 a34, v230
    v_mfma_f32_16x16x32_bf16 v[180:183], v[220:223], a[232:235], v[180:183]
    buffer_load_dwordx4 v31, s[36:39], s51 offen offset:3168 nt lds
    v_accvgpr_write_b32 a35, v231
    v_mfma_f32_16x16x32_bf16 v[188:191], v[220:223], a[236:239], v[188:191]
    s_waitcnt lgkmcnt(5)
    v_max3_f32 v27, v27, v68, v69
    v_max3_f32 v27, v27, v70, v71
    v_fma_f32 v68, v68, s60, v244
    v_mfma_f32_16x16x32_bf16 v[36:39], v[192:195], v[32:35], 0
    ds_read_b128 v[220:223], v12 offset:8640
    v_mfma_f32_16x16x32_bf16 a[152:155], a[240:243], v[228:231], a[152:155]
    v_fma_f32 v69, v69, s60, v244
    v_fma_f32 v70, v70, s60, v244
    v_fma_f32 v71, v71, s60, v244
    v_exp_f32 v68, v68
    v_mfma_f32_16x16x32_bf16 v[44:47], v[192:195], v[40:43], 0
    v_exp_f32 v69, v69
    v_exp_f32 v70, v70
    v_mfma_f32_16x16x32_bf16 v[52:55], v[192:195], v[48:51], 0
    s_add_u32 s51, s51, 2048
    v_exp_f32 v71, v71
    v_cvt_pk_bf16_f32 v224, v68, v69
    v_cvt_pk_bf16_f32 v225, v70, v71
    v_accvgpr_write_b32 a36, v224
    v_mfma_f32_16x16x32_bf16 v[60:63], v[192:195], v[56:59], 0
    s_add_u32 m0, s49, 4224
    v_accvgpr_write_b32 a37, v225
    v_max3_f32 v27, v27, v108, v109
    v_max3_f32 v27, v27, v110, v111
    v_fma_f32 v108, v108, s60, v244
    v_mfma_f32_16x16x32_bf16 v[68:71], v[192:195], v[64:67], 0
    buffer_load_dwordx4 v28, s[36:39], s51 offen offset:0 nt lds
    v_fma_f32 v109, v109, s60, v244
    v_mfma_f32_16x16x32_bf16 v[76:79], v[196:199], v[32:35], 0
    ds_read_b128 v[192:195], v13 offset:0
    v_fma_f32 v110, v110, s60, v244
    v_fma_f32 v111, v111, s60, v244
    v_mfma_f32_16x16x32_bf16 v[84:87], v[196:199], v[40:43], 0
    v_exp_f32 v108, v108
    v_exp_f32 v109, v109
    v_exp_f32 v110, v110
    v_mfma_f32_16x16x32_bf16 v[92:95], v[196:199], v[48:51], 0
    v_exp_f32 v111, v111
    v_cvt_pk_bf16_f32 v226, v108, v109
    v_cvt_pk_bf16_f32 v227, v110, v111
    v_mfma_f32_16x16x32_bf16 v[100:103], v[196:199], v[56:59], 0
    v_accvgpr_write_b32 a38, v226
    v_accvgpr_write_b32 a39, v227
    v_mfma_f32_16x16x32_bf16 v[108:111], v[196:199], v[64:67], 0
    s_waitcnt lgkmcnt(5)
    s_nop 0
    v_mfma_f32_16x16x32_bf16 v[36:39], v[200:203], v[72:75], v[36:39]
    buffer_load_dwordx4 v29, s[36:39], s51 offen offset:1056 nt lds
    v_mfma_f32_16x16x32_bf16 a[156:159], a[240:243], v[224:227], a[156:159]
    ds_read_b128 v[196:199], v13 offset:8448
    v_max3_f32 v23, v23, v116, v117
    v_mfma_f32_16x16x32_bf16 v[44:47], v[200:203], v[80:83], v[44:47]
    v_max3_f32 v23, v23, v118, v119
    v_fma_f32 v116, v116, s60, v240
    v_fma_f32 v117, v117, s60, v240
    v_mfma_f32_16x16x32_bf16 v[52:55], v[200:203], v[88:91], v[52:55]
    v_fma_f32 v118, v118, s60, v240
    v_fma_f32 v119, v119, s60, v240
    v_mfma_f32_16x16x32_bf16 v[60:63], v[200:203], v[96:99], v[60:63]
    v_exp_f32 v116, v116
    v_mfma_f32_16x16x32_bf16 v[68:71], v[200:203], v[104:107], v[68:71]
    v_exp_f32 v117, v117
    v_mfma_f32_16x16x32_bf16 v[76:79], v[204:207], v[72:75], v[76:79]
    ds_read_b128 v[200:203], v13 offset:64
    v_mfma_f32_16x16x32_bf16 v[84:87], v[204:207], v[80:83], v[84:87]
    buffer_load_dwordx4 v30, s[36:39], s51 offen offset:2112 nt lds
    v_mfma_f32_16x16x32_bf16 v[92:95], v[204:207], v[88:91], v[92:95]
    v_exp_f32 v118, v118
    v_mfma_f32_16x16x32_bf16 v[100:103], v[204:207], v[96:99], v[100:103]
    v_exp_f32 v119, v119
    v_cvt_pk_bf16_f32 v224, v116, v117
    v_mfma_f32_16x16x32_bf16 v[108:111], v[204:207], v[104:107], v[108:111]
    s_waitcnt lgkmcnt(5)
    v_cvt_pk_bf16_f32 v225, v118, v119
    v_accvgpr_write_b32 a40, v224
    v_mfma_f32_16x16x32_bf16 v[36:39], v[208:211], v[112:115], v[36:39]
    s_add_u32 s51, s49, 7392
    v_add_u32 v251, s51, v18
    v_accvgpr_write_b32 a41, v225
    v_max3_f32 v23, v23, v156, v157
    v_mfma_f32_16x16x32_bf16 v[44:47], v[208:211], v[120:123], v[44:47]
    ds_read_b128 v[204:207], v13 offset:8512
    v_max3_f32 v23, v23, v158, v159
    v_mfma_f32_16x16x32_bf16 v[52:55], v[208:211], v[128:131], v[52:55]
    ds_write_b128 v251, a[80:83]
    v_mfma_f32_16x16x32_bf16 v[60:63], v[208:211], v[136:139], v[60:63]
    v_fma_f32 v156, v156, s60, v240
    v_fma_f32 v157, v157, s60, v240
    v_fma_f32 v158, v158, s60, v240
    v_mfma_f32_16x16x32_bf16 v[68:71], v[208:211], v[144:147], v[68:71]
    v_fma_f32 v159, v159, s60, v240
    v_mfma_f32_16x16x32_bf16 v[76:79], v[212:215], v[112:115], v[76:79]
    ds_read_b128 v[208:211], v13 offset:128
    v_mfma_f32_16x16x32_bf16 v[84:87], v[212:215], v[120:123], v[84:87]
    v_exp_f32 v156, v156
    v_mfma_f32_16x16x32_bf16 v[92:95], v[212:215], v[128:131], v[92:95]
    v_exp_f32 v157, v157
    v_mfma_f32_16x16x32_bf16 v[100:103], v[212:215], v[136:139], v[100:103]
    v_exp_f32 v158, v158
    v_mfma_f32_16x16x32_bf16 v[108:111], v[212:215], v[144:147], v[108:111]
    s_waitcnt lgkmcnt(6)
    v_exp_f32 v159, v159
    v_cvt_pk_bf16_f32 v226, v156, v157
    v_cvt_pk_bf16_f32 v227, v158, v159
    v_mfma_f32_16x16x32_bf16 v[36:39], v[216:219], v[152:155], v[36:39]
    ds_read_b128 v[212:215], v13 offset:8576
    v_accvgpr_write_b32 a42, v226
    v_mfma_f32_16x16x32_bf16 v[44:47], v[216:219], v[160:163], v[44:47]
    v_accvgpr_write_b32 a43, v227
    v_max3_f32 v24, v24, v124, v125
    v_mfma_f32_16x16x32_bf16 v[52:55], v[216:219], v[168:171], v[52:55]
    v_max3_f32 v24, v24, v126, v127
    v_fma_f32 v124, v124, s60, v241
    v_mfma_f32_16x16x32_bf16 v[60:63], v[216:219], v[176:179], v[60:63]
    v_mfma_f32_16x16x32_bf16 a[140:143], a[240:243], v[224:227], a[140:143]
    v_fma_f32 v125, v125, s60, v241
    v_fma_f32 v126, v126, s60, v241
    v_fma_f32 v127, v127, s60, v241
    v_mfma_f32_16x16x32_bf16 v[68:71], v[216:219], v[184:187], v[68:71]
    v_exp_f32 v124, v124
    v_mfma_f32_16x16x32_bf16 v[76:79], v[220:223], v[152:155], v[76:79]
    ds_read_b128 v[216:219], v13 offset:192
    v_exp_f32 v125, v125
    v_mfma_f32_16x16x32_bf16 v[84:87], v[220:223], v[160:163], v[84:87]
    v_exp_f32 v126, v126
    v_mfma_f32_16x16x32_bf16 v[92:95], v[220:223], v[168:171], v[92:95]
    v_exp_f32 v127, v127
    v_cvt_pk_bf16_f32 v228, v124, v125
    v_mfma_f32_16x16x32_bf16 v[100:103], v[220:223], v[176:179], v[100:103]
    v_cvt_pk_bf16_f32 v229, v126, v127
    v_accvgpr_write_b32 a44, v228
    v_mfma_f32_16x16x32_bf16 v[108:111], v[220:223], v[184:187], v[108:111]
    s_waitcnt lgkmcnt(6)
    v_accvgpr_write_b32 a45, v229
    v_max3_f32 v24, v24, v164, v165
    v_max3_f32 v24, v24, v166, v167
    v_mfma_f32_16x16x32_bf16 v[36:39], v[192:195], a[160:163], v[36:39]
    ds_read_b128 v[220:223], v13 offset:8640
    v_fma_f32 v164, v164, s60, v241
    v_mfma_f32_16x16x32_bf16 v[44:47], v[192:195], a[164:167], v[44:47]
    v_fma_f32 v165, v165, s60, v241
    v_fma_f32 v166, v166, s60, v241
    v_fma_f32 v167, v167, s60, v241
    v_mfma_f32_16x16x32_bf16 v[52:55], v[192:195], a[168:171], v[52:55]
    v_exp_f32 v164, v164
    v_mfma_f32_16x16x32_bf16 v[60:63], v[192:195], a[172:175], v[60:63]
    v_exp_f32 v165, v165
    v_mfma_f32_16x16x32_bf16 v[68:71], v[192:195], a[176:179], v[68:71]
    v_exp_f32 v166, v166
    v_mfma_f32_16x16x32_bf16 v[76:79], v[196:199], a[160:163], v[76:79]
    v_exp_f32 v167, v167
    v_cvt_pk_bf16_f32 v230, v164, v165
    v_mfma_f32_16x16x32_bf16 v[84:87], v[196:199], a[164:167], v[84:87]
    v_cvt_pk_bf16_f32 v231, v166, v167
    v_accvgpr_write_b32 a46, v230
    v_accvgpr_write_b32 a47, v231
    v_mfma_f32_16x16x32_bf16 v[92:95], v[196:199], a[168:171], v[92:95]
    v_max3_f32 v25, v25, v132, v133
    v_max3_f32 v25, v25, v134, v135
    v_mfma_f32_16x16x32_bf16 v[100:103], v[196:199], a[172:175], v[100:103]
    v_fma_f32 v132, v132, s60, v242
    v_mfma_f32_16x16x32_bf16 v[108:111], v[196:199], a[176:179], v[108:111]
    v_mfma_f32_16x16x32_bf16 a[144:147], a[240:243], v[228:231], a[144:147]
    s_waitcnt lgkmcnt(5)
    v_fma_f32 v133, v133, s60, v242
    v_fma_f32 v134, v134, s60, v242
    v_fma_f32 v135, v135, s60, v242
    v_mfma_f32_16x16x32_bf16 v[36:39], v[200:203], a[180:183], v[36:39]
    v_exp_f32 v132, v132
    v_mfma_f32_16x16x32_bf16 v[44:47], v[200:203], a[184:187], v[44:47]
    v_exp_f32 v133, v133
    v_exp_f32 v134, v134
    v_mfma_f32_16x16x32_bf16 v[52:55], v[200:203], a[188:191], v[52:55]
    v_exp_f32 v135, v135
    v_mfma_f32_16x16x32_bf16 v[60:63], v[200:203], a[192:195], v[60:63]
    v_cvt_pk_bf16_f32 v224, v132, v133
    v_cvt_pk_bf16_f32 v225, v134, v135
    v_accvgpr_write_b32 a48, v224
    v_mfma_f32_16x16x32_bf16 v[68:71], v[200:203], a[196:199], v[68:71]
    v_accvgpr_write_b32 a49, v225
    v_max3_f32 v25, v25, v172, v173
    v_mfma_f32_16x16x32_bf16 v[76:79], v[204:207], a[180:183], v[76:79]
    v_max3_f32 v25, v25, v174, v175
    v_fma_f32 v172, v172, s60, v242
    v_fma_f32 v173, v173, s60, v242
    v_mfma_f32_16x16x32_bf16 v[84:87], v[204:207], a[184:187], v[84:87]
    v_fma_f32 v174, v174, s60, v242
    v_fma_f32 v175, v175, s60, v242
    v_mfma_f32_16x16x32_bf16 v[92:95], v[204:207], a[188:191], v[92:95]
    v_exp_f32 v172, v172
    v_mfma_f32_16x16x32_bf16 v[100:103], v[204:207], a[192:195], v[100:103]
    v_exp_f32 v173, v173
    v_mfma_f32_16x16x32_bf16 v[108:111], v[204:207], a[196:199], v[108:111]
    v_exp_f32 v174, v174
    s_waitcnt vmcnt(7) lgkmcnt(0)
    s_waitcnt vmcnt(1)
    s_barrier
    v_mfma_f32_16x16x32_bf16 v[36:39], v[208:211], a[200:203], v[36:39]
    s_mov_b32 s51, 32768
    v_add_u32 v12, 67584, v7
    v_add_u32 v13, 67584, v8
    v_exp_f32 v175, v175
    v_cvt_pk_bf16_f32 v226, v172, v173
    v_mfma_f32_16x16x32_bf16 v[44:47], v[208:211], a[204:207], v[44:47]
    s_add_u32 m0, s49, 33792
    v_cvt_pk_bf16_f32 v227, v174, v175
    v_accvgpr_write_b32 a50, v226
    v_accvgpr_write_b32 a51, v227
    v_mfma_f32_16x16x32_bf16 v[52:55], v[208:211], a[208:211], v[52:55]
    buffer_load_dwordx4 v28, s[36:39], s51 offen offset:0 nt lds
    v_mfma_f32_16x16x32_bf16 v[60:63], v[208:211], a[212:215], v[60:63]
    ds_read_b128 v[192:195], v12 offset:0
    v_max3_f32 v26, v26, v140, v141
    v_max3_f32 v26, v26, v142, v143
    v_mfma_f32_16x16x32_bf16 v[68:71], v[208:211], a[216:219], v[68:71]
    ds_read_b128 v[196:199], v12 offset:8448
    v_fma_f32 v140, v140, s60, v243
    v_mfma_f32_16x16x32_bf16 v[76:79], v[212:215], a[200:203], v[76:79]
    ds_read_b128 v[200:203], v12 offset:64
    ds_read_b128 v[204:207], v12 offset:8512
    v_mfma_f32_16x16x32_bf16 a[148:151], a[240:243], v[224:227], a[148:151]
    ds_read_b128 v[208:211], v12 offset:128
    v_fma_f32 v141, v141, s60, v243
    v_fma_f32 v142, v142, s60, v243
    v_mfma_f32_16x16x32_bf16 v[84:87], v[212:215], a[204:207], v[84:87]
    buffer_load_dwordx4 v29, s[36:39], s51 offen offset:1056 nt lds
    v_fma_f32 v143, v143, s60, v243
    v_mfma_f32_16x16x32_bf16 v[92:95], v[212:215], a[208:211], v[92:95]
    v_exp_f32 v140, v140
    v_mfma_f32_16x16x32_bf16 v[100:103], v[212:215], a[212:215], v[100:103]
    v_exp_f32 v141, v141
    v_exp_f32 v142, v142
    v_mfma_f32_16x16x32_bf16 v[108:111], v[212:215], a[216:219], v[108:111]
    v_exp_f32 v143, v143
    v_cvt_pk_bf16_f32 v228, v140, v141
    v_mfma_f32_16x16x32_bf16 v[36:39], v[216:219], a[220:223], v[36:39]
    ds_read_b128 v[212:215], v12 offset:8576
    v_cvt_pk_bf16_f32 v229, v142, v143
    v_accvgpr_write_b32 a52, v228
    v_mfma_f32_16x16x32_bf16 v[44:47], v[216:219], a[224:227], v[44:47]
    v_accvgpr_write_b32 a53, v229
    v_max3_f32 v26, v26, v180, v181
    v_max3_f32 v26, v26, v182, v183
    v_mfma_f32_16x16x32_bf16 v[52:55], v[216:219], a[228:231], v[52:55]
    buffer_load_dwordx4 v30, s[36:39], s51 offen offset:2112 nt lds
    v_fma_f32 v180, v180, s60, v243
    v_mfma_f32_16x16x32_bf16 v[60:63], v[216:219], a[232:235], v[60:63]
    v_fma_f32 v181, v181, s60, v243
    v_fma_f32 v182, v182, s60, v243
    v_fma_f32 v183, v183, s60, v243
    v_mfma_f32_16x16x32_bf16 v[68:71], v[216:219], a[236:239], v[68:71]
    v_exp_f32 v180, v180
    v_mfma_f32_16x16x32_bf16 v[76:79], v[220:223], a[220:223], v[76:79]
    ds_read_b128 v[216:219], v12 offset:192
    v_exp_f32 v181, v181
    v_exp_f32 v182, v182
    v_mfma_f32_16x16x32_bf16 v[84:87], v[220:223], a[224:227], v[84:87]
    v_exp_f32 v183, v183
    v_cvt_pk_bf16_f32 v230, v180, v181
    v_mfma_f32_16x16x32_bf16 v[92:95], v[220:223], a[228:231], v[92:95]
    v_cvt_pk_bf16_f32 v231, v182, v183
    v_accvgpr_write_b32 a54, v230
    v_accvgpr_write_b32 a55, v231
    v_mfma_f32_16x16x32_bf16 v[100:103], v[220:223], a[232:235], v[100:103]
    buffer_load_dwordx4 v31, s[36:39], s51 offen offset:3168 nt lds
    v_max3_f32 v27, v27, v148, v149
    v_mfma_f32_16x16x32_bf16 v[108:111], v[220:223], a[236:239], v[108:111]
    s_waitcnt lgkmcnt(5)
    v_max3_f32 v27, v27, v150, v151
    v_fma_f32 v148, v148, s60, v244
    v_mfma_f32_16x16x32_bf16 v[116:119], v[192:195], v[32:35], 0
    ds_read_b128 v[220:223], v12 offset:8640
    v_mfma_f32_16x16x32_bf16 a[152:155], a[240:243], v[228:231], a[152:155]
    v_fma_f32 v149, v149, s60, v244
    v_fma_f32 v150, v150, s60, v244
    v_fma_f32 v151, v151, s60, v244
    v_exp_f32 v148, v148
    v_exp_f32 v149, v149
    v_mfma_f32_16x16x32_bf16 v[124:127], v[192:195], v[40:43], 0
    v_exp_f32 v150, v150
    v_exp_f32 v151, v151
    v_mfma_f32_16x16x32_bf16 v[132:135], v[192:195], v[48:51], 0
    s_add_u32 s51, s51, 2048
    v_cvt_pk_bf16_f32 v224, v148, v149
    v_cvt_pk_bf16_f32 v225, v150, v151
    v_accvgpr_write_b32 a56, v224
    v_mfma_f32_16x16x32_bf16 v[140:143], v[192:195], v[56:59], 0
    s_add_u32 m0, s49, 38016
    v_accvgpr_write_b32 a57, v225
    v_max3_f32 v27, v27, v188, v189
    v_max3_f32 v27, v27, v190, v191
    v_fma_f32 v188, v188, s60, v244
    v_mfma_f32_16x16x32_bf16 v[148:151], v[192:195], v[64:67], 0
    buffer_load_dwordx4 v28, s[36:39], s51 offen offset:0 nt lds
    v_fma_f32 v189, v189, s60, v244
    v_mfma_f32_16x16x32_bf16 v[156:159], v[196:199], v[32:35], 0
    ds_read_b128 v[192:195], v13 offset:0
    v_fma_f32 v190, v190, s60, v244
    v_fma_f32 v191, v191, s60, v244
    v_mfma_f32_16x16x32_bf16 v[164:167], v[196:199], v[40:43], 0
    v_exp_f32 v188, v188
    v_exp_f32 v189, v189
    v_exp_f32 v190, v190
    v_mfma_f32_16x16x32_bf16 v[172:175], v[196:199], v[48:51], 0
    v_exp_f32 v191, v191
    v_cvt_pk_bf16_f32 v226, v188, v189
    v_cvt_pk_bf16_f32 v227, v190, v191
    v_mfma_f32_16x16x32_bf16 v[180:183], v[196:199], v[56:59], 0
    v_accvgpr_write_b32 a58, v226
    v_accvgpr_write_b32 a59, v227
    v_mfma_f32_16x16x32_bf16 v[188:191], v[196:199], v[64:67], 0
    s_waitcnt lgkmcnt(5)
    s_nop 0
    v_mfma_f32_16x16x32_bf16 v[116:119], v[200:203], v[72:75], v[116:119]
    buffer_load_dwordx4 v29, s[36:39], s51 offen offset:1056 nt lds
    v_mfma_f32_16x16x32_bf16 a[156:159], a[240:243], v[224:227], a[156:159]
    ds_read_b128 v[196:199], v13 offset:8448
    v_max3_f32 v23, v23, v36, v37
    v_mfma_f32_16x16x32_bf16 v[124:127], v[200:203], v[80:83], v[124:127]
    v_max3_f32 v23, v23, v38, v39
    v_fma_f32 v36, v36, s60, v240
    v_fma_f32 v37, v37, s60, v240
    v_mfma_f32_16x16x32_bf16 v[132:135], v[200:203], v[88:91], v[132:135]
    v_fma_f32 v38, v38, s60, v240
    v_fma_f32 v39, v39, s60, v240
    v_mfma_f32_16x16x32_bf16 v[140:143], v[200:203], v[96:99], v[140:143]
    v_exp_f32 v36, v36
    v_mfma_f32_16x16x32_bf16 v[148:151], v[200:203], v[104:107], v[148:151]
    v_exp_f32 v37, v37
    v_mfma_f32_16x16x32_bf16 v[156:159], v[204:207], v[72:75], v[156:159]
    ds_read_b128 v[200:203], v13 offset:64
    v_mfma_f32_16x16x32_bf16 v[164:167], v[204:207], v[80:83], v[164:167]
    buffer_load_dwordx4 v30, s[36:39], s51 offen offset:2112 nt lds
    v_mfma_f32_16x16x32_bf16 v[172:175], v[204:207], v[88:91], v[172:175]
    v_exp_f32 v38, v38
    v_mfma_f32_16x16x32_bf16 v[180:183], v[204:207], v[96:99], v[180:183]
    v_exp_f32 v39, v39
    v_cvt_pk_bf16_f32 v224, v36, v37
    v_mfma_f32_16x16x32_bf16 v[188:191], v[204:207], v[104:107], v[188:191]
    s_waitcnt lgkmcnt(5)
    v_cvt_pk_bf16_f32 v225, v38, v39
    v_accvgpr_write_b32 a60, v224
    v_mfma_f32_16x16x32_bf16 v[116:119], v[208:211], v[112:115], v[116:119]
    s_add_u32 s51, s49, 41184
    v_add_u32 v251, s51, v18
    v_accvgpr_write_b32 a61, v225
    v_max3_f32 v23, v23, v76, v77
    v_mfma_f32_16x16x32_bf16 v[124:127], v[208:211], v[120:123], v[124:127]
    ds_read_b128 v[204:207], v13 offset:8512
    v_max3_f32 v23, v23, v78, v79
    v_mfma_f32_16x16x32_bf16 v[132:135], v[208:211], v[128:131], v[132:135]
    ds_write_b128 v251, a[84:87]
    v_mfma_f32_16x16x32_bf16 v[140:143], v[208:211], v[136:139], v[140:143]
    v_fma_f32 v76, v76, s60, v240
    v_fma_f32 v77, v77, s60, v240
    v_fma_f32 v78, v78, s60, v240
    v_mfma_f32_16x16x32_bf16 v[148:151], v[208:211], v[144:147], v[148:151]
    v_fma_f32 v79, v79, s60, v240
    v_mfma_f32_16x16x32_bf16 v[156:159], v[212:215], v[112:115], v[156:159]
    ds_read_b128 v[208:211], v13 offset:128
    v_mfma_f32_16x16x32_bf16 v[164:167], v[212:215], v[120:123], v[164:167]
    v_exp_f32 v76, v76
    v_mfma_f32_16x16x32_bf16 v[172:175], v[212:215], v[128:131], v[172:175]
    v_exp_f32 v77, v77
    v_mfma_f32_16x16x32_bf16 v[180:183], v[212:215], v[136:139], v[180:183]
    v_exp_f32 v78, v78
    v_mfma_f32_16x16x32_bf16 v[188:191], v[212:215], v[144:147], v[188:191]
    s_waitcnt lgkmcnt(6)
    v_exp_f32 v79, v79
    v_cvt_pk_bf16_f32 v226, v76, v77
    v_cvt_pk_bf16_f32 v227, v78, v79
    v_mfma_f32_16x16x32_bf16 v[116:119], v[216:219], v[152:155], v[116:119]
    ds_read_b128 v[212:215], v13 offset:8576
    v_accvgpr_write_b32 a62, v226
    v_mfma_f32_16x16x32_bf16 v[124:127], v[216:219], v[160:163], v[124:127]
    v_accvgpr_write_b32 a63, v227
    v_max3_f32 v24, v24, v44, v45
    v_mfma_f32_16x16x32_bf16 v[132:135], v[216:219], v[168:171], v[132:135]
    v_max3_f32 v24, v24, v46, v47
    v_fma_f32 v44, v44, s60, v241
    v_mfma_f32_16x16x32_bf16 v[140:143], v[216:219], v[176:179], v[140:143]
    v_mfma_f32_16x16x32_bf16 a[140:143], a[240:243], v[224:227], a[140:143]
    v_fma_f32 v45, v45, s60, v241
    v_fma_f32 v46, v46, s60, v241
    v_fma_f32 v47, v47, s60, v241
    v_mfma_f32_16x16x32_bf16 v[148:151], v[216:219], v[184:187], v[148:151]
    v_exp_f32 v44, v44
    v_mfma_f32_16x16x32_bf16 v[156:159], v[220:223], v[152:155], v[156:159]
    ds_read_b128 v[216:219], v13 offset:192
    v_exp_f32 v45, v45
    v_mfma_f32_16x16x32_bf16 v[164:167], v[220:223], v[160:163], v[164:167]
    v_exp_f32 v46, v46
    v_mfma_f32_16x16x32_bf16 v[172:175], v[220:223], v[168:171], v[172:175]
    v_exp_f32 v47, v47
    v_cvt_pk_bf16_f32 v228, v44, v45
    v_mfma_f32_16x16x32_bf16 v[180:183], v[220:223], v[176:179], v[180:183]
    v_cvt_pk_bf16_f32 v229, v46, v47
    v_accvgpr_write_b32 a64, v228
    v_mfma_f32_16x16x32_bf16 v[188:191], v[220:223], v[184:187], v[188:191]
    s_waitcnt lgkmcnt(6)
    v_accvgpr_write_b32 a65, v229
    v_max3_f32 v24, v24, v84, v85
    v_max3_f32 v24, v24, v86, v87
    v_mfma_f32_16x16x32_bf16 v[116:119], v[192:195], a[160:163], v[116:119]
    ds_read_b128 v[220:223], v13 offset:8640
    v_fma_f32 v84, v84, s60, v241
    v_mfma_f32_16x16x32_bf16 v[124:127], v[192:195], a[164:167], v[124:127]
    v_fma_f32 v85, v85, s60, v241
    v_fma_f32 v86, v86, s60, v241
    v_fma_f32 v87, v87, s60, v241
    v_mfma_f32_16x16x32_bf16 v[132:135], v[192:195], a[168:171], v[132:135]
    v_exp_f32 v84, v84
    v_mfma_f32_16x16x32_bf16 v[140:143], v[192:195], a[172:175], v[140:143]
    v_exp_f32 v85, v85
    v_mfma_f32_16x16x32_bf16 v[148:151], v[192:195], a[176:179], v[148:151]
    v_exp_f32 v86, v86
    v_mfma_f32_16x16x32_bf16 v[156:159], v[196:199], a[160:163], v[156:159]
    v_exp_f32 v87, v87
    v_cvt_pk_bf16_f32 v230, v84, v85
    v_mfma_f32_16x16x32_bf16 v[164:167], v[196:199], a[164:167], v[164:167]
    v_cvt_pk_bf16_f32 v231, v86, v87
    v_accvgpr_write_b32 a66, v230
    v_accvgpr_write_b32 a67, v231
    v_mfma_f32_16x16x32_bf16 v[172:175], v[196:199], a[168:171], v[172:175]
    v_max3_f32 v25, v25, v52, v53
    v_max3_f32 v25, v25, v54, v55
    v_mfma_f32_16x16x32_bf16 v[180:183], v[196:199], a[172:175], v[180:183]
    v_fma_f32 v52, v52, s60, v242
    v_mfma_f32_16x16x32_bf16 v[188:191], v[196:199], a[176:179], v[188:191]
    v_mfma_f32_16x16x32_bf16 a[144:147], a[240:243], v[228:231], a[144:147]
    s_waitcnt lgkmcnt(5)
    v_fma_f32 v53, v53, s60, v242
    v_fma_f32 v54, v54, s60, v242
    v_fma_f32 v55, v55, s60, v242
    v_mfma_f32_16x16x32_bf16 v[116:119], v[200:203], a[180:183], v[116:119]
    v_exp_f32 v52, v52
    v_mfma_f32_16x16x32_bf16 v[124:127], v[200:203], a[184:187], v[124:127]
    v_exp_f32 v53, v53
    v_exp_f32 v54, v54
    v_mfma_f32_16x16x32_bf16 v[132:135], v[200:203], a[188:191], v[132:135]
    v_exp_f32 v55, v55
    v_mfma_f32_16x16x32_bf16 v[140:143], v[200:203], a[192:195], v[140:143]
    v_cvt_pk_bf16_f32 v224, v52, v53
    v_cvt_pk_bf16_f32 v225, v54, v55
    v_accvgpr_write_b32 a68, v224
    v_mfma_f32_16x16x32_bf16 v[148:151], v[200:203], a[196:199], v[148:151]
    v_accvgpr_write_b32 a69, v225
    v_max3_f32 v25, v25, v92, v93
    v_mfma_f32_16x16x32_bf16 v[156:159], v[204:207], a[180:183], v[156:159]
    v_max3_f32 v25, v25, v94, v95
    v_fma_f32 v92, v92, s60, v242
    v_fma_f32 v93, v93, s60, v242
    v_mfma_f32_16x16x32_bf16 v[164:167], v[204:207], a[184:187], v[164:167]
    v_fma_f32 v94, v94, s60, v242
    v_fma_f32 v95, v95, s60, v242
    v_mfma_f32_16x16x32_bf16 v[172:175], v[204:207], a[188:191], v[172:175]
    v_exp_f32 v92, v92
    v_mfma_f32_16x16x32_bf16 v[180:183], v[204:207], a[192:195], v[180:183]
    v_exp_f32 v93, v93
    v_mfma_f32_16x16x32_bf16 v[188:191], v[204:207], a[196:199], v[188:191]
    v_exp_f32 v94, v94
    v_exp_f32 v95, v95
    s_waitcnt vmcnt(7) lgkmcnt(0)
    s_waitcnt vmcnt(1)
    s_barrier
    v_mfma_f32_16x16x32_bf16 v[116:119], v[208:211], a[200:203], v[116:119]
    s_mov_b32 s51, 65536
    v_add_u32 v12, 0, v9
    v_cvt_pk_bf16_f32 v226, v92, v93
    v_cvt_pk_bf16_f32 v227, v94, v95
    v_accvgpr_write_b32 a70, v226
    v_mfma_f32_16x16x32_bf16 v[124:127], v[208:211], a[204:207], v[124:127]
    s_add_u32 m0, s49, 67584
    v_accvgpr_write_b32 a71, v227
    v_max3_f32 v26, v26, v60, v61
    v_mfma_f32_16x16x32_bf16 v[132:135], v[208:211], a[208:211], v[132:135]
    buffer_load_dwordx4 v28, s[36:39], s51 offen offset:0 nt lds
    v_max3_f32 v26, v26, v62, v63
    v_mfma_f32_16x16x32_bf16 v[140:143], v[208:211], a[212:215], v[140:143]
    ds_read_b64_tr_b16 v[192:193], v12 offset:0
    ds_read_b64_tr_b16 v[194:195], v12 offset:8448
    v_mfma_f32_16x16x32_bf16 v[148:151], v[208:211], a[216:219], v[148:151]
    ds_read_b64_tr_b16 v[196:197], v12 offset:32
    ds_read_b64_tr_b16 v[198:199], v12 offset:8480
    v_fma_f32 v60, v60, s60, v243
    v_mfma_f32_16x16x32_bf16 v[156:159], v[212:215], a[200:203], v[156:159]
    ds_read_b128 a[100:103], v16 offset:0
    ds_read_b128 a[104:107], v16 offset:1024
    v_mfma_f32_16x16x32_bf16 a[148:151], a[240:243], v[224:227], a[148:151]
    ds_read_b128 a[108:111], v16 offset:2048
    v_fma_f32 v61, v61, s60, v243
    v_fma_f32 v62, v62, s60, v243
    v_mfma_f32_16x16x32_bf16 v[164:167], v[212:215], a[204:207], v[164:167]
    ds_read_b128 a[112:115], v16 offset:3072
    v_fma_f32 v63, v63, s60, v243
    v_mfma_f32_16x16x32_bf16 v[172:175], v[212:215], a[208:211], v[172:175]
    ds_read_b128 a[116:119], v16 offset:4096
    v_exp_f32 v60, v60
    v_mfma_f32_16x16x32_bf16 v[180:183], v[212:215], a[212:215], v[180:183]
    buffer_load_dwordx4 v29, s[36:39], s51 offen offset:1056 nt lds
    v_exp_f32 v61, v61
    v_mfma_f32_16x16x32_bf16 v[188:191], v[212:215], a[216:219], v[188:191]
    v_exp_f32 v62, v62
    v_exp_f32 v63, v63
    v_mfma_f32_16x16x32_bf16 v[116:119], v[216:219], a[220:223], v[116:119]
    ds_read_b64_tr_b16 v[200:201], v12 offset:64
    ds_read_b64_tr_b16 v[202:203], v12 offset:8512
    v_cvt_pk_bf16_f32 v228, v60, v61
    v_mfma_f32_16x16x32_bf16 v[124:127], v[216:219], a[224:227], v[124:127]
    ds_read_b64_tr_b16 v[204:205], v12 offset:96
    ds_read_b64_tr_b16 v[206:207], v12 offset:8544
    v_mfma_f32_16x16x32_bf16 v[132:135], v[216:219], a[228:231], v[132:135]
    buffer_load_dwordx4 v30, s[36:39], s51 offen offset:2112 nt lds
    v_cvt_pk_bf16_f32 v229, v62, v63
    v_accvgpr_write_b32 a72, v228
    v_mfma_f32_16x16x32_bf16 v[140:143], v[216:219], a[232:235], v[140:143]
    ds_read_b64_tr_b16 v[208:209], v12 offset:128
    ds_read_b64_tr_b16 v[210:211], v12 offset:8576
    v_mfma_f32_16x16x32_bf16 v[148:151], v[216:219], a[236:239], v[148:151]
    ds_read_b64_tr_b16 v[212:213], v12 offset:192
    ds_read_b64_tr_b16 v[214:215], v12 offset:8640
    v_accvgpr_write_b32 a73, v229
    v_mfma_f32_16x16x32_bf16 v[156:159], v[220:223], a[220:223], v[156:159]
    ds_read_b128 a[120:123], v16 offset:5120
    v_max3_f32 v26, v26, v100, v101
    v_max3_f32 v26, v26, v102, v103
    v_fma_f32 v100, v100, s60, v243
    v_mfma_f32_16x16x32_bf16 v[164:167], v[220:223], a[224:227], v[164:167]
    ds_read_b128 a[124:127], v16 offset:6144
    v_fma_f32 v101, v101, s60, v243
    v_fma_f32 v102, v102, s60, v243
    v_fma_f32 v103, v103, s60, v243
    v_mfma_f32_16x16x32_bf16 v[172:175], v[220:223], a[228:231], v[172:175]
    ds_read_b128 a[128:131], v16 offset:7168
    v_exp_f32 v100, v100
    v_mfma_f32_16x16x32_bf16 v[180:183], v[220:223], a[232:235], v[180:183]
    buffer_load_dwordx4 v31, s[36:39], s51 offen offset:3168 nt lds
    v_exp_f32 v101, v101
    v_mfma_f32_16x16x32_bf16 v[188:191], v[220:223], a[236:239], v[188:191]
    s_waitcnt lgkmcnt(11)
    v_exp_f32 v102, v102
    v_exp_f32 v103, v103
    v_cvt_pk_bf16_f32 v230, v100, v101
    v_cvt_pk_bf16_f32 v231, v102, v103
    v_mfma_f32_16x16x32_bf16 v[32:35], v[192:195], a[100:103], 0
    ds_read_b128 a[132:135], v16 offset:8192
    v_accvgpr_write_b32 a74, v230
    v_accvgpr_write_b32 a75, v231
    v_max3_f32 v27, v27, v68, v69
    v_mfma_f32_16x16x32_bf16 v[40:43], v[192:195], a[104:107], 0
    ds_read_b128 a[136:139], v16 offset:9216
    v_max3_f32 v27, v27, v70, v71
    v_fma_f32 v68, v68, s60, v244
    v_mfma_f32_16x16x32_bf16 v[48:51], v[192:195], a[108:111], 0
    s_add_u32 s51, s51, 2048
    s_add_u32 m0, s49, 71808
    ds_read_b64_tr_b16 v[216:217], v12 offset:16896
    ds_read_b64_tr_b16 v[218:219], v12 offset:25344
    ds_read_b64_tr_b16 v[220:221], v12 offset:16928
    ds_read_b64_tr_b16 v[222:223], v12 offset:25376
    v_mfma_f32_16x16x32_bf16 a[152:155], a[240:243], v[228:231], a[152:155]
    v_fma_f32 v69, v69, s60, v244
    v_fma_f32 v70, v70, s60, v244
    v_fma_f32 v71, v71, s60, v244
    v_exp_f32 v68, v68
    v_exp_f32 v69, v69
    v_exp_f32 v70, v70
    v_exp_f32 v71, v71
    v_cvt_pk_bf16_f32 v224, v68, v69
    v_cvt_pk_bf16_f32 v225, v70, v71
    v_mfma_f32_16x16x32_bf16 v[56:59], v[192:195], a[112:115], 0
    v_accvgpr_write_b32 a76, v224
    v_accvgpr_write_b32 a77, v225
    v_max3_f32 v27, v27, v108, v109
    v_mfma_f32_16x16x32_bf16 v[64:67], v[192:195], a[116:119], 0
    buffer_load_dwordx4 v28, s[36:39], s51 offen offset:0 nt lds
    v_max3_f32 v27, v27, v110, v111
    v_fma_f32 v108, v108, s60, v244
    v_mfma_f32_16x16x32_bf16 v[36:39], v[196:199], a[100:103], 0
    ds_read_b64_tr_b16 v[192:193], v12 offset:16960
    ds_read_b64_tr_b16 v[194:195], v12 offset:25408
    v_fma_f32 v109, v109, s60, v244
    v_mfma_f32_16x16x32_bf16 v[44:47], v[196:199], a[104:107], 0
    v_fma_f32 v110, v110, s60, v244
    v_fma_f32 v111, v111, s60, v244
    v_exp_f32 v108, v108
    v_exp_f32 v109, v109
    v_mfma_f32_16x16x32_bf16 v[52:55], v[196:199], a[108:111], 0
    v_exp_f32 v110, v110
    v_exp_f32 v111, v111
    v_cvt_pk_bf16_f32 v226, v108, v109
    v_cvt_pk_bf16_f32 v227, v110, v111
    v_mfma_f32_16x16x32_bf16 v[60:63], v[196:199], a[112:115], 0
    v_accvgpr_write_b32 a78, v226
    v_accvgpr_write_b32 a79, v227
    s_nop 0
    v_mfma_f32_16x16x32_bf16 v[68:71], v[196:199], a[116:119], 0
    v_mfma_f32_16x16x32_bf16 a[156:159], a[240:243], v[224:227], a[156:159]
    s_waitcnt lgkmcnt(15)
    v_accvgpr_mov_b32 a200, a88
    v_accvgpr_mov_b32 a201, a89
    v_accvgpr_mov_b32 a202, a90
    v_accvgpr_mov_b32 a203, a91
    v_accvgpr_mov_b32 a204, a92
    v_accvgpr_mov_b32 a205, a93
    v_accvgpr_mov_b32 a206, a94
    v_accvgpr_mov_b32 a207, a95
    v_accvgpr_mov_b32 a208, a96
    v_mfma_f32_16x16x32_bf16 v[72:75], v[200:203], a[100:103], 0
    buffer_load_dwordx4 v29, s[36:39], s51 offen offset:1056 nt lds
    v_accvgpr_mov_b32 a209, a97
    v_accvgpr_mov_b32 a210, a98
    v_accvgpr_mov_b32 a211, a99
    v_mfma_f32_16x16x32_bf16 v[80:83], v[200:203], a[104:107], 0
    ds_read_b64_tr_b16 v[196:197], v12 offset:16992
    ds_read_b64_tr_b16 v[198:199], v12 offset:25440
    v_mfma_f32_16x16x32_bf16 v[88:91], v[200:203], a[108:111], 0
    v_max3_f32 v23, v23, v116, v117
    v_max3_f32 v23, v23, v118, v119
    v_fma_f32 v116, v116, s60, v240
    v_mfma_f32_16x16x32_bf16 v[96:99], v[200:203], a[112:115], 0
    v_fma_f32 v117, v117, s60, v240
    v_fma_f32 v118, v118, s60, v240
    v_fma_f32 v119, v119, s60, v240
    v_mfma_f32_16x16x32_bf16 v[104:107], v[200:203], a[116:119], 0
    v_exp_f32 v116, v116
    v_mfma_f32_16x16x32_bf16 v[76:79], v[204:207], a[100:103], 0
    ds_read_b64_tr_b16 v[200:201], v12 offset:17024
    ds_read_b64_tr_b16 v[202:203], v12 offset:25472
    v_mfma_f32_16x16x32_bf16 v[84:87], v[204:207], a[104:107], 0
    buffer_load_dwordx4 v30, s[36:39], s51 offen offset:2112 nt lds
    v_exp_f32 v117, v117
    v_mfma_f32_16x16x32_bf16 v[92:95], v[204:207], a[108:111], 0
    v_exp_f32 v118, v118
    v_mfma_f32_16x16x32_bf16 v[100:103], v[204:207], a[112:115], 0
    v_exp_f32 v119, v119
    v_cvt_pk_bf16_f32 v224, v116, v117
    v_cvt_pk_bf16_f32 v225, v118, v119
    v_mfma_f32_16x16x32_bf16 v[108:111], v[204:207], a[116:119], 0
    s_waitcnt lgkmcnt(15)
    v_accvgpr_write_b32 a80, v224
    v_accvgpr_write_b32 a81, v225
    v_max3_f32 v23, v23, v156, v157
    v_mfma_f32_16x16x32_bf16 v[112:115], v[208:211], a[100:103], 0
    s_add_u32 s51, s49, 74976
    v_add_u32 v251, s51, v18
    v_max3_f32 v23, v23, v158, v159
    v_fma_f32 v156, v156, s60, v240
    v_mfma_f32_16x16x32_bf16 v[120:123], v[208:211], a[104:107], 0
    ds_read_b64_tr_b16 v[204:205], v12 offset:17088
    ds_read_b64_tr_b16 v[206:207], v12 offset:25536
    v_fma_f32 v157, v157, s60, v240
    v_mfma_f32_16x16x32_bf16 v[128:131], v[208:211], a[108:111], 0
    ds_write_b128 v251, a[200:203]
    v_fma_f32 v158, v158, s60, v240
    v_mfma_f32_16x16x32_bf16 v[136:139], v[208:211], a[112:115], 0
    v_fma_f32 v159, v159, s60, v240
    v_exp_f32 v156, v156
    v_mfma_f32_16x16x32_bf16 v[144:147], v[208:211], a[116:119], 0
    v_exp_f32 v157, v157
    v_mfma_f32_16x16x32_bf16 v[152:155], v[212:215], a[100:103], 0
    ds_read_b64_tr_b16 v[208:209], v12 offset:160
    ds_read_b64_tr_b16 v[210:211], v12 offset:8608
    v_mfma_f32_16x16x32_bf16 v[160:163], v[212:215], a[104:107], 0
    v_exp_f32 v158, v158
    v_exp_f32 v159, v159
    v_cvt_pk_bf16_f32 v226, v156, v157
    v_mfma_f32_16x16x32_bf16 v[168:171], v[212:215], a[108:111], 0
    v_cvt_pk_bf16_f32 v227, v158, v159
    v_accvgpr_write_b32 a82, v226
    v_accvgpr_write_b32 a83, v227
    v_mfma_f32_16x16x32_bf16 v[176:179], v[212:215], a[112:115], 0
    v_max3_f32 v24, v24, v124, v125
    v_max3_f32 v24, v24, v126, v127
    v_fma_f32 v124, v124, s60, v241
    v_mfma_f32_16x16x32_bf16 v[184:187], v[212:215], a[116:119], 0
    v_mfma_f32_16x16x32_bf16 a[140:143], a[240:243], v[224:227], a[140:143]
    s_waitcnt lgkmcnt(11)
    v_fma_f32 v125, v125, s60, v241
    v_fma_f32 v126, v126, s60, v241
    v_fma_f32 v127, v127, s60, v241
    v_exp_f32 v124, v124
    v_mfma_f32_16x16x32_bf16 v[32:35], v[216:219], a[120:123], v[32:35]
    ds_read_b64_tr_b16 v[212:213], v12 offset:224
    ds_read_b64_tr_b16 v[214:215], v12 offset:8672
    v_mfma_f32_16x16x32_bf16 v[40:43], v[216:219], a[124:127], v[40:43]
    v_exp_f32 v125, v125
    v_mfma_f32_16x16x32_bf16 v[48:51], v[216:219], a[128:131], v[48:51]
    v_exp_f32 v126, v126
    v_exp_f32 v127, v127
    v_cvt_pk_bf16_f32 v228, v124, v125
    v_mfma_f32_16x16x32_bf16 v[56:59], v[216:219], a[132:135], v[56:59]
    v_cvt_pk_bf16_f32 v229, v126, v127
    v_accvgpr_write_b32 a84, v228
    v_accvgpr_write_b32 a85, v229
    v_mfma_f32_16x16x32_bf16 v[64:67], v[216:219], a[136:139], v[64:67]
    v_max3_f32 v24, v24, v164, v165
    v_max3_f32 v24, v24, v166, v167
    v_fma_f32 v164, v164, s60, v241
    v_fma_f32 v165, v165, s60, v241
    v_mfma_f32_16x16x32_bf16 v[36:39], v[220:223], a[120:123], v[36:39]
    ds_read_b64_tr_b16 v[216:217], v12 offset:17056
    ds_read_b64_tr_b16 v[218:219], v12 offset:25504
    v_mfma_f32_16x16x32_bf16 v[44:47], v[220:223], a[124:127], v[44:47]
    v_fma_f32 v166, v166, s60, v241
    v_fma_f32 v167, v167, s60, v241
    v_mfma_f32_16x16x32_bf16 v[52:55], v[220:223], a[128:131], v[52:55]
    v_exp_f32 v164, v164
    v_exp_f32 v165, v165
    v_mfma_f32_16x16x32_bf16 v[60:63], v[220:223], a[132:135], v[60:63]
    v_exp_f32 v166, v166
    v_exp_f32 v167, v167
    v_mfma_f32_16x16x32_bf16 v[68:71], v[220:223], a[136:139], v[68:71]
    s_waitcnt lgkmcnt(11)
    v_cvt_pk_bf16_f32 v230, v164, v165
    v_cvt_pk_bf16_f32 v231, v166, v167
    v_accvgpr_write_b32 a86, v230
    v_accvgpr_write_b32 a87, v231
    v_mfma_f32_16x16x32_bf16 v[72:75], v[192:195], a[120:123], v[72:75]
    ds_read_b64_tr_b16 v[220:221], v12 offset:17120
    ds_read_b64_tr_b16 v[222:223], v12 offset:25568
    v_mfma_f32_16x16x32_bf16 v[80:83], v[192:195], a[124:127], v[80:83]
    v_max3_f32 v25, v25, v132, v133
    v_max3_f32 v25, v25, v134, v135
    v_fma_f32 v132, v132, s60, v242
    v_mfma_f32_16x16x32_bf16 v[88:91], v[192:195], a[128:131], v[88:91]
    v_mfma_f32_16x16x32_bf16 a[144:147], a[240:243], v[228:231], a[144:147]
    v_fma_f32 v133, v133, s60, v242
    v_fma_f32 v134, v134, s60, v242
    v_fma_f32 v135, v135, s60, v242
    v_exp_f32 v132, v132
    v_mfma_f32_16x16x32_bf16 v[96:99], v[192:195], a[132:135], v[96:99]
    v_exp_f32 v133, v133
    v_exp_f32 v134, v134
    v_mfma_f32_16x16x32_bf16 v[104:107], v[192:195], a[136:139], v[104:107]
    v_exp_f32 v135, v135
    v_cvt_pk_bf16_f32 v224, v132, v133
    v_cvt_pk_bf16_f32 v225, v134, v135
    v_mfma_f32_16x16x32_bf16 v[76:79], v[196:199], a[120:123], v[76:79]
    v_accvgpr_write_b32 a88, v224
    v_accvgpr_write_b32 a89, v225
    v_max3_f32 v25, v25, v172, v173
    v_max3_f32 v25, v25, v174, v175
    v_mfma_f32_16x16x32_bf16 v[84:87], v[196:199], a[124:127], v[84:87]
    v_fma_f32 v172, v172, s60, v242
    v_fma_f32 v173, v173, s60, v242
    v_fma_f32 v174, v174, s60, v242
    v_fma_f32 v175, v175, s60, v242
    v_mfma_f32_16x16x32_bf16 v[92:95], v[196:199], a[128:131], v[92:95]
    v_exp_f32 v172, v172
    v_mfma_f32_16x16x32_bf16 v[100:103], v[196:199], a[132:135], v[100:103]
    v_exp_f32 v173, v173
    v_exp_f32 v174, v174
    v_mfma_f32_16x16x32_bf16 v[108:111], v[196:199], a[136:139], v[108:111]
    s_waitcnt lgkmcnt(9)
    v_exp_f32 v175, v175
    v_cvt_pk_bf16_f32 v226, v172, v173
    v_cvt_pk_bf16_f32 v227, v174, v175
    v_mfma_f32_16x16x32_bf16 v[112:115], v[200:203], a[120:123], v[112:115]
    v_accvgpr_write_b32 a90, v226
    v_accvgpr_write_b32 a91, v227
    v_max3_f32 v26, v26, v140, v141
    v_max3_f32 v26, v26, v142, v143
    v_mfma_f32_16x16x32_bf16 v[120:123], v[200:203], a[124:127], v[120:123]
    v_fma_f32 v140, v140, s60, v243
    v_mfma_f32_16x16x32_bf16 v[128:131], v[200:203], a[128:131], v[128:131]
    v_mfma_f32_16x16x32_bf16 a[148:151], a[240:243], v[224:227], a[148:151]
    v_fma_f32 v141, v141, s60, v243
    v_fma_f32 v142, v142, s60, v243
    v_fma_f32 v143, v143, s60, v243
    v_exp_f32 v140, v140
    v_exp_f32 v141, v141
    v_mfma_f32_16x16x32_bf16 v[136:139], v[200:203], a[132:135], v[136:139]
    v_exp_f32 v142, v142
    v_exp_f32 v143, v143
    v_mfma_f32_16x16x32_bf16 v[144:147], v[200:203], a[136:139], v[144:147]
    v_cvt_pk_bf16_f32 v228, v140, v141
    v_cvt_pk_bf16_f32 v229, v142, v143
    v_accvgpr_write_b32 a92, v228
    v_accvgpr_write_b32 a93, v229
    v_mfma_f32_16x16x32_bf16 v[152:155], v[204:207], a[120:123], v[152:155]
    v_max3_f32 v26, v26, v180, v181
    v_max3_f32 v26, v26, v182, v183
    v_fma_f32 v180, v180, s60, v243
    v_fma_f32 v181, v181, s60, v243
    v_mfma_f32_16x16x32_bf16 v[160:163], v[204:207], a[124:127], v[160:163]
    v_fma_f32 v182, v182, s60, v243
    v_fma_f32 v183, v183, s60, v243
    v_exp_f32 v180, v180
    v_mfma_f32_16x16x32_bf16 v[168:171], v[204:207], a[128:131], v[168:171]
    v_exp_f32 v181, v181
    v_mfma_f32_16x16x32_bf16 v[176:179], v[204:207], a[132:135], v[176:179]
    v_exp_f32 v182, v182
    v_exp_f32 v183, v183
    v_cvt_pk_bf16_f32 v230, v180, v181
    v_mfma_f32_16x16x32_bf16 v[184:187], v[204:207], a[136:139], v[184:187]
    s_waitcnt lgkmcnt(4)
    v_cvt_pk_bf16_f32 v231, v182, v183
    v_accvgpr_write_b32 a94, v230
    v_accvgpr_write_b32 a95, v231
    v_max3_f32 v27, v27, v148, v149
    v_mfma_f32_16x16x32_bf16 v[116:119], v[208:211], a[100:103], 0
    v_max3_f32 v27, v27, v150, v151
    v_fma_f32 v148, v148, s60, v244
    v_mfma_f32_16x16x32_bf16 v[124:127], v[208:211], a[104:107], 0
    v_mfma_f32_16x16x32_bf16 a[152:155], a[240:243], v[228:231], a[152:155]
    v_fma_f32 v149, v149, s60, v244
    v_fma_f32 v150, v150, s60, v244
    v_fma_f32 v151, v151, s60, v244
    v_exp_f32 v148, v148
    v_exp_f32 v149, v149
    v_exp_f32 v150, v150
    v_exp_f32 v151, v151
    v_mfma_f32_16x16x32_bf16 v[132:135], v[208:211], a[108:111], 0
    v_cvt_pk_bf16_f32 v224, v148, v149
    v_cvt_pk_bf16_f32 v225, v150, v151
    v_accvgpr_write_b32 a96, v224
    v_mfma_f32_16x16x32_bf16 v[140:143], v[208:211], a[112:115], 0
    v_accvgpr_write_b32 a97, v225
    v_max3_f32 v27, v27, v188, v189
    v_max3_f32 v27, v27, v190, v191
    v_mfma_f32_16x16x32_bf16 v[148:151], v[208:211], a[116:119], 0
    v_fma_f32 v188, v188, s60, v244
    v_fma_f32 v189, v189, s60, v244
    v_fma_f32 v190, v190, s60, v244
    v_fma_f32 v191, v191, s60, v244
    v_mfma_f32_16x16x32_bf16 v[156:159], v[212:215], a[100:103], 0
    v_exp_f32 v188, v188
    v_mfma_f32_16x16x32_bf16 v[164:167], v[212:215], a[104:107], 0
    v_exp_f32 v189, v189
    v_exp_f32 v190, v190
    v_mfma_f32_16x16x32_bf16 v[172:175], v[212:215], a[108:111], 0
    v_exp_f32 v191, v191
    v_cvt_pk_bf16_f32 v226, v188, v189
    v_cvt_pk_bf16_f32 v227, v190, v191
    v_accvgpr_write_b32 a98, v226
    v_mfma_f32_16x16x32_bf16 v[180:183], v[212:215], a[112:115], 0
    v_accvgpr_write_b32 a99, v227
    s_nop 0
    v_mfma_f32_16x16x32_bf16 v[188:191], v[212:215], a[116:119], 0
    v_mfma_f32_16x16x32_bf16 a[156:159], a[240:243], v[224:227], a[156:159]
    v_fma_f32 v232, v23, s60, v240
    s_waitcnt vmcnt(7) lgkmcnt(0)
    s_waitcnt vmcnt(1)
    s_barrier
    v_mfma_f32_16x16x32_bf16 v[116:119], v[216:219], a[120:123], v[116:119]
    ds_read_b128 a[100:103], v16 offset:20480
    v_add_u32 v12, 33792, v9
    v_mfma_f32_16x16x32_bf16 v[124:127], v[216:219], a[124:127], v[124:127]
    ds_read_b64_tr_b16 v[192:193], v12 offset:0
    ds_read_b64_tr_b16 v[194:195], v12 offset:8448
    v_mfma_f32_16x16x32_bf16 v[132:135], v[216:219], a[128:131], v[132:135]
    ds_read_b64_tr_b16 v[196:197], v12 offset:32
    ds_read_b64_tr_b16 v[198:199], v12 offset:8480
    v_mfma_f32_16x16x32_bf16 v[140:143], v[216:219], a[132:135], v[140:143]
    ds_read_b128 a[104:107], v16 offset:21504
    v_fma_f32 v233, v24, s60, v241
    v_fma_f32 v234, v25, s60, v242
    v_mfma_f32_16x16x32_bf16 v[148:151], v[216:219], a[136:139], v[148:151]
    ds_read_b128 a[108:111], v16 offset:22528
    ds_read_b128 a[112:115], v16 offset:23552
    ds_read_b128 a[116:119], v16 offset:24576
    v_mfma_f32_16x16x32_bf16 v[156:159], v[220:223], a[120:123], v[156:159]
    s_mov_b32 s51, 98304
    s_add_u32 m0, s49, 0
    v_fma_f32 v235, v26, s60, v243
    v_mfma_f32_16x16x32_bf16 v[164:167], v[220:223], a[124:127], v[164:167]
    buffer_load_dwordx4 v28, s[36:39], s51 offen offset:0 nt lds
    v_mfma_f32_16x16x32_bf16 v[172:175], v[220:223], a[128:131], v[172:175]
    ds_read_b64_tr_b16 v[200:201], v12 offset:64
    ds_read_b64_tr_b16 v[202:203], v12 offset:8512
    v_mfma_f32_16x16x32_bf16 v[180:183], v[220:223], a[132:135], v[180:183]
    ds_read_b64_tr_b16 v[204:205], v12 offset:96
    ds_read_b64_tr_b16 v[206:207], v12 offset:8544
    v_mfma_f32_16x16x32_bf16 v[188:191], v[220:223], a[136:139], v[188:191]
    s_waitcnt lgkmcnt(4)
    v_fma_f32 v236, v27, s60, v244
    v_max3_f32 v232, v232, v233, v234
    v_mfma_f32_16x16x32_bf16 v[32:35], v[192:195], a[100:103], v[32:35]
    buffer_load_dwordx4 v29, s[36:39], s51 offen offset:1056 nt lds
    v_mfma_f32_16x16x32_bf16 v[40:43], v[192:195], a[104:107], v[40:43]
    ds_read_b64_tr_b16 v[208:209], v12 offset:128
    ds_read_b64_tr_b16 v[210:211], v12 offset:8576
    v_mfma_f32_16x16x32_bf16 v[48:51], v[192:195], a[108:111], v[48:51]
    ds_read_b64_tr_b16 v[212:213], v12 offset:160
    ds_read_b64_tr_b16 v[214:215], v12 offset:8608
    v_mfma_f32_16x16x32_bf16 v[56:59], v[192:195], a[112:115], v[56:59]
    buffer_load_dwordx4 v30, s[36:39], s51 offen offset:2112 nt lds
    v_mfma_f32_16x16x32_bf16 v[64:67], v[192:195], a[116:119], v[64:67]
    ds_read_b64_tr_b16 v[216:217], v12 offset:192
    ds_read_b64_tr_b16 v[218:219], v12 offset:8640
    v_mfma_f32_16x16x32_bf16 v[36:39], v[196:199], a[100:103], v[36:39]
    ds_read_b64_tr_b16 v[220:221], v12 offset:224
    ds_read_b64_tr_b16 v[222:223], v12 offset:8672
    v_mfma_f32_16x16x32_bf16 v[44:47], v[196:199], a[104:107], v[44:47]
    ds_read_b128 a[120:123], v16 offset:25600
    v_max3_f32 v232, v232, v235, v236
    v_mfma_f32_16x16x32_bf16 v[52:55], v[196:199], a[108:111], v[52:55]
    ds_read_b128 a[124:127], v16 offset:26624
    v_cmp_lt_f32 vcc, s7, v232
    v_mfma_f32_16x16x32_bf16 v[60:63], v[196:199], a[112:115], v[60:63]
    buffer_load_dwordx4 v31, s[36:39], s51 offen offset:3168 nt lds
    v_mfma_f32_16x16x32_bf16 v[68:71], v[196:199], a[116:119], v[68:71]
    s_waitcnt lgkmcnt(10)
    ds_read_b128 a[128:131], v16 offset:27648
    v_mfma_f32_16x16x32_bf16 v[72:75], v[200:203], a[100:103], v[72:75]
    ds_read_b128 a[132:135], v16 offset:28672
    s_nop 0
    v_mfma_f32_16x16x32_bf16 v[80:83], v[200:203], a[104:107], v[80:83]
    ds_read_b128 a[136:139], v16 offset:29696
    v_mfma_f32_16x16x32_bf16 v[88:91], v[200:203], a[108:111], v[88:91]
    s_add_u32 s51, s51, 2048
    s_add_u32 m0, s49, 4224
    v_mfma_f32_16x16x32_bf16 v[96:99], v[200:203], a[112:115], v[96:99]
    ds_read_b64_tr_b16 v[192:193], v12 offset:16896
    ds_read_b64_tr_b16 v[194:195], v12 offset:25344
    v_mfma_f32_16x16x32_bf16 v[104:107], v[200:203], a[116:119], v[104:107]
    buffer_load_dwordx4 v28, s[36:39], s51 offen offset:0 nt lds
    v_mfma_f32_16x16x32_bf16 v[76:79], v[204:207], a[100:103], v[76:79]
    ds_read_b64_tr_b16 v[196:197], v12 offset:16928
    ds_read_b64_tr_b16 v[198:199], v12 offset:25376
    v_mfma_f32_16x16x32_bf16 v[84:87], v[204:207], a[104:107], v[84:87]
    ds_read_b64_tr_b16 v[200:201], v12 offset:16960
    ds_read_b64_tr_b16 v[202:203], v12 offset:25408
    v_mfma_f32_16x16x32_bf16 v[92:95], v[204:207], a[108:111], v[92:95]
    s_cmp_lg_u64 vcc, 0
    s_cselect_b32 s3, 1, 0
    v_mov_b32 v232, s3
    v_mfma_f32_16x16x32_bf16 v[100:103], v[204:207], a[112:115], v[100:103]
    ds_write_b32 v250, v232
    v_mfma_f32_16x16x32_bf16 v[108:111], v[204:207], a[116:119], v[108:111]
    s_waitcnt lgkmcnt(15)
    v_mfma_f32_16x16x32_bf16 v[112:115], v[208:211], a[100:103], v[112:115]
    buffer_load_dwordx4 v29, s[36:39], s51 offen offset:1056 nt lds
    v_mfma_f32_16x16x32_bf16 v[120:123], v[208:211], a[104:107], v[120:123]
    ds_read_b64_tr_b16 v[204:205], v12 offset:16992
    ds_read_b64_tr_b16 v[206:207], v12 offset:25440
    v_mfma_f32_16x16x32_bf16 v[128:131], v[208:211], a[108:111], v[128:131]
    ds_write_b128 v17, a[0:3] offset:0
    v_mfma_f32_16x16x32_bf16 v[136:139], v[208:211], a[112:115], v[136:139]
    ds_write_b128 v17, a[4:7] offset:1024
    v_mfma_f32_16x16x32_bf16 v[144:147], v[208:211], a[116:119], v[144:147]
    ds_write_b128 v17, a[8:11] offset:2048
    v_mfma_f32_16x16x32_bf16 v[116:119], v[212:215], a[100:103], v[116:119]
    ds_read_b64_tr_b16 v[208:209], v12 offset:17024
    ds_read_b64_tr_b16 v[210:211], v12 offset:25472
    v_mfma_f32_16x16x32_bf16 v[124:127], v[212:215], a[104:107], v[124:127]
    buffer_load_dwordx4 v30, s[36:39], s51 offen offset:2112 nt lds
    v_mfma_f32_16x16x32_bf16 v[132:135], v[212:215], a[108:111], v[132:135]
    ds_write_b128 v17, a[12:15] offset:3072
    v_mfma_f32_16x16x32_bf16 v[140:143], v[212:215], a[112:115], v[140:143]
    ds_write_b128 v17, a[16:19] offset:4096
    v_mfma_f32_16x16x32_bf16 v[148:151], v[212:215], a[116:119], v[148:151]
    s_waitcnt lgkmcnt(15)
    v_mfma_f32_16x16x32_bf16 v[152:155], v[216:219], a[100:103], v[152:155]
    s_add_u32 s51, s49, 7392
    v_add_u32 v251, s51, v18
    v_mfma_f32_16x16x32_bf16 v[160:163], v[216:219], a[104:107], v[160:163]
    ds_read_b64_tr_b16 v[212:213], v12 offset:17056
    ds_read_b64_tr_b16 v[214:215], v12 offset:25504
    v_mfma_f32_16x16x32_bf16 v[168:171], v[216:219], a[108:111], v[168:171]
    ds_write_b128 v251, a[204:207]
    v_mfma_f32_16x16x32_bf16 v[176:179], v[216:219], a[112:115], v[176:179]
    v_mfma_f32_16x16x32_bf16 v[184:187], v[216:219], a[116:119], v[184:187]
    v_mfma_f32_16x16x32_bf16 v[156:159], v[220:223], a[100:103], v[156:159]
    ds_read_b64_tr_b16 v[216:217], v12 offset:17088
    ds_read_b64_tr_b16 v[218:219], v12 offset:25536
    v_mfma_f32_16x16x32_bf16 v[164:167], v[220:223], a[104:107], v[164:167]
    v_mfma_f32_16x16x32_bf16 v[172:175], v[220:223], a[108:111], v[172:175]
    v_mfma_f32_16x16x32_bf16 v[180:183], v[220:223], a[112:115], v[180:183]
    v_mfma_f32_16x16x32_bf16 v[188:191], v[220:223], a[116:119], v[188:191]
    s_waitcnt lgkmcnt(15)
    v_mfma_f32_16x16x32_bf16 v[32:35], v[192:195], a[120:123], v[32:35]
    ds_read_b64_tr_b16 v[220:221], v12 offset:17120
    ds_read_b64_tr_b16 v[222:223], v12 offset:25568
    v_mfma_f32_16x16x32_bf16 v[40:43], v[192:195], a[124:127], v[40:43]
    v_mfma_f32_16x16x32_bf16 v[48:51], v[192:195], a[128:131], v[48:51]
    v_mfma_f32_16x16x32_bf16 v[56:59], v[192:195], a[132:135], v[56:59]
    v_mfma_f32_16x16x32_bf16 v[64:67], v[192:195], a[136:139], v[64:67]
    v_mfma_f32_16x16x32_bf16 v[36:39], v[196:199], a[120:123], v[36:39]
    v_mfma_f32_16x16x32_bf16 v[44:47], v[196:199], a[124:127], v[44:47]
    v_mfma_f32_16x16x32_bf16 v[52:55], v[196:199], a[128:131], v[52:55]
    v_mfma_f32_16x16x32_bf16 v[60:63], v[196:199], a[132:135], v[60:63]
    v_mfma_f32_16x16x32_bf16 v[68:71], v[196:199], a[136:139], v[68:71]
    s_waitcnt lgkmcnt(14)
    v_mfma_f32_16x16x32_bf16 v[72:75], v[200:203], a[120:123], v[72:75]
    v_mfma_f32_16x16x32_bf16 v[80:83], v[200:203], a[124:127], v[80:83]
    v_mfma_f32_16x16x32_bf16 v[88:91], v[200:203], a[128:131], v[88:91]
    v_mfma_f32_16x16x32_bf16 v[96:99], v[200:203], a[132:135], v[96:99]
    v_mfma_f32_16x16x32_bf16 v[104:107], v[200:203], a[136:139], v[104:107]
    v_mfma_f32_16x16x32_bf16 v[76:79], v[204:207], a[120:123], v[76:79]
    v_mfma_f32_16x16x32_bf16 v[84:87], v[204:207], a[124:127], v[84:87]
    v_mfma_f32_16x16x32_bf16 v[92:95], v[204:207], a[128:131], v[92:95]
    v_mfma_f32_16x16x32_bf16 v[100:103], v[204:207], a[132:135], v[100:103]
    v_mfma_f32_16x16x32_bf16 v[108:111], v[204:207], a[136:139], v[108:111]
    s_waitcnt lgkmcnt(5)
    v_mfma_f32_16x16x32_bf16 v[112:115], v[208:211], a[120:123], v[112:115]
    v_mfma_f32_16x16x32_bf16 v[120:123], v[208:211], a[124:127], v[120:123]
    v_mfma_f32_16x16x32_bf16 v[128:131], v[208:211], a[128:131], v[128:131]
    v_mfma_f32_16x16x32_bf16 v[136:139], v[208:211], a[132:135], v[136:139]
    v_mfma_f32_16x16x32_bf16 v[144:147], v[208:211], a[136:139], v[144:147]
    s_waitcnt vmcnt(7) lgkmcnt(0)
    s_waitcnt vmcnt(1)
    s_barrier
    v_mfma_f32_16x16x32_bf16 v[116:119], v[212:215], a[120:123], v[116:119]
    ds_read_b128 a[100:103], v16 offset:40960
    v_add_u32 v12, 67584, v9
    v_mfma_f32_16x16x32_bf16 v[124:127], v[212:215], a[124:127], v[124:127]
    ds_read_b64_tr_b16 v[192:193], v12 offset:0
    ds_read_b64_tr_b16 v[194:195], v12 offset:8448
    v_mfma_f32_16x16x32_bf16 v[132:135], v[212:215], a[128:131], v[132:135]
    ds_read_b64_tr_b16 v[196:197], v12 offset:32
    ds_read_b64_tr_b16 v[198:199], v12 offset:8480
    v_mfma_f32_16x16x32_bf16 v[140:143], v[212:215], a[132:135], v[140:143]
    ds_read_b128 a[104:107], v16 offset:41984
    v_mov_b32 v236, 162816
    v_mfma_f32_16x16x32_bf16 v[148:151], v[212:215], a[136:139], v[148:151]
    ds_read_b128 v[232:235], v236
    v_mfma_f32_16x16x32_bf16 v[152:155], v[216:219], a[120:123], v[152:155]
    ds_read_b128 a[108:111], v16 offset:43008
    s_mov_b32 s51, 131072
    v_mfma_f32_16x16x32_bf16 v[160:163], v[216:219], a[124:127], v[160:163]
    ds_read_b128 a[112:115], v16 offset:44032
    s_add_u32 m0, s49, 33792
    v_mfma_f32_16x16x32_bf16 v[168:171], v[216:219], a[128:131], v[168:171]
    ds_read_b128 a[116:119], v16 offset:45056
    v_mfma_f32_16x16x32_bf16 v[176:179], v[216:219], a[132:135], v[176:179]
    buffer_load_dwordx4 v28, s[36:39], s51 offen offset:0 nt lds
    v_mfma_f32_16x16x32_bf16 v[184:187], v[216:219], a[136:139], v[184:187]
    ds_read_b64_tr_b16 v[200:201], v12 offset:64
    ds_read_b64_tr_b16 v[202:203], v12 offset:8512
    v_mfma_f32_16x16x32_bf16 v[156:159], v[220:223], a[120:123], v[156:159]
    ds_read_b64_tr_b16 v[204:205], v12 offset:96
    ds_read_b64_tr_b16 v[206:207], v12 offset:8544
    v_mfma_f32_16x16x32_bf16 v[164:167], v[220:223], a[124:127], v[164:167]
    buffer_load_dwordx4 v29, s[36:39], s51 offen offset:1056 nt lds
    v_mfma_f32_16x16x32_bf16 v[172:175], v[220:223], a[128:131], v[172:175]
    buffer_load_dwordx4 v30, s[36:39], s51 offen offset:2112 nt lds
    v_mfma_f32_16x16x32_bf16 v[180:183], v[220:223], a[132:135], v[180:183]
    ds_read_b64_tr_b16 v[208:209], v12 offset:128
    ds_read_b64_tr_b16 v[210:211], v12 offset:8576
    v_mfma_f32_16x16x32_bf16 v[188:191], v[220:223], a[136:139], v[188:191]
    s_waitcnt lgkmcnt(6)
    v_mfma_f32_16x16x32_bf16 v[32:35], v[192:195], a[100:103], v[32:35]
    ds_read_b64_tr_b16 v[212:213], v12 offset:160
    ds_read_b64_tr_b16 v[214:215], v12 offset:8608
    v_mfma_f32_16x16x32_bf16 v[40:43], v[192:195], a[104:107], v[40:43]
    v_or3_b32 v232, v232, v233, v234
    v_or_b32 v232, v232, v235
    v_mfma_f32_16x16x32_bf16 v[48:51], v[192:195], a[108:111], v[48:51]
    s_nop 0
    v_readfirstlane_b32 s3, v232
    s_nop 1
    v_mfma_f32_16x16x32_bf16 v[56:59], v[192:195], a[112:115], v[56:59]
    buffer_load_dwordx4 v31, s[36:39], s51 offen offset:3168 nt lds
    v_mfma_f32_16x16x32_bf16 v[64:67], v[192:195], a[116:119], v[64:67]
    s_andn2_b32 s3, s3, s5
    s_cbranch_scc1 L_redo
    v_mfma_f32_16x16x32_bf16 v[36:39], v[196:199], a[100:103], v[36:39]
    ds_read_b64_tr_b16 v[216:217], v12 offset:192
    ds_read_b64_tr_b16 v[218:219], v12 offset:8640
    v_mfma_f32_16x16x32_bf16 v[44:47], v[196:199], a[104:107], v[44:47]
    ds_read_b64_tr_b16 v[220:221], v12 offset:224
    ds_read_b64_tr_b16 v[222:223], v12 offset:8672
    v_mfma_f32_16x16x32_bf16 v[52:55], v[196:199], a[108:111], v[52:55]
    s_add_u32 s51, s51, 2048
    s_add_u32 m0, s49, 38016
    v_mfma_f32_16x16x32_bf16 v[60:63], v[196:199], a[112:115], v[60:63]
    ds_read_b128 a[120:123], v16 offset:46080
    v_mfma_f32_16x16x32_bf16 v[68:71], v[196:199], a[116:119], v[68:71]
    s_waitcnt lgkmcnt(9)
    ds_read_b128 a[124:127], v16 offset:47104
    v_mfma_f32_16x16x32_bf16 v[72:75], v[200:203], a[100:103], v[72:75]
    buffer_load_dwordx4 v28, s[36:39], s51 offen offset:0 nt lds
    v_mfma_f32_16x16x32_bf16 v[80:83], v[200:203], a[104:107], v[80:83]
    ds_read_b128 a[128:131], v16 offset:48128
    v_mfma_f32_16x16x32_bf16 v[88:91], v[200:203], a[108:111], v[88:91]
    ds_read_b128 a[132:135], v16 offset:49152
    v_mfma_f32_16x16x32_bf16 v[96:99], v[200:203], a[112:115], v[96:99]
    ds_read_b128 a[136:139], v16 offset:50176
    v_mfma_f32_16x16x32_bf16 v[104:107], v[200:203], a[116:119], v[104:107]
    ds_read_b64_tr_b16 v[192:193], v12 offset:16896
    ds_read_b64_tr_b16 v[194:195], v12 offset:25344
    v_mfma_f32_16x16x32_bf16 v[76:79], v[204:207], a[100:103], v[76:79]
    buffer_load_dwordx4 v29, s[36:39], s51 offen offset:1056 nt lds
    v_mfma_f32_16x16x32_bf16 v[84:87], v[204:207], a[104:107], v[84:87]
    ds_read_b64_tr_b16 v[196:197], v12 offset:16928
    ds_read_b64_tr_b16 v[198:199], v12 offset:25376
    v_mfma_f32_16x16x32_bf16 v[92:95], v[204:207], a[108:111], v[92:95]
    ds_read_b64_tr_b16 v[200:201], v12 offset:16960
    ds_read_b64_tr_b16 v[202:203], v12 offset:25408
    v_mfma_f32_16x16x32_bf16 v[100:103], v[204:207], a[112:115], v[100:103]
    ds_write_b128 v17, a[20:23] offset:20480
    v_mfma_f32_16x16x32_bf16 v[108:111], v[204:207], a[116:119], v[108:111]
    s_waitcnt lgkmcnt(15)
    v_accvgpr_read_b32 v245, a140
    v_accvgpr_read_b32 v246, a144
    v_mfma_f32_16x16x32_bf16 v[112:115], v[208:211], a[100:103], v[112:115]
    ds_read_b64_tr_b16 v[204:205], v12 offset:16992
    ds_read_b64_tr_b16 v[206:207], v12 offset:25440
    v_mfma_f32_16x16x32_bf16 v[120:123], v[208:211], a[104:107], v[120:123]
    buffer_load_dwordx4 v30, s[36:39], s51 offen offset:2112 nt lds
    v_mfma_f32_16x16x32_bf16 v[128:131], v[208:211], a[108:111], v[128:131]
    ds_write_b128 v17, a[24:27] offset:21504
    v_mfma_f32_16x16x32_bf16 v[136:139], v[208:211], a[112:115], v[136:139]
    ds_write_b128 v17, a[28:31] offset:22528
    v_mfma_f32_16x16x32_bf16 v[144:147], v[208:211], a[116:119], v[144:147]
    ds_write_b128 v17, a[32:35] offset:23552
    v_mfma_f32_16x16x32_bf16 v[116:119], v[212:215], a[100:103], v[116:119]
    s_add_u32 s51, s49, 41184
    v_add_u32 v251, s51, v18
    v_accvgpr_read_b32 v247, a148
    v_mfma_f32_16x16x32_bf16 v[124:127], v[212:215], a[104:107], v[124:127]
    ds_read_b64_tr_b16 v[208:209], v12 offset:17024
    ds_read_b64_tr_b16 v[210:211], v12 offset:25472
    v_mfma_f32_16x16x32_bf16 v[132:135], v[212:215], a[108:111], v[132:135]
    ds_write_b128 v251, a[208:211]
    v_mfma_f32_16x16x32_bf16 v[140:143], v[212:215], a[112:115], v[140:143]
    ds_write_b128 v17, a[36:39] offset:24576
    v_mfma_f32_16x16x32_bf16 v[148:151], v[212:215], a[116:119], v[148:151]
    s_waitcnt lgkmcnt(15)
    v_accvgpr_read_b32 v248, a152
    v_accvgpr_read_b32 v249, a156
    v_mfma_f32_16x16x32_bf16 v[152:155], v[216:219], a[100:103], v[152:155]
    ds_read_b64_tr_b16 v[212:213], v12 offset:17056
    ds_read_b64_tr_b16 v[214:215], v12 offset:25504
    v_mfma_f32_16x16x32_bf16 v[160:163], v[216:219], a[104:107], v[160:163]
    ds_write_b32 v254, v245 offset:0
    v_mfma_f32_16x16x32_bf16 v[168:171], v[216:219], a[108:111], v[168:171]
    ds_write_b32 v254, v246 offset:4224
    v_mfma_f32_16x16x32_bf16 v[176:179], v[216:219], a[112:115], v[176:179]
    ds_write_b32 v254, v247 offset:8448
    v_mfma_f32_16x16x32_bf16 v[184:187], v[216:219], a[116:119], v[184:187]
    ds_write_b32 v254, v248 offset:12672
    v_mfma_f32_16x16x32_bf16 v[156:159], v[220:223], a[100:103], v[156:159]
    ds_read_b64_tr_b16 v[216:217], v12 offset:17088
    ds_read_b64_tr_b16 v[218:219], v12 offset:25536
    v_mfma_f32_16x16x32_bf16 v[164:167], v[220:223], a[104:107], v[164:167]
    ds_write_b32 v254, v249 offset:16896
    v_mfma_f32_16x16x32_bf16 v[172:175], v[220:223], a[108:111], v[172:175]
    v_mfma_f32_16x16x32_bf16 v[180:183], v[220:223], a[112:115], v[180:183]
    v_mfma_f32_16x16x32_bf16 v[188:191], v[220:223], a[116:119], v[188:191]
    s_waitcnt lgkmcnt(15)
    v_mfma_f32_16x16x32_bf16 v[32:35], v[192:195], a[120:123], v[32:35]
    ds_read_b64_tr_b16 v[220:221], v12 offset:17120
    ds_read_b64_tr_b16 v[222:223], v12 offset:25568
    v_mfma_f32_16x16x32_bf16 v[40:43], v[192:195], a[124:127], v[40:43]
    v_mfma_f32_16x16x32_bf16 v[48:51], v[192:195], a[128:131], v[48:51]
    v_mfma_f32_16x16x32_bf16 v[56:59], v[192:195], a[132:135], v[56:59]
    v_mfma_f32_16x16x32_bf16 v[64:67], v[192:195], a[136:139], v[64:67]
    v_mfma_f32_16x16x32_bf16 v[36:39], v[196:199], a[120:123], v[36:39]
    v_mfma_f32_16x16x32_bf16 v[44:47], v[196:199], a[124:127], v[44:47]
    v_mfma_f32_16x16x32_bf16 v[52:55], v[196:199], a[128:131], v[52:55]
    v_mfma_f32_16x16x32_bf16 v[60:63], v[196:199], a[132:135], v[60:63]
    v_mfma_f32_16x16x32_bf16 v[68:71], v[196:199], a[136:139], v[68:71]
    v_mfma_f32_16x16x32_bf16 v[72:75], v[200:203], a[120:123], v[72:75]
    v_mfma_f32_16x16x32_bf16 v[80:83], v[200:203], a[124:127], v[80:83]
    v_mfma_f32_16x16x32_bf16 v[88:91], v[200:203], a[128:131], v[88:91]
    v_mfma_f32_16x16x32_bf16 v[96:99], v[200:203], a[132:135], v[96:99]
    v_mfma_f32_16x16x32_bf16 v[104:107], v[200:203], a[136:139], v[104:107]
    v_mfma_f32_16x16x32_bf16 v[76:79], v[204:207], a[120:123], v[76:79]
    v_mfma_f32_16x16x32_bf16 v[84:87], v[204:207], a[124:127], v[84:87]
    v_mfma_f32_16x16x32_bf16 v[92:95], v[204:207], a[128:131], v[92:95]
    v_mfma_f32_16x16x32_bf16 v[100:103], v[204:207], a[132:135], v[100:103]
    v_mfma_f32_16x16x32_bf16 v[108:111], v[204:207], a[136:139], v[108:111]
    s_waitcnt lgkmcnt(9)
    v_mfma_f32_16x16x32_bf16 v[112:115], v[208:211], a[120:123], v[112:115]
    v_mfma_f32_16x16x32_bf16 v[120:123], v[208:211], a[124:127], v[120:123]
    v_mfma_f32_16x16x32_bf16 v[128:131], v[208:211], a[128:131], v[128:131]
    v_mfma_f32_16x16x32_bf16 v[136:139], v[208:211], a[132:135], v[136:139]
    v_mfma_f32_16x16x32_bf16 v[144:147], v[208:211], a[136:139], v[144:147]
    s_waitcnt vmcnt(7) lgkmcnt(0)
    s_waitcnt vmcnt(1)
    s_barrier
    v_mfma_f32_16x16x32_bf16 v[116:119], v[212:215], a[120:123], v[116:119]
    ds_read_b128 a[100:103], v16 offset:0
    v_add_u32 v12, 0, v9
    v_mfma_f32_16x16x32_bf16 v[124:127], v[212:215], a[124:127], v[124:127]
    ds_read_b64_tr_b16 v[192:193], v12 offset:0
    ds_read_b64_tr_b16 v[194:195], v12 offset:8448
    v_mfma_f32_16x16x32_bf16 v[132:135], v[212:215], a[128:131], v[132:135]
    ds_read_b64_tr_b16 v[196:197], v12 offset:32
    ds_read_b64_tr_b16 v[198:199], v12 offset:8480
    v_mfma_f32_16x16x32_bf16 v[140:143], v[212:215], a[132:135], v[140:143]
    ds_read_b128 a[104:107], v16 offset:1024
    s_mov_b32 s51, 163840
    v_mfma_f32_16x16x32_bf16 v[148:151], v[212:215], a[136:139], v[148:151]
    ds_read_b128 a[108:111], v16 offset:2048
    v_mfma_f32_16x16x32_bf16 v[152:155], v[216:219], a[120:123], v[152:155]
    ds_read_b128 a[112:115], v16 offset:3072
    s_add_u32 m0, s49, 67584
    v_mfma_f32_16x16x32_bf16 v[160:163], v[216:219], a[124:127], v[160:163]
    ds_read_b128 a[116:119], v16 offset:4096
    v_mfma_f32_16x16x32_bf16 v[168:171], v[216:219], a[128:131], v[168:171]
    buffer_load_dwordx4 v28, s[36:39], s51 offen offset:0 nt lds
    v_mfma_f32_16x16x32_bf16 v[176:179], v[216:219], a[132:135], v[176:179]
    ds_read_b64_tr_b16 v[200:201], v12 offset:64
    ds_read_b64_tr_b16 v[202:203], v12 offset:8512
    v_mfma_f32_16x16x32_bf16 v[184:187], v[216:219], a[136:139], v[184:187]
    ds_read_b64_tr_b16 v[204:205], v12 offset:96
    ds_read_b64_tr_b16 v[206:207], v12 offset:8544
    v_mfma_f32_16x16x32_bf16 v[156:159], v[220:223], a[120:123], v[156:159]
    buffer_load_dwordx4 v29, s[36:39], s51 offen offset:1056 nt lds
    v_mfma_f32_16x16x32_bf16 v[164:167], v[220:223], a[124:127], v[164:167]
    ds_read_b64_tr_b16 v[208:209], v12 offset:128
    ds_read_b64_tr_b16 v[210:211], v12 offset:8576
    v_mfma_f32_16x16x32_bf16 v[172:175], v[220:223], a[128:131], v[172:175]
    buffer_load_dwordx4 v30, s[36:39], s51 offen offset:2112 nt lds
    v_mfma_f32_16x16x32_bf16 v[180:183], v[220:223], a[132:135], v[180:183]
    ds_read_b64_tr_b16 v[212:213], v12 offset:160
    ds_read_b64_tr_b16 v[214:215], v12 offset:8608
    v_mfma_f32_16x16x32_bf16 v[188:191], v[220:223], a[136:139], v[188:191]
    s_waitcnt lgkmcnt(8)
    ds_read_b64 v[224:225], v253 offset:0
    v_mfma_f32_16x16x32_bf16 v[32:35], v[192:195], a[100:103], v[32:35]
    ds_read_b64 v[226:227], v253 offset:4224
    v_mfma_f32_16x16x32_bf16 v[40:43], v[192:195], a[104:107], v[40:43]
    ds_read_b64 v[228:229], v253 offset:8448
    v_mfma_f32_16x16x32_bf16 v[48:51], v[192:195], a[108:111], v[48:51]
    ds_read_b64 v[230:231], v253 offset:12672
    v_mfma_f32_16x16x32_bf16 v[56:59], v[192:195], a[112:115], v[56:59]
    buffer_load_dwordx4 v31, s[36:39], s51 offen offset:3168 nt lds
    v_mfma_f32_16x16x32_bf16 v[64:67], v[192:195], a[116:119], v[64:67]
    ds_read_b64 v[232:233], v253 offset:16896
    v_mfma_f32_16x16x32_bf16 v[36:39], v[196:199], a[100:103], v[36:39]
    ds_read_b64_tr_b16 v[216:217], v12 offset:192
    ds_read_b64_tr_b16 v[218:219], v12 offset:8640
    v_mfma_f32_16x16x32_bf16 v[44:47], v[196:199], a[104:107], v[44:47]
    ds_read_b64_tr_b16 v[220:221], v12 offset:224
    ds_read_b64_tr_b16 v[222:223], v12 offset:8672
    v_mfma_f32_16x16x32_bf16 v[52:55], v[196:199], a[108:111], v[52:55]
    s_add_u32 s51, s51, 2048
    s_add_u32 m0, s49, 71808
    v_mfma_f32_16x16x32_bf16 v[60:63], v[196:199], a[112:115], v[60:63]
    ds_read_b128 a[120:123], v16 offset:5120
    v_mfma_f32_16x16x32_bf16 v[68:71], v[196:199], a[116:119], v[68:71]
    s_waitcnt lgkmcnt(14)
    ds_read_b128 a[124:127], v16 offset:6144
    v_mfma_f32_16x16x32_bf16 v[72:75], v[200:203], a[100:103], v[72:75]
    buffer_load_dwordx4 v28, s[36:39], s51 offen offset:0 nt lds
    v_mfma_f32_16x16x32_bf16 v[80:83], v[200:203], a[104:107], v[80:83]
    ds_read_b128 a[128:131], v16 offset:7168
    v_mfma_f32_16x16x32_bf16 v[88:91], v[200:203], a[108:111], v[88:91]
    ds_read_b128 a[132:135], v16 offset:8192
    v_mfma_f32_16x16x32_bf16 v[96:99], v[200:203], a[112:115], v[96:99]
    ds_read_b128 a[136:139], v16 offset:9216
    v_mfma_f32_16x16x32_bf16 v[104:107], v[200:203], a[116:119], v[104:107]
    ds_read_b64_tr_b16 v[192:193], v12 offset:16896
    ds_read_b64_tr_b16 v[194:195], v12 offset:25344
    v_mfma_f32_16x16x32_bf16 v[76:79], v[204:207], a[100:103], v[76:79]
    buffer_load_dwordx4 v29, s[36:39], s51 offen offset:1056 nt lds
    v_mfma_f32_16x16x32_bf16 v[84:87], v[204:207], a[104:107], v[84:87]
    ds_read_b64_tr_b16 v[196:197], v12 offset:16928
    ds_read_b64_tr_b16 v[198:199], v12 offset:25376
    v_mfma_f32_16x16x32_bf16 v[92:95], v[204:207], a[108:111], v[92:95]
    ds_read_b64_tr_b16 v[200:201], v12 offset:16960
    ds_read_b64_tr_b16 v[202:203], v12 offset:25408
    v_mfma_f32_16x16x32_bf16 v[100:103], v[204:207], a[112:115], v[100:103]
    ds_write_b128 v17, a[40:43] offset:40960
    v_mfma_f32_16x16x32_bf16 v[108:111], v[204:207], a[116:119], v[108:111]
    s_waitcnt lgkmcnt(15)
    v_mfma_f32_16x16x32_bf16 v[112:115], v[208:211], a[100:103], v[112:115]
    ds_read_b64_tr_b16 v[204:205], v12 offset:16992
    ds_read_b64_tr_b16 v[206:207], v12 offset:25440
    v_mfma_f32_16x16x32_bf16 v[120:123], v[208:211], a[104:107], v[120:123]
    buffer_load_dwordx4 v30, s[36:39], s51 offen offset:2112 nt lds
    v_mfma_f32_16x16x32_bf16 v[128:131], v[208:211], a[108:111], v[128:131]
    ds_write_b128 v17, a[44:47] offset:41984
    v_mfma_f32_16x16x32_bf16 v[136:139], v[208:211], a[112:115], v[136:139]
    ds_write_b128 v17, a[48:51] offset:43008
    v_mfma_f32_16x16x32_bf16 v[144:147], v[208:211], a[116:119], v[144:147]
    ds_write_b128 v17, a[52:55] offset:44032
    v_mfma_f32_16x16x32_bf16 v[116:119], v[212:215], a[100:103], v[116:119]
    s_add_u32 s51, s49, 74976
    v_add_u32 v251, s51, v18
    v_mfma_f32_16x16x32_bf16 v[124:127], v[212:215], a[104:107], v[124:127]
    ds_read_b64_tr_b16 v[208:209], v12 offset:17024
    ds_read_b64_tr_b16 v[210:211], v12 offset:25472
    v_mfma_f32_16x16x32_bf16 v[132:135], v[212:215], a[108:111], v[132:135]
    ds_write_b128 v251, a[244:247]
    v_mfma_f32_16x16x32_bf16 v[140:143], v[212:215], a[112:115], v[140:143]
    ds_write_b128 v17, a[56:59] offset:45056
    v_mfma_f32_16x16x32_bf16 v[148:151], v[212:215], a[116:119], v[148:151]
    s_waitcnt lgkmcnt(15)
    v_mfma_f32_16x16x32_bf16 v[152:155], v[216:219], a[100:103], v[152:155]
    ds_read_b64_tr_b16 v[212:213], v12 offset:17056
    ds_read_b64_tr_b16 v[214:215], v12 offset:25504
    v_mfma_f32_16x16x32_bf16 v[160:163], v[216:219], a[104:107], v[160:163]
    v_add_f32 v224, v224, v225
    v_add_f32 v226, v226, v227
    v_mfma_f32_16x16x32_bf16 v[168:171], v[216:219], a[108:111], v[168:171]
    v_add_f32 v228, v228, v229
    v_add_f32 v230, v230, v231
    v_mfma_f32_16x16x32_bf16 v[176:179], v[216:219], a[112:115], v[176:179]
    v_add_f32 v232, v232, v233
    v_mfma_f32_16x16x32_bf16 v[184:187], v[216:219], a[116:119], v[184:187]
    v_rcp_f32 v240, v224
    v_mfma_f32_16x16x32_bf16 v[156:159], v[220:223], a[100:103], v[156:159]
    ds_read_b64_tr_b16 v[216:217], v12 offset:17088
    ds_read_b64_tr_b16 v[218:219], v12 offset:25536
    v_mfma_f32_16x16x32_bf16 v[164:167], v[220:223], a[104:107], v[164:167]
    v_rcp_f32 v241, v226
    v_mfma_f32_16x16x32_bf16 v[172:175], v[220:223], a[108:111], v[172:175]
    v_rcp_f32 v242, v228
    v_mfma_f32_16x16x32_bf16 v[180:183], v[220:223], a[112:115], v[180:183]
    v_rcp_f32 v243, v230
    v_mfma_f32_16x16x32_bf16 v[188:191], v[220:223], a[116:119], v[188:191]
    s_waitcnt lgkmcnt(15)
    v_rcp_f32 v244, v232
    v_mfma_f32_16x16x32_bf16 v[32:35], v[192:195], a[120:123], v[32:35]
    ds_read_b64_tr_b16 v[220:221], v12 offset:17120
    ds_read_b64_tr_b16 v[222:223], v12 offset:25568
    v_mfma_f32_16x16x32_bf16 v[40:43], v[192:195], a[124:127], v[40:43]
    v_mfma_f32_16x16x32_bf16 v[48:51], v[192:195], a[128:131], v[48:51]
    v_mfma_f32_16x16x32_bf16 v[56:59], v[192:195], a[132:135], v[56:59]
    v_mfma_f32_16x16x32_bf16 v[64:67], v[192:195], a[136:139], v[64:67]
    v_mfma_f32_16x16x32_bf16 v[36:39], v[196:199], a[120:123], v[36:39]
    v_mfma_f32_16x16x32_bf16 v[44:47], v[196:199], a[124:127], v[44:47]
    v_mfma_f32_16x16x32_bf16 v[52:55], v[196:199], a[128:131], v[52:55]
    v_mfma_f32_16x16x32_bf16 v[60:63], v[196:199], a[132:135], v[60:63]
    v_mfma_f32_16x16x32_bf16 v[68:71], v[196:199], a[136:139], v[68:71]
    s_waitcnt lgkmcnt(13)
    v_mfma_f32_16x16x32_bf16 v[72:75], v[200:203], a[120:123], v[72:75]
    v_mfma_f32_16x16x32_bf16 v[80:83], v[200:203], a[124:127], v[80:83]
    v_mfma_f32_16x16x32_bf16 v[88:91], v[200:203], a[128:131], v[88:91]
    v_mfma_f32_16x16x32_bf16 v[96:99], v[200:203], a[132:135], v[96:99]
    v_mfma_f32_16x16x32_bf16 v[104:107], v[200:203], a[136:139], v[104:107]
    v_mfma_f32_16x16x32_bf16 v[76:79], v[204:207], a[120:123], v[76:79]
    v_mfma_f32_16x16x32_bf16 v[84:87], v[204:207], a[124:127], v[84:87]
    v_mfma_f32_16x16x32_bf16 v[92:95], v[204:207], a[128:131], v[92:95]
    v_mfma_f32_16x16x32_bf16 v[100:103], v[204:207], a[132:135], v[100:103]
    v_mfma_f32_16x16x32_bf16 v[108:111], v[204:207], a[136:139], v[108:111]
    s_waitcnt lgkmcnt(4)
    v_mfma_f32_16x16x32_bf16 v[112:115], v[208:211], a[120:123], v[112:115]
    v_mfma_f32_16x16x32_bf16 v[120:123], v[208:211], a[124:127], v[120:123]
    v_mfma_f32_16x16x32_bf16 v[128:131], v[208:211], a[128:131], v[128:131]
    v_mfma_f32_16x16x32_bf16 v[136:139], v[208:211], a[132:135], v[136:139]
    v_mfma_f32_16x16x32_bf16 v[144:147], v[208:211], a[136:139], v[144:147]
    s_waitcnt vmcnt(7) lgkmcnt(0)
    s_waitcnt vmcnt(2)
    s_barrier
    v_mfma_f32_16x16x32_bf16 v[116:119], v[212:215], a[120:123], v[116:119]
    ds_read_b128 a[100:103], v16 offset:20480
    v_add_u32 v12, 33792, v9
    v_mfma_f32_16x16x32_bf16 v[124:127], v[212:215], a[124:127], v[124:127]
    ds_read_b64_tr_b16 v[192:193], v12 offset:0
    ds_read_b64_tr_b16 v[194:195], v12 offset:8448
    v_mfma_f32_16x16x32_bf16 v[132:135], v[212:215], a[128:131], v[132:135]
    ds_read_b64_tr_b16 v[196:197], v12 offset:32
    ds_read_b64_tr_b16 v[198:199], v12 offset:8480
    v_mfma_f32_16x16x32_bf16 v[140:143], v[212:215], a[132:135], v[140:143]
    ds_read_b128 a[104:107], v16 offset:21504
    s_mov_b32 s51, 196608
    v_mfma_f32_16x16x32_bf16 v[148:151], v[212:215], a[136:139], v[148:151]
    ds_read_b128 a[108:111], v16 offset:22528
    v_mfma_f32_16x16x32_bf16 v[152:155], v[216:219], a[120:123], v[152:155]
    ds_read_b128 a[112:115], v16 offset:23552
    s_add_u32 m0, s49, 0
    v_mfma_f32_16x16x32_bf16 v[160:163], v[216:219], a[124:127], v[160:163]
    ds_read_b128 a[116:119], v16 offset:24576
    v_mfma_f32_16x16x32_bf16 v[168:171], v[216:219], a[128:131], v[168:171]
    buffer_load_dwordx4 v28, s[36:39], s51 offen offset:0 nt lds
    v_mfma_f32_16x16x32_bf16 v[176:179], v[216:219], a[132:135], v[176:179]
    ds_read_b64_tr_b16 v[200:201], v12 offset:64
    ds_read_b64_tr_b16 v[202:203], v12 offset:8512
    v_mfma_f32_16x16x32_bf16 v[184:187], v[216:219], a[136:139], v[184:187]
    ds_read_b64_tr_b16 v[204:205], v12 offset:96
    ds_read_b64_tr_b16 v[206:207], v12 offset:8544
    v_mfma_f32_16x16x32_bf16 v[156:159], v[220:223], a[120:123], v[156:159]
    buffer_load_dwordx4 v29, s[36:39], s51 offen offset:1056 nt lds
    v_mfma_f32_16x16x32_bf16 v[164:167], v[220:223], a[124:127], v[164:167]
    ds_read_b64_tr_b16 v[208:209], v12 offset:128
    ds_read_b64_tr_b16 v[210:211], v12 offset:8576
    v_mfma_f32_16x16x32_bf16 v[172:175], v[220:223], a[128:131], v[172:175]
    buffer_load_dwordx4 v30, s[36:39], s51 offen offset:2112 nt lds
    v_mfma_f32_16x16x32_bf16 v[180:183], v[220:223], a[132:135], v[180:183]
    ds_read_b64_tr_b16 v[212:213], v12 offset:160
    ds_read_b64_tr_b16 v[214:215], v12 offset:8608
    v_mfma_f32_16x16x32_bf16 v[188:191], v[220:223], a[136:139], v[188:191]
    s_waitcnt lgkmcnt(8)
    v_mfma_f32_16x16x32_bf16 v[32:35], v[192:195], a[100:103], v[32:35]
    ds_read_b64_tr_b16 v[216:217], v12 offset:192
    ds_read_b64_tr_b16 v[218:219], v12 offset:8640
    v_mfma_f32_16x16x32_bf16 v[40:43], v[192:195], a[104:107], v[40:43]
    ds_read_b64_tr_b16 v[220:221], v12 offset:224
    ds_read_b64_tr_b16 v[222:223], v12 offset:8672
    v_mfma_f32_16x16x32_bf16 v[48:51], v[192:195], a[108:111], v[48:51]
    ds_read_b128 a[120:123], v16 offset:25600
    v_mfma_f32_16x16x32_bf16 v[56:59], v[192:195], a[112:115], v[56:59]
    buffer_load_dwordx4 v31, s[36:39], s51 offen offset:3168 nt lds
    v_mfma_f32_16x16x32_bf16 v[64:67], v[192:195], a[116:119], v[64:67]
    ds_read_b128 a[124:127], v16 offset:26624
    v_mfma_f32_16x16x32_bf16 v[36:39], v[196:199], a[100:103], v[36:39]
    ds_read_b128 a[128:131], v16 offset:27648
    v_mfma_f32_16x16x32_bf16 v[44:47], v[196:199], a[104:107], v[44:47]
    ds_read_b128 a[132:135], v16 offset:28672
    v_mfma_f32_16x16x32_bf16 v[52:55], v[196:199], a[108:111], v[52:55]
    s_add_u32 s51, s51, 2048
    s_add_u32 m0, s49, 4224
    v_mfma_f32_16x16x32_bf16 v[60:63], v[196:199], a[112:115], v[60:63]
    ds_read_b128 a[136:139], v16 offset:29696
    v_mfma_f32_16x16x32_bf16 v[68:71], v[196:199], a[116:119], v[68:71]
    s_waitcnt lgkmcnt(13)
    v_mfma_f32_16x16x32_bf16 v[72:75], v[200:203], a[100:103], v[72:75]
    buffer_load_dwordx4 v28, s[36:39], s51 offen offset:0 nt lds
    v_mfma_f32_16x16x32_bf16 v[80:83], v[200:203], a[104:107], v[80:83]
    ds_read_b64_tr_b16 v[192:193], v12 offset:16896
    ds_read_b64_tr_b16 v[194:195], v12 offset:25344
    v_mfma_f32_16x16x32_bf16 v[88:91], v[200:203], a[108:111], v[88:91]
    ds_read_b64_tr_b16 v[196:197], v12 offset:16928
    ds_read_b64_tr_b16 v[198:199], v12 offset:25376
    v_mfma_f32_16x16x32_bf16 v[96:99], v[200:203], a[112:115], v[96:99]
    ds_write_b128 v17, a[60:63] offset:0
    v_mfma_f32_16x16x32_bf16 v[104:107], v[200:203], a[116:119], v[104:107]
    ds_write_b128 v17, a[64:67] offset:1024
    v_mfma_f32_16x16x32_bf16 v[76:79], v[204:207], a[100:103], v[76:79]
    buffer_load_dwordx4 v29, s[36:39], s51 offen offset:1056 nt lds
    v_mfma_f32_16x16x32_bf16 v[84:87], v[204:207], a[104:107], v[84:87]
    ds_read_b64_tr_b16 v[200:201], v12 offset:16960
    ds_read_b64_tr_b16 v[202:203], v12 offset:25408
    v_mfma_f32_16x16x32_bf16 v[92:95], v[204:207], a[108:111], v[92:95]
    ds_write_b128 v17, a[68:71] offset:2048
    v_mfma_f32_16x16x32_bf16 v[100:103], v[204:207], a[112:115], v[100:103]
    ds_write_b128 v17, a[72:75] offset:3072
    v_mfma_f32_16x16x32_bf16 v[108:111], v[204:207], a[116:119], v[108:111]
    s_waitcnt lgkmcnt(15)
    v_mfma_f32_16x16x32_bf16 v[112:115], v[208:211], a[100:103], v[112:115]
    ds_read_b64_tr_b16 v[204:205], v12 offset:16992
    ds_read_b64_tr_b16 v[206:207], v12 offset:25440
    v_mfma_f32_16x16x32_bf16 v[120:123], v[208:211], a[104:107], v[120:123]
    buffer_load_dwordx4 v30, s[36:39], s51 offen offset:2112 nt lds
    v_mfma_f32_16x16x32_bf16 v[128:131], v[208:211], a[108:111], v[128:131]
    ds_write_b128 v17, a[76:79] offset:4096
    v_mfma_f32_16x16x32_bf16 v[136:139], v[208:211], a[112:115], v[136:139]
    v_mfma_f32_16x16x32_bf16 v[144:147], v[208:211], a[116:119], v[144:147]
    v_mfma_f32_16x16x32_bf16 v[116:119], v[212:215], a[100:103], v[116:119]
    s_add_u32 s51, s49, 7392
    v_add_u32 v251, s51, v18
    v_mfma_f32_16x16x32_bf16 v[124:127], v[212:215], a[104:107], v[124:127]
    ds_read_b64_tr_b16 v[208:209], v12 offset:17024
    ds_read_b64_tr_b16 v[210:211], v12 offset:25472
    v_mfma_f32_16x16x32_bf16 v[132:135], v[212:215], a[108:111], v[132:135]
    ds_write_b128 v251, a[248:251]
    v_mfma_f32_16x16x32_bf16 v[140:143], v[212:215], a[112:115], v[140:143]
    v_mfma_f32_16x16x32_bf16 v[148:151], v[212:215], a[116:119], v[148:151]
    v_mfma_f32_16x16x32_bf16 v[152:155], v[216:219], a[100:103], v[152:155]
    ds_read_b64_tr_b16 v[212:213], v12 offset:17056
    ds_read_b64_tr_b16 v[214:215], v12 offset:25504
    v_mfma_f32_16x16x32_bf16 v[160:163], v[216:219], a[104:107], v[160:163]
    v_mfma_f32_16x16x32_bf16 v[168:171], v[216:219], a[108:111], v[168:171]
    v_mfma_f32_16x16x32_bf16 v[176:179], v[216:219], a[112:115], v[176:179]
    v_mfma_f32_16x16x32_bf16 v[184:187], v[216:219], a[116:119], v[184:187]
    v_mfma_f32_16x16x32_bf16 v[156:159], v[220:223], a[100:103], v[156:159]
    ds_read_b64_tr_b16 v[216:217], v12 offset:17088
    ds_read_b64_tr_b16 v[218:219], v12 offset:25536
    v_mfma_f32_16x16x32_bf16 v[164:167], v[220:223], a[104:107], v[164:167]
    v_mfma_f32_16x16x32_bf16 v[172:175], v[220:223], a[108:111], v[172:175]
    v_mfma_f32_16x16x32_bf16 v[180:183], v[220:223], a[112:115], v[180:183]
    v_mfma_f32_16x16x32_bf16 v[188:191], v[220:223], a[116:119], v[188:191]
    s_waitcnt lgkmcnt(15)
    v_mfma_f32_16x16x32_bf16 v[32:35], v[192:195], a[120:123], v[32:35]
    ds_read_b64_tr_b16 v[220:221], v12 offset:17120
    ds_read_b64_tr_b16 v[222:223], v12 offset:25568
    v_mfma_f32_16x16x32_bf16 v[40:43], v[192:195], a[124:127], v[40:43]
    v_mfma_f32_16x16x32_bf16 v[48:51], v[192:195], a[128:131], v[48:51]
    v_mfma_f32_16x16x32_bf16 v[56:59], v[192:195], a[132:135], v[56:59]
    v_mfma_f32_16x16x32_bf16 v[64:67], v[192:195], a[136:139], v[64:67]
    v_mfma_f32_16x16x32_bf16 v[36:39], v[196:199], a[120:123], v[36:39]
    v_mfma_f32_16x16x32_bf16 v[44:47], v[196:199], a[124:127], v[44:47]
    v_mfma_f32_16x16x32_bf16 v[52:55], v[196:199], a[128:131], v[52:55]
    v_mfma_f32_16x16x32_bf16 v[60:63], v[196:199], a[132:135], v[60:63]
    v_mfma_f32_16x16x32_bf16 v[68:71], v[196:199], a[136:139], v[68:71]
    s_waitcnt lgkmcnt(10)
    v_mfma_f32_16x16x32_bf16 v[72:75], v[200:203], a[120:123], v[72:75]
    v_mfma_f32_16x16x32_bf16 v[80:83], v[200:203], a[124:127], v[80:83]
    v_mfma_f32_16x16x32_bf16 v[88:91], v[200:203], a[128:131], v[88:91]
    v_mfma_f32_16x16x32_bf16 v[96:99], v[200:203], a[132:135], v[96:99]
    v_mfma_f32_16x16x32_bf16 v[104:107], v[200:203], a[136:139], v[104:107]
    v_mfma_f32_16x16x32_bf16 v[76:79], v[204:207], a[120:123], v[76:79]
    v_mfma_f32_16x16x32_bf16 v[84:87], v[204:207], a[124:127], v[84:87]
    v_mfma_f32_16x16x32_bf16 v[92:95], v[204:207], a[128:131], v[92:95]
    v_mfma_f32_16x16x32_bf16 v[100:103], v[204:207], a[132:135], v[100:103]
    v_mfma_f32_16x16x32_bf16 v[108:111], v[204:207], a[136:139], v[108:111]
    s_waitcnt lgkmcnt(4)
    v_mfma_f32_16x16x32_bf16 v[112:115], v[208:211], a[120:123], v[112:115]
    v_mfma_f32_16x16x32_bf16 v[120:123], v[208:211], a[124:127], v[120:123]
    v_mfma_f32_16x16x32_bf16 v[128:131], v[208:211], a[128:131], v[128:131]
    v_mfma_f32_16x16x32_bf16 v[136:139], v[208:211], a[132:135], v[136:139]
    v_mfma_f32_16x16x32_bf16 v[144:147], v[208:211], a[136:139], v[144:147]
    s_waitcnt vmcnt(7) lgkmcnt(0)
    s_waitcnt vmcnt(2)
    s_barrier
    v_mfma_f32_16x16x32_bf16 v[116:119], v[212:215], a[120:123], v[116:119]
    ds_read_b128 a[100:103], v16 offset:40960
    v_add_u32 v12, 67584, v9
    v_mfma_f32_16x16x32_bf16 v[124:127], v[212:215], a[124:127], v[124:127]
    ds_read_b64_tr_b16 v[192:193], v12 offset:0
    ds_read_b64_tr_b16 v[194:195], v12 offset:8448
    v_mfma_f32_16x16x32_bf16 v[132:135], v[212:215], a[128:131], v[132:135]
    ds_read_b64_tr_b16 v[196:197], v12 offset:32
    ds_read_b64_tr_b16 v[198:199], v12 offset:8480
    v_mfma_f32_16x16x32_bf16 v[140:143], v[212:215], a[132:135], v[140:143]
    ds_read_b128 a[104:107], v16 offset:41984
    s_mov_b32 s51, 229376
    v_mfma_f32_16x16x32_bf16 v[148:151], v[212:215], a[136:139], v[148:151]
    ds_read_b128 a[108:111], v16 offset:43008
    v_mfma_f32_16x16x32_bf16 v[152:155], v[216:219], a[120:123], v[152:155]
    ds_read_b128 a[112:115], v16 offset:44032
    s_add_u32 m0, s49, 33792
    v_mfma_f32_16x16x32_bf16 v[160:163], v[216:219], a[124:127], v[160:163]
    ds_read_b128 a[116:119], v16 offset:45056
    v_mfma_f32_16x16x32_bf16 v[168:171], v[216:219], a[128:131], v[168:171]
    buffer_load_dwordx4 v28, s[36:39], s51 offen offset:0 nt lds
    v_mfma_f32_16x16x32_bf16 v[176:179], v[216:219], a[132:135], v[176:179]
    ds_read_b64_tr_b16 v[200:201], v12 offset:64
    ds_read_b64_tr_b16 v[202:203], v12 offset:8512
    v_mfma_f32_16x16x32_bf16 v[184:187], v[216:219], a[136:139], v[184:187]
    ds_read_b64_tr_b16 v[204:205], v12 offset:96
    ds_read_b64_tr_b16 v[206:207], v12 offset:8544
    v_mfma_f32_16x16x32_bf16 v[156:159], v[220:223], a[120:123], v[156:159]
    buffer_load_dwordx4 v29, s[36:39], s51 offen offset:1056 nt lds
    v_mfma_f32_16x16x32_bf16 v[164:167], v[220:223], a[124:127], v[164:167]
    ds_read_b64_tr_b16 v[208:209], v12 offset:128
    ds_read_b64_tr_b16 v[210:211], v12 offset:8576
    v_mfma_f32_16x16x32_bf16 v[172:175], v[220:223], a[128:131], v[172:175]
    buffer_load_dwordx4 v30, s[36:39], s51 offen offset:2112 nt lds
    v_mfma_f32_16x16x32_bf16 v[180:183], v[220:223], a[132:135], v[180:183]
    ds_read_b64_tr_b16 v[212:213], v12 offset:160
    ds_read_b64_tr_b16 v[214:215], v12 offset:8608
    v_mfma_f32_16x16x32_bf16 v[188:191], v[220:223], a[136:139], v[188:191]
    s_waitcnt lgkmcnt(8)
    v_mfma_f32_16x16x32_bf16 v[32:35], v[192:195], a[100:103], v[32:35]
    ds_read_b64_tr_b16 v[216:217], v12 offset:192
    ds_read_b64_tr_b16 v[218:219], v12 offset:8640
    v_mfma_f32_16x16x32_bf16 v[40:43], v[192:195], a[104:107], v[40:43]
    ds_read_b64_tr_b16 v[220:221], v12 offset:224
    ds_read_b64_tr_b16 v[222:223], v12 offset:8672
    v_mfma_f32_16x16x32_bf16 v[48:51], v[192:195], a[108:111], v[48:51]
    ds_read_b128 a[120:123], v16 offset:46080
    v_mfma_f32_16x16x32_bf16 v[56:59], v[192:195], a[112:115], v[56:59]
    buffer_load_dwordx4 v31, s[36:39], s51 offen offset:3168 nt lds
    v_mfma_f32_16x16x32_bf16 v[64:67], v[192:195], a[116:119], v[64:67]
    ds_read_b128 a[124:127], v16 offset:47104
    v_mfma_f32_16x16x32_bf16 v[36:39], v[196:199], a[100:103], v[36:39]
    ds_read_b128 a[128:131], v16 offset:48128
    v_mfma_f32_16x16x32_bf16 v[44:47], v[196:199], a[104:107], v[44:47]
    ds_read_b128 a[132:135], v16 offset:49152
    v_mfma_f32_16x16x32_bf16 v[52:55], v[196:199], a[108:111], v[52:55]
    s_add_u32 s51, s51, 2048
    s_add_u32 m0, s49, 38016
    v_mfma_f32_16x16x32_bf16 v[60:63], v[196:199], a[112:115], v[60:63]
    ds_read_b128 a[136:139], v16 offset:50176
    v_mfma_f32_16x16x32_bf16 v[68:71], v[196:199], a[116:119], v[68:71]
    s_waitcnt lgkmcnt(13)
    v_mfma_f32_16x16x32_bf16 v[72:75], v[200:203], a[100:103], v[72:75]
    buffer_load_dwordx4 v28, s[36:39], s51 offen offset:0 nt lds
    v_mfma_f32_16x16x32_bf16 v[80:83], v[200:203], a[104:107], v[80:83]
    ds_read_b64_tr_b16 v[192:193], v12 offset:16896
    ds_read_b64_tr_b16 v[194:195], v12 offset:25344
    v_mfma_f32_16x16x32_bf16 v[88:91], v[200:203], a[108:111], v[88:91]
    ds_read_b64_tr_b16 v[196:197], v12 offset:16928
    ds_read_b64_tr_b16 v[198:199], v12 offset:25376
    v_mfma_f32_16x16x32_bf16 v[96:99], v[200:203], a[112:115], v[96:99]
    ds_write_b128 v17, a[80:83] offset:20480
    v_mfma_f32_16x16x32_bf16 v[104:107], v[200:203], a[116:119], v[104:107]
    ds_write_b128 v17, a[84:87] offset:21504
    v_mfma_f32_16x16x32_bf16 v[76:79], v[204:207], a[100:103], v[76:79]
    buffer_load_dwordx4 v29, s[36:39], s51 offen offset:1056 nt lds
    v_mfma_f32_16x16x32_bf16 v[84:87], v[204:207], a[104:107], v[84:87]
    ds_read_b64_tr_b16 v[200:201], v12 offset:16960
    ds_read_b64_tr_b16 v[202:203], v12 offset:25408
    v_mfma_f32_16x16x32_bf16 v[92:95], v[204:207], a[108:111], v[92:95]
    ds_write_b128 v17, a[88:91] offset:22528
    v_mfma_f32_16x16x32_bf16 v[100:103], v[204:207], a[112:115], v[100:103]
    ds_write_b128 v17, a[92:95] offset:23552
    v_mfma_f32_16x16x32_bf16 v[108:111], v[204:207], a[116:119], v[108:111]
    s_waitcnt lgkmcnt(15)
    v_mfma_f32_16x16x32_bf16 v[112:115], v[208:211], a[100:103], v[112:115]
    ds_read_b64_tr_b16 v[204:205], v12 offset:16992
    ds_read_b64_tr_b16 v[206:207], v12 offset:25440
    v_mfma_f32_16x16x32_bf16 v[120:123], v[208:211], a[104:107], v[120:123]
    buffer_load_dwordx4 v30, s[36:39], s51 offen offset:2112 nt lds
    v_mfma_f32_16x16x32_bf16 v[128:131], v[208:211], a[108:111], v[128:131]
    ds_write_b128 v17, a[96:99] offset:24576
    v_mfma_f32_16x16x32_bf16 v[136:139], v[208:211], a[112:115], v[136:139]
    v_mfma_f32_16x16x32_bf16 v[144:147], v[208:211], a[116:119], v[144:147]
    v_mfma_f32_16x16x32_bf16 v[116:119], v[212:215], a[100:103], v[116:119]
    s_add_u32 s51, s49, 41184
    v_add_u32 v251, s51, v18
    v_mfma_f32_16x16x32_bf16 v[124:127], v[212:215], a[104:107], v[124:127]
    ds_read_b64_tr_b16 v[208:209], v12 offset:17024
    ds_read_b64_tr_b16 v[210:211], v12 offset:25472
    v_mfma_f32_16x16x32_bf16 v[132:135], v[212:215], a[108:111], v[132:135]
    ds_write_b128 v251, a[252:255]
    v_mfma_f32_16x16x32_bf16 v[140:143], v[212:215], a[112:115], v[140:143]
    v_mfma_f32_16x16x32_bf16 v[148:151], v[212:215], a[116:119], v[148:151]
    v_mfma_f32_16x16x32_bf16 v[152:155], v[216:219], a[100:103], v[152:155]
    ds_read_b64_tr_b16 v[212:213], v12 offset:17056
    ds_read_b64_tr_b16 v[214:215], v12 offset:25504
    v_mfma_f32_16x16x32_bf16 v[160:163], v[216:219], a[104:107], v[160:163]
    v_mfma_f32_16x16x32_bf16 v[168:171], v[216:219], a[108:111], v[168:171]
    v_mfma_f32_16x16x32_bf16 v[176:179], v[216:219], a[112:115], v[176:179]
    v_mfma_f32_16x16x32_bf16 v[184:187], v[216:219], a[116:119], v[184:187]
    v_mfma_f32_16x16x32_bf16 v[156:159], v[220:223], a[100:103], v[156:159]
    ds_read_b64_tr_b16 v[216:217], v12 offset:17088
    ds_read_b64_tr_b16 v[218:219], v12 offset:25536
    v_mfma_f32_16x16x32_bf16 v[164:167], v[220:223], a[104:107], v[164:167]
    v_mfma_f32_16x16x32_bf16 v[172:175], v[220:223], a[108:111], v[172:175]
    v_mfma_f32_16x16x32_bf16 v[180:183], v[220:223], a[112:115], v[180:183]
    v_mfma_f32_16x16x32_bf16 v[188:191], v[220:223], a[116:119], v[188:191]
    s_waitcnt lgkmcnt(15)
    v_mfma_f32_16x16x32_bf16 v[32:35], v[192:195], a[120:123], v[32:35]
    ds_read_b64_tr_b16 v[220:221], v12 offset:17120
    ds_read_b64_tr_b16 v[222:223], v12 offset:25568
    v_mfma_f32_16x16x32_bf16 v[40:43], v[192:195], a[124:127], v[40:43]
    v_mfma_f32_16x16x32_bf16 v[48:51], v[192:195], a[128:131], v[48:51]
    v_mfma_f32_16x16x32_bf16 v[56:59], v[192:195], a[132:135], v[56:59]
    v_mfma_f32_16x16x32_bf16 v[64:67], v[192:195], a[136:139], v[64:67]
    v_mfma_f32_16x16x32_bf16 v[36:39], v[196:199], a[120:123], v[36:39]
    v_mfma_f32_16x16x32_bf16 v[44:47], v[196:199], a[124:127], v[44:47]
    v_mfma_f32_16x16x32_bf16 v[52:55], v[196:199], a[128:131], v[52:55]
    v_mfma_f32_16x16x32_bf16 v[60:63], v[196:199], a[132:135], v[60:63]
    v_mfma_f32_16x16x32_bf16 v[68:71], v[196:199], a[136:139], v[68:71]
    s_waitcnt lgkmcnt(10)
    v_mfma_f32_16x16x32_bf16 v[72:75], v[200:203], a[120:123], v[72:75]
    v_mfma_f32_16x16x32_bf16 v[80:83], v[200:203], a[124:127], v[80:83]
    v_mfma_f32_16x16x32_bf16 v[88:91], v[200:203], a[128:131], v[88:91]
    v_mfma_f32_16x16x32_bf16 v[96:99], v[200:203], a[132:135], v[96:99]
    v_mfma_f32_16x16x32_bf16 v[104:107], v[200:203], a[136:139], v[104:107]
    v_mfma_f32_16x16x32_bf16 v[76:79], v[204:207], a[120:123], v[76:79]
    v_mfma_f32_16x16x32_bf16 v[84:87], v[204:207], a[124:127], v[84:87]
    v_mfma_f32_16x16x32_bf16 v[92:95], v[204:207], a[128:131], v[92:95]
    v_mfma_f32_16x16x32_bf16 v[100:103], v[204:207], a[132:135], v[100:103]
    v_mfma_f32_16x16x32_bf16 v[108:111], v[204:207], a[136:139], v[108:111]
    s_waitcnt lgkmcnt(4)
    v_mfma_f32_16x16x32_bf16 v[112:115], v[208:211], a[120:123], v[112:115]
    v_mfma_f32_16x16x32_bf16 v[120:123], v[208:211], a[124:127], v[120:123]
    v_mfma_f32_16x16x32_bf16 v[128:131], v[208:211], a[128:131], v[128:131]
    v_mfma_f32_16x16x32_bf16 v[136:139], v[208:211], a[132:135], v[136:139]
    v_mfma_f32_16x16x32_bf16 v[144:147], v[208:211], a[136:139], v[144:147]
    s_waitcnt vmcnt(7) lgkmcnt(0)
    s_waitcnt vmcnt(2)
    s_barrier
    v_mfma_f32_16x16x32_bf16 v[116:119], v[212:215], a[120:123], v[116:119]
    ds_read_b128 a[100:103], v16 offset:0
    v_add_u32 v12, 0, v9
    v_mfma_f32_16x16x32_bf16 v[124:127], v[212:215], a[124:127], v[124:127]
    ds_read_b64_tr_b16 v[192:193], v12 offset:0
    ds_read_b64_tr_b16 v[194:195], v12 offset:8448
    v_mfma_f32_16x16x32_bf16 v[132:135], v[212:215], a[128:131], v[132:135]
    ds_read_b64_tr_b16 v[196:197], v12 offset:32
    ds_read_b64_tr_b16 v[198:199], v12 offset:8480
    v_mfma_f32_16x16x32_bf16 v[140:143], v[212:215], a[132:135], v[140:143]
    ds_read_b128 a[104:107], v16 offset:1024
    v_add_u32 v28, 0, v4
    v_mfma_f32_16x16x32_bf16 v[148:151], v[212:215], a[136:139], v[148:151]
    v_subrev_u32 v29, 160, v4
    v_subrev_u32 v30, 320, v4
    v_subrev_u32 v31, 480, v4
    v_mfma_f32_16x16x32_bf16 v[152:155], v[216:219], a[120:123], v[152:155]
    ds_read_b128 a[108:111], v16 offset:2048
    s_lshl_b32 s56, s55, 7
    v_mfma_f32_16x16x32_bf16 v[160:163], v[216:219], a[124:127], v[160:163]
    ds_read_b128 a[112:115], v16 offset:3072
    ds_read_b128 a[116:119], v16 offset:4096
    v_mfma_f32_16x16x32_bf16 v[168:171], v[216:219], a[128:131], v[168:171]
    s_add_u32 s56, s56, s1
    s_add_u32 s55, s55, 1
    s_cmp_eq_u32 s55, 7
    s_cselect_b32 s55, 0, s55
    v_mfma_f32_16x16x32_bf16 v[176:179], v[216:219], a[132:135], v[176:179]
    s_add_u32 m0, s49, 67584
    s_nop 0
    buffer_load_dwordx4 v28, s[40:43], s56 offen offset:0  lds
    v_mfma_f32_16x16x32_bf16 v[184:187], v[216:219], a[136:139], v[184:187]
    ds_read_b64_tr_b16 v[200:201], v12 offset:64
    ds_read_b64_tr_b16 v[202:203], v12 offset:8512
    v_mfma_f32_16x16x32_bf16 v[156:159], v[220:223], a[120:123], v[156:159]
    ds_read_b64_tr_b16 v[204:205], v12 offset:96
    ds_read_b64_tr_b16 v[206:207], v12 offset:8544
    v_mfma_f32_16x16x32_bf16 v[164:167], v[220:223], a[124:127], v[164:167]
    buffer_load_dwordx4 v29, s[40:43], s56 offen offset:1056  lds
    v_mfma_f32_16x16x32_bf16 v[172:175], v[220:223], a[128:131], v[172:175]
    buffer_load_dwordx4 v30, s[40:43], s56 offen offset:2112  lds
    v_mfma_f32_16x16x32_bf16 v[180:183], v[220:223], a[132:135], v[180:183]
    ds_read_b64_tr_b16 v[208:209], v12 offset:128
    ds_read_b64_tr_b16 v[210:211], v12 offset:8576
    v_mfma_f32_16x16x32_bf16 v[188:191], v[220:223], a[136:139], v[188:191]
    s_waitcnt lgkmcnt(6)
    v_mfma_f32_16x16x32_bf16 v[32:35], v[192:195], a[100:103], v[32:35]
    ds_read_b64_tr_b16 v[212:213], v12 offset:160
    ds_read_b64_tr_b16 v[214:215], v12 offset:8608
    v_mfma_f32_16x16x32_bf16 v[40:43], v[192:195], a[104:107], v[40:43]
    ds_read_b64_tr_b16 v[216:217], v12 offset:192
    ds_read_b64_tr_b16 v[218:219], v12 offset:8640
    v_mfma_f32_16x16x32_bf16 v[48:51], v[192:195], a[108:111], v[48:51]
    ds_read_b64_tr_b16 v[220:221], v12 offset:224
    ds_read_b64_tr_b16 v[222:223], v12 offset:8672
    v_mfma_f32_16x16x32_bf16 v[56:59], v[192:195], a[112:115], v[56:59]
    buffer_load_dwordx4 v31, s[40:43], s56 offen offset:3168  lds
    v_mfma_f32_16x16x32_bf16 v[64:67], v[192:195], a[116:119], v[64:67]
    ds_read_b128 a[120:123], v16 offset:5120
    v_mfma_f32_16x16x32_bf16 v[36:39], v[196:199], a[100:103], v[36:39]
    ds_read_b128 a[124:127], v16 offset:6144
    v_mfma_f32_16x16x32_bf16 v[44:47], v[196:199], a[104:107], v[44:47]
    ds_read_b128 a[128:131], v16 offset:7168
    v_mfma_f32_16x16x32_bf16 v[52:55], v[196:199], a[108:111], v[52:55]
    s_add_u32 s51, s56, 3584
    s_add_u32 m0, s49, 71808
    v_mfma_f32_16x16x32_bf16 v[60:63], v[196:199], a[112:115], v[60:63]
    ds_read_b128 a[132:135], v16 offset:8192
    v_mfma_f32_16x16x32_bf16 v[68:71], v[196:199], a[116:119], v[68:71]
    s_waitcnt lgkmcnt(12)
    ds_read_b128 a[136:139], v16 offset:9216
    v_mfma_f32_16x16x32_bf16 v[72:75], v[200:203], a[100:103], v[72:75]
    buffer_load_dwordx4 v28, s[40:43], s51 offen offset:0  lds
    v_mfma_f32_16x16x32_bf16 v[80:83], v[200:203], a[104:107], v[80:83]
    ds_read_b64_tr_b16 v[192:193], v12 offset:16896
    ds_read_b64_tr_b16 v[194:195], v12 offset:25344
    v_mfma_f32_16x16x32_bf16 v[88:91], v[200:203], a[108:111], v[88:91]
    ds_read_b64_tr_b16 v[196:197], v12 offset:16928
    ds_read_b64_tr_b16 v[198:199], v12 offset:25376
    v_mfma_f32_16x16x32_bf16 v[96:99], v[200:203], a[112:115], v[96:99]
    v_mfma_f32_16x16x32_bf16 v[104:107], v[200:203], a[116:119], v[104:107]
    v_mfma_f32_16x16x32_bf16 v[76:79], v[204:207], a[100:103], v[76:79]
    buffer_load_dwordx4 v29, s[40:43], s51 offen offset:1056  lds
    v_mfma_f32_16x16x32_bf16 v[84:87], v[204:207], a[104:107], v[84:87]
    ds_read_b64_tr_b16 v[200:201], v12 offset:16960
    ds_read_b64_tr_b16 v[202:203], v12 offset:25408
    v_mfma_f32_16x16x32_bf16 v[92:95], v[204:207], a[108:111], v[92:95]
    v_mfma_f32_16x16x32_bf16 v[100:103], v[204:207], a[112:115], v[100:103]
    v_mfma_f32_16x16x32_bf16 v[108:111], v[204:207], a[116:119], v[108:111]
    s_waitcnt lgkmcnt(15)
    v_mfma_f32_16x16x32_bf16 v[112:115], v[208:211], a[100:103], v[112:115]
    ds_read_b64_tr_b16 v[204:205], v12 offset:16992
    ds_read_b64_tr_b16 v[206:207], v12 offset:25440
    v_mfma_f32_16x16x32_bf16 v[120:123], v[208:211], a[104:107], v[120:123]
    buffer_load_dwordx4 v30, s[40:43], s51 offen offset:2112  lds
    v_mfma_f32_16x16x32_bf16 v[128:131], v[208:211], a[108:111], v[128:131]
    v_mfma_f32_16x16x32_bf16 v[136:139], v[208:211], a[112:115], v[136:139]
    v_mfma_f32_16x16x32_bf16 v[144:147], v[208:211], a[116:119], v[144:147]
    v_mfma_f32_16x16x32_bf16 v[116:119], v[212:215], a[100:103], v[116:119]
    ds_read_b64_tr_b16 v[208:209], v12 offset:17024
    ds_read_b64_tr_b16 v[210:211], v12 offset:25472
    v_mfma_f32_16x16x32_bf16 v[124:127], v[212:215], a[104:107], v[124:127]
    v_mfma_f32_16x16x32_bf16 v[132:135], v[212:215], a[108:111], v[132:135]
    buffer_load_dwordx4 v31, s[40:43], s51 offen offset:3168  lds
    v_mfma_f32_16x16x32_bf16 v[140:143], v[212:215], a[112:115], v[140:143]
    v_mfma_f32_16x16x32_bf16 v[148:151], v[212:215], a[116:119], v[148:151]
    s_waitcnt lgkmcnt(15)
    v_mfma_f32_16x16x32_bf16 v[152:155], v[216:219], a[100:103], v[152:155]
    ds_read_b64_tr_b16 v[212:213], v12 offset:17056
    ds_read_b64_tr_b16 v[214:215], v12 offset:25504
    v_mfma_f32_16x16x32_bf16 v[160:163], v[216:219], a[104:107], v[160:163]
    v_mfma_f32_16x16x32_bf16 v[168:171], v[216:219], a[108:111], v[168:171]
    v_mfma_f32_16x16x32_bf16 v[176:179], v[216:219], a[112:115], v[176:179]
    v_mfma_f32_16x16x32_bf16 v[184:187], v[216:219], a[116:119], v[184:187]
    v_mfma_f32_16x16x32_bf16 v[156:159], v[220:223], a[100:103], v[156:159]
    ds_read_b64_tr_b16 v[216:217], v12 offset:17088
    ds_read_b64_tr_b16 v[218:219], v12 offset:25536
    v_mfma_f32_16x16x32_bf16 v[164:167], v[220:223], a[104:107], v[164:167]
    v_mfma_f32_16x16x32_bf16 v[172:175], v[220:223], a[108:111], v[172:175]
    v_mfma_f32_16x16x32_bf16 v[180:183], v[220:223], a[112:115], v[180:183]
    v_mfma_f32_16x16x32_bf16 v[188:191], v[220:223], a[116:119], v[188:191]
    s_waitcnt lgkmcnt(10)
    v_mfma_f32_16x16x32_bf16 v[32:35], v[192:195], a[120:123], v[32:35]
    ds_read_b64_tr_b16 v[220:221], v12 offset:17120
    ds_read_b64_tr_b16 v[222:223], v12 offset:25568
    v_mfma_f32_16x16x32_bf16 v[40:43], v[192:195], a[124:127], v[40:43]
    v_mfma_f32_16x16x32_bf16 v[48:51], v[192:195], a[128:131], v[48:51]
    v_mfma_f32_16x16x32_bf16 v[56:59], v[192:195], a[132:135], v[56:59]
    v_mfma_f32_16x16x32_bf16 v[64:67], v[192:195], a[136:139], v[64:67]
    v_mfma_f32_16x16x32_bf16 v[36:39], v[196:199], a[120:123], v[36:39]
    v_mfma_f32_16x16x32_bf16 v[44:47], v[196:199], a[124:127], v[44:47]
    v_mfma_f32_16x16x32_bf16 v[52:55], v[196:199], a[128:131], v[52:55]
    v_mfma_f32_16x16x32_bf16 v[60:63], v[196:199], a[132:135], v[60:63]
    v_mfma_f32_16x16x32_bf16 v[68:71], v[196:199], a[136:139], v[68:71]
    s_waitcnt lgkmcnt(8)
    v_mfma_f32_16x16x32_bf16 v[72:75], v[200:203], a[120:123], v[72:75]
    v_mfma_f32_16x16x32_bf16 v[80:83], v[200:203], a[124:127], v[80:83]
    v_mfma_f32_16x16x32_bf16 v[88:91], v[200:203], a[128:131], v[88:91]
    v_mfma_f32_16x16x32_bf16 v[96:99], v[200:203], a[132:135], v[96:99]
    v_mfma_f32_16x16x32_bf16 v[104:107], v[200:203], a[136:139], v[104:107]
    v_mfma_f32_16x16x32_bf16 v[76:79], v[204:207], a[120:123], v[76:79]
    v_mfma_f32_16x16x32_bf16 v[84:87], v[204:207], a[124:127], v[84:87]
    v_mfma_f32_16x16x32_bf16 v[92:95], v[204:207], a[128:131], v[92:95]
    v_mfma_f32_16x16x32_bf16 v[100:103], v[204:207], a[132:135], v[100:103]
    v_mfma_f32_16x16x32_bf16 v[108:111], v[204:207], a[136:139], v[108:111]
    s_waitcnt lgkmcnt(4)
    v_mfma_f32_16x16x32_bf16 v[112:115], v[208:211], a[120:123], v[112:115]
    v_mfma_f32_16x16x32_bf16 v[120:123], v[208:211], a[124:127], v[120:123]
    v_mfma_f32_16x16x32_bf16 v[128:131], v[208:211], a[128:131], v[128:131]
    v_mfma_f32_16x16x32_bf16 v[136:139], v[208:211], a[132:135], v[136:139]
    v_mfma_f32_16x16x32_bf16 v[144:147], v[208:211], a[136:139], v[144:147]
    s_waitcnt vmcnt(8) lgkmcnt(0)
    s_barrier
    v_mfma_f32_16x16x32_bf16 v[116:119], v[212:215], a[120:123], v[116:119]
    ds_read_b128 a[100:103], v16 offset:20480
    v_add_u32 v12, 33792, v9
    v_mfma_f32_16x16x32_bf16 v[124:127], v[212:215], a[124:127], v[124:127]
    ds_read_b64_tr_b16 v[192:193], v12 offset:0
    s_lshl_b32 s56, s55, 7
    v_mfma_f32_16x16x32_bf16 v[132:135], v[212:215], a[128:131], v[132:135]
    ds_read_b64_tr_b16 v[194:195], v12 offset:8448
    s_add_u32 s56, s56, s1
    v_mfma_f32_16x16x32_bf16 v[140:143], v[212:215], a[132:135], v[140:143]
    ds_read_b64_tr_b16 v[196:197], v12 offset:32
    v_mfma_f32_16x16x32_bf16 v[148:151], v[212:215], a[136:139], v[148:151]
    ds_read_b64_tr_b16 v[198:199], v12 offset:8480
    v_mfma_f32_16x16x32_bf16 v[152:155], v[216:219], a[120:123], v[152:155]
    ds_read_b128 a[104:107], v16 offset:21504
    ds_read_b128 a[108:111], v16 offset:22528
    v_mfma_f32_16x16x32_bf16 v[160:163], v[216:219], a[124:127], v[160:163]
    ds_read_b128 a[112:115], v16 offset:23552
    ds_read_b128 a[116:119], v16 offset:24576
    v_mfma_f32_16x16x32_bf16 v[168:171], v[216:219], a[128:131], v[168:171]
    s_add_u32 s55, s55, 1
    s_cmp_eq_u32 s55, 7
    s_cselect_b32 s55, 0, s55
    v_mfma_f32_16x16x32_bf16 v[176:179], v[216:219], a[132:135], v[176:179]
    s_add_u32 m0, s49, 0
    s_nop 0
    buffer_load_dwordx4 v28, s[40:43], s56 offen offset:0  lds
    v_mfma_f32_16x16x32_bf16 v[184:187], v[216:219], a[136:139], v[184:187]
    ds_read_b64_tr_b16 v[200:201], v12 offset:64
    v_mfma_f32_16x16x32_bf16 v[156:159], v[220:223], a[120:123], v[156:159]
    ds_read_b64_tr_b16 v[202:203], v12 offset:8512
    v_mfma_f32_16x16x32_bf16 v[164:167], v[220:223], a[124:127], v[164:167]
    ds_read_b64_tr_b16 v[204:205], v12 offset:96
    v_mfma_f32_16x16x32_bf16 v[172:175], v[220:223], a[128:131], v[172:175]
    ds_read_b64_tr_b16 v[206:207], v12 offset:8544
    v_mfma_f32_16x16x32_bf16 v[180:183], v[220:223], a[132:135], v[180:183]
    buffer_load_dwordx4 v29, s[40:43], s56 offen offset:1056  lds
    v_mfma_f32_16x16x32_bf16 v[188:191], v[220:223], a[136:139], v[188:191]
    s_waitcnt lgkmcnt(4)
    ds_read_b64_tr_b16 v[208:209], v12 offset:16896
    s_cmp_lt_u32 s4, 0x40000000
    s_cbranch_scc1 L_clsB
    v_mfma_f32_16x16x32_bf16 v[32:35], v[192:195], a[100:103], v[32:35]
    buffer_load_dwordx4 v30, s[40:43], s56 offen offset:2112  lds
    v_mfma_f32_16x16x32_bf16 v[40:43], v[192:195], a[104:107], v[40:43]
    ds_read_b128 a[120:123], v16 offset:25600
    v_mfma_f32_16x16x32_bf16 v[48:51], v[192:195], a[108:111], v[48:51]
    ds_read_b128 a[124:127], v16 offset:26624
    v_mfma_f32_16x16x32_bf16 v[56:59], v[192:195], a[112:115], v[56:59]
    ds_read_b128 a[128:131], v16 offset:27648
    v_mfma_f32_16x16x32_bf16 v[64:67], v[192:195], a[116:119], v[64:67]
    ds_read_b128 a[132:135], v16 offset:28672
    v_mfma_f32_16x16x32_bf16 v[36:39], v[196:199], a[100:103], v[36:39]
    ds_read_b128 a[136:139], v16 offset:29696
    v_lshlrev_b32 v236, 2, v0
    v_mfma_f32_16x16x32_bf16 v[44:47], v[196:199], a[104:107], v[44:47]
    ds_read_b64_tr_b16 v[210:211], v12 offset:25344
    v_mfma_f32_16x16x32_bf16 v[52:55], v[196:199], a[108:111], v[52:55]
    ds_read_b64_tr_b16 v[212:213], v12 offset:16928
    v_mfma_f32_16x16x32_bf16 v[60:63], v[196:199], a[112:115], v[60:63]
    ds_read_b64_tr_b16 v[214:215], v12 offset:25376
    v_mfma_f32_16x16x32_bf16 v[68:71], v[196:199], a[116:119], v[68:71]
    s_waitcnt lgkmcnt(9)
    ds_read_b64_tr_b16 v[216:217], v12 offset:16960
    v_mfma_f32_16x16x32_bf16 v[72:75], v[200:203], a[100:103], v[72:75]
    buffer_load_dwordx4 v31, s[40:43], s56 offen offset:3168  lds
    v_mfma_f32_16x16x32_bf16 v[80:83], v[200:203], a[104:107], v[80:83]
    s_add_u32 s51, s56, 3584
    s_add_u32 m0, s49, 4224
    v_mfma_f32_16x16x32_bf16 v[88:91], v[200:203], a[108:111], v[88:91]
    buffer_load_dwordx4 v28, s[40:43], s51 offen offset:0  lds
    v_mfma_f32_16x16x32_bf16 v[96:99], v[200:203], a[112:115], v[96:99]
    ds_read_b64_tr_b16 v[218:219], v12 offset:25408
    v_mfma_f32_16x16x32_bf16 v[104:107], v[200:203], a[116:119], v[104:107]
    ds_read_b64_tr_b16 v[220:221], v12 offset:16992
    v_mfma_f32_16x16x32_bf16 v[76:79], v[204:207], a[100:103], v[76:79]
    ds_read_b64_tr_b16 v[222:223], v12 offset:25440
    v_mfma_f32_16x16x32_bf16 v[84:87], v[204:207], a[104:107], v[84:87]
    buffer_load_dwordx4 v29, s[40:43], s51 offen offset:1056  lds
    v_mfma_f32_16x16x32_bf16 v[92:95], v[204:207], a[108:111], v[92:95]
    ds_read_b64_tr_b16 v[192:193], v12 offset:128
    v_mfma_f32_16x16x32_bf16 v[100:103], v[204:207], a[112:115], v[100:103]
    ds_read_b64_tr_b16 v[194:195], v12 offset:8576
    v_mfma_f32_16x16x32_bf16 v[108:111], v[204:207], a[116:119], v[108:111]
    s_waitcnt lgkmcnt(6)
    ds_read_b64_tr_b16 v[196:197], v12 offset:160
    v_mfma_f32_16x16x32_bf16 v[32:35], v[208:211], a[120:123], v[32:35]
    ds_read_b64_tr_b16 v[198:199], v12 offset:8608
    v_mfma_f32_16x16x32_bf16 v[40:43], v[208:211], a[124:127], v[40:43]
    buffer_load_dwordx4 v30, s[40:43], s51 offen offset:2112  lds
    v_mfma_f32_16x16x32_bf16 v[48:51], v[208:211], a[128:131], v[48:51]
    v_mfma_f32_16x16x32_bf16 v[56:59], v[208:211], a[132:135], v[56:59]
    v_mfma_f32_16x16x32_bf16 v[64:67], v[208:211], a[136:139], v[64:67]
    ds_read_b64_tr_b16 v[200:201], v12 offset:17024
    s_add_u32 s58, s52, 0
    v_mfma_f32_16x16x32_bf16 v[36:39], v[212:215], a[120:123], v[36:39]
    ds_read_b64_tr_b16 v[202:203], v12 offset:25472
    s_add_u32 s59, s52, 4096
    v_mfma_f32_16x16x32_bf16 v[44:47], v[212:215], a[124:127], v[44:47]
    ds_read_b64_tr_b16 v[204:205], v12 offset:17056
    v_mfma_f32_16x16x32_bf16 v[52:55], v[212:215], a[128:131], v[52:55]
    buffer_load_dwordx4 v31, s[40:43], s51 offen offset:3168  lds
    v_mfma_f32_16x16x32_bf16 v[60:63], v[212:215], a[132:135], v[60:63]
    ds_read_b64_tr_b16 v[206:207], v12 offset:25504
    v_mfma_f32_16x16x32_bf16 v[68:71], v[212:215], a[136:139], v[68:71]
    s_waitcnt lgkmcnt(8)
    v_cvt_pk_bf16_f32 v32, v32, v33
    v_cvt_pk_bf16_f32 v33, v34, v35
    v_mfma_f32_16x16x32_bf16 v[72:75], v[216:219], a[120:123], v[72:75]
    ds_read_b64_tr_b16 v[208:209], v12 offset:192
    v_cvt_pk_bf16_f32 v34, v36, v37
    v_mfma_f32_16x16x32_bf16 v[80:83], v[216:219], a[124:127], v[80:83]
    ds_read_b64_tr_b16 v[210:211], v12 offset:8640
    v_cvt_pk_bf16_f32 v35, v38, v39
    v_mfma_f32_16x16x32_bf16 v[88:91], v[216:219], a[128:131], v[88:91]
    ds_read_b64_tr_b16 v[212:213], v12 offset:224
    v_cvt_pk_bf16_f32 v40, v40, v41
    v_mfma_f32_16x16x32_bf16 v[96:99], v[216:219], a[132:135], v[96:99]
    ds_read_b64_tr_b16 v[214:215], v12 offset:8672
    v_cvt_pk_bf16_f32 v41, v42, v43
    v_mfma_f32_16x16x32_bf16 v[104:107], v[216:219], a[136:139], v[104:107]
    ds_write_b128 v11, v[32:35] offset:0
    v_mfma_f32_16x16x32_bf16 v[76:79], v[220:223], a[120:123], v[76:79]
    ds_read_b64_tr_b16 v[216:217], v12 offset:17088
    v_cvt_pk_bf16_f32 v42, v44, v45
    v_mfma_f32_16x16x32_bf16 v[84:87], v[220:223], a[124:127], v[84:87]
    ds_read_b64_tr_b16 v[218:219], v12 offset:25536
    v_cvt_pk_bf16_f32 v43, v46, v47
    v_mfma_f32_16x16x32_bf16 v[92:95], v[220:223], a[128:131], v[92:95]
    ds_write_b128 v11, v[40:43] offset:1024
    v_mfma_f32_16x16x32_bf16 v[100:103], v[220:223], a[132:135], v[100:103]
    v_cvt_pk_bf16_f32 v48, v48, v49
    v_cvt_pk_bf16_f32 v49, v50, v51
    v_mfma_f32_16x16x32_bf16 v[108:111], v[220:223], a[136:139], v[108:111]
    s_waitcnt lgkmcnt(12)
    v_cvt_pk_bf16_f32 v50, v52, v53
    v_cvt_pk_bf16_f32 v51, v54, v55
    v_cvt_pk_bf16_f32 v56, v56, v57
    v_mfma_f32_16x16x32_bf16 v[112:115], v[192:195], a[100:103], v[112:115]
    ds_read_b64_tr_b16 v[220:221], v12 offset:17120
    v_cvt_pk_bf16_f32 v57, v58, v59
    v_cvt_pk_bf16_f32 v58, v60, v61
    v_mfma_f32_16x16x32_bf16 v[120:123], v[192:195], a[104:107], v[120:123]
    ds_read_b64_tr_b16 v[222:223], v12 offset:25568
    v_cvt_pk_bf16_f32 v59, v62, v63
    v_cvt_pk_bf16_f32 v64, v64, v65
    v_mfma_f32_16x16x32_bf16 v[128:131], v[192:195], a[108:111], v[128:131]
    ds_write_b128 v11, v[48:51] offset:2048
    v_mfma_f32_16x16x32_bf16 v[136:139], v[192:195], a[112:115], v[136:139]
    ds_write_b128 v11, v[56:59] offset:3072
    v_cvt_pk_bf16_f32 v65, v66, v67
    v_cvt_pk_bf16_f32 v66, v68, v69
    v_cvt_pk_bf16_f32 v67, v70, v71
    v_cvt_pk_bf16_f32 v72, v72, v73
    v_cvt_pk_bf16_f32 v73, v74, v75
    v_cvt_pk_bf16_f32 v74, v76, v77
    v_cvt_pk_bf16_f32 v75, v78, v79
    v_mfma_f32_16x16x32_bf16 v[144:147], v[192:195], a[116:119], v[144:147]
    v_cvt_pk_bf16_f32 v80, v80, v81
    v_cvt_pk_bf16_f32 v81, v82, v83
    v_mfma_f32_16x16x32_bf16 v[116:119], v[196:199], a[100:103], v[116:119]
    v_cvt_pk_bf16_f32 v82, v84, v85
    v_cvt_pk_bf16_f32 v83, v86, v87
    v_mfma_f32_16x16x32_bf16 v[124:127], v[196:199], a[104:107], v[124:127]
    ds_write_b128 v11, v[64:67] offset:4096
    v_mfma_f32_16x16x32_bf16 v[132:135], v[196:199], a[108:111], v[132:135]
    s_add_u32 s58, s52, 10240
    v_cvt_pk_bf16_f32 v88, v88, v89
    v_cvt_pk_bf16_f32 v89, v90, v91
    v_mfma_f32_16x16x32_bf16 v[140:143], v[196:199], a[112:115], v[140:143]
    s_add_u32 s59, s52, 14336
    v_cvt_pk_bf16_f32 v90, v92, v93
    v_cvt_pk_bf16_f32 v91, v94, v95
    v_mfma_f32_16x16x32_bf16 v[148:151], v[196:199], a[116:119], v[148:151]
    s_waitcnt lgkmcnt(13)
    v_cvt_pk_bf16_f32 v96, v96, v97
    v_cvt_pk_bf16_f32 v97, v98, v99
    v_mfma_f32_16x16x32_bf16 v[112:115], v[200:203], a[120:123], v[112:115]
    ds_write_b128 v11, v[72:75] offset:10240
    v_mfma_f32_16x16x32_bf16 v[120:123], v[200:203], a[124:127], v[120:123]
    ds_write_b128 v11, v[80:83] offset:11264
    v_mfma_f32_16x16x32_bf16 v[128:131], v[200:203], a[128:131], v[128:131]
    ds_write_b128 v11, v[88:91] offset:12288
    v_cvt_pk_bf16_f32 v98, v100, v101
    v_cvt_pk_bf16_f32 v99, v102, v103
    v_mfma_f32_16x16x32_bf16 v[136:139], v[200:203], a[132:135], v[136:139]
    v_cvt_pk_bf16_f32 v104, v104, v105
    v_cvt_pk_bf16_f32 v105, v106, v107
    v_mfma_f32_16x16x32_bf16 v[144:147], v[200:203], a[136:139], v[144:147]
    ds_write_b128 v11, v[96:99] offset:13312
    v_mfma_f32_16x16x32_bf16 v[116:119], v[204:207], a[120:123], v[116:119]
    v_cvt_pk_bf16_f32 v106, v108, v109
    v_cvt_pk_bf16_f32 v107, v110, v111
    v_mfma_f32_16x16x32_bf16 v[124:127], v[204:207], a[124:127], v[124:127]
    ds_write_b128 v11, v[104:107] offset:14336
    v_mfma_f32_16x16x32_bf16 v[132:135], v[204:207], a[128:131], v[132:135]
    s_add_u32 s58, s52, 20480
    s_add_u32 s59, s52, 24576
    v_mfma_f32_16x16x32_bf16 v[140:143], v[204:207], a[132:135], v[140:143]
    v_mfma_f32_16x16x32_bf16 v[148:151], v[204:207], a[136:139], v[148:151]
    s_waitcnt lgkmcnt(14)
    v_cvt_pk_bf16_f32 v112, v112, v113
    v_cvt_pk_bf16_f32 v113, v114, v115
    v_mfma_f32_16x16x32_bf16 v[152:155], v[208:211], a[100:103], v[152:155]
    v_cvt_pk_bf16_f32 v114, v116, v117
    v_cvt_pk_bf16_f32 v115, v118, v119
    v_mfma_f32_16x16x32_bf16 v[160:163], v[208:211], a[104:107], v[160:163]
    v_cvt_pk_bf16_f32 v120, v120, v121
    v_cvt_pk_bf16_f32 v121, v122, v123
    v_mfma_f32_16x16x32_bf16 v[168:171], v[208:211], a[108:111], v[168:171]
    v_cvt_pk_bf16_f32 v122, v124, v125
    v_cvt_pk_bf16_f32 v123, v126, v127
    v_mfma_f32_16x16x32_bf16 v[176:179], v[208:211], a[112:115], v[176:179]
    v_cvt_pk_bf16_f32 v128, v128, v129
    v_cvt_pk_bf16_f32 v129, v130, v131
    v_mfma_f32_16x16x32_bf16 v[184:187], v[208:211], a[116:119], v[184:187]
    ds_write_b128 v11, v[112:115] offset:40960
    s_waitcnt vmcnt(8) lgkmcnt(0)
    s_barrier
    v_mfma_f32_16x16x32_bf16 v[156:159], v[212:215], a[100:103], v[156:159]
    s_lshl_b32 s56, s55, 7
    v_cvt_pk_bf16_f32 v130, v132, v133
    v_cvt_pk_bf16_f32 v131, v134, v135
    v_add_u32 v12, 67584, v10
    v_mfma_f32_16x16x32_bf16 v[164:167], v[212:215], a[104:107], v[164:167]
    ds_read_b64_tr_b16 v[192:193], v12 offset:0
    v_cvt_pk_bf16_f32 v136, v136, v137
    v_cvt_pk_bf16_f32 v137, v138, v139
    v_mfma_f32_16x16x32_bf16 v[172:175], v[212:215], a[108:111], v[172:175]
    ds_read_b64_tr_b16 v[194:195], v12 offset:256
    v_cvt_pk_bf16_f32 v138, v140, v141
    v_cvt_pk_bf16_f32 v139, v142, v143
    v_mfma_f32_16x16x32_bf16 v[180:183], v[212:215], a[112:115], v[180:183]
    ds_read_b64_tr_b16 v[196:197], v12 offset:16896
    v_cvt_pk_bf16_f32 v144, v144, v145
    v_cvt_pk_bf16_f32 v145, v146, v147
    v_cvt_pk_bf16_f32 v146, v148, v149
    v_mfma_f32_16x16x32_bf16 v[188:191], v[212:215], a[116:119], v[188:191]
    ds_read_b64_tr_b16 v[198:199], v12 offset:17152
    v_cvt_pk_bf16_f32 v147, v150, v151
    v_mfma_f32_16x16x32_bf16 v[152:155], v[216:219], a[120:123], v[152:155]
    s_add_u32 s56, s56, s1
    s_add_u32 s55, s55, 1
    s_cmp_eq_u32 s55, 7
    s_cselect_b32 s55, 0, s55
    v_mfma_f32_16x16x32_bf16 v[160:163], v[216:219], a[124:127], v[160:163]
    s_add_u32 m0, s49, 33792
    s_nop 0
    buffer_load_dwordx4 v28, s[40:43], s56 offen offset:0  lds
    v_mfma_f32_16x16x32_bf16 v[168:171], v[216:219], a[128:131], v[168:171]
    buffer_load_dwordx4 v29, s[40:43], s56 offen offset:1056  lds
    ds_read_b128 a[160:163], v5 offset:0
    v_mfma_f32_16x16x32_bf16 v[176:179], v[216:219], a[132:135], v[176:179]
    ds_read_b128 a[164:167], v5 offset:1024
    ds_read_b128 a[168:171], v5 offset:2048
    v_mfma_f32_16x16x32_bf16 v[184:187], v[216:219], a[136:139], v[184:187]
    ds_read_b128 a[172:175], v5 offset:3072
    ds_read_b128 a[176:179], v5 offset:4096
    ds_read_b128 a[180:183], v5 offset:5120
    v_mfma_f32_16x16x32_bf16 v[156:159], v[220:223], a[120:123], v[156:159]
    ds_read_b128 a[184:187], v5 offset:6144
    ds_read_b128 a[188:191], v5 offset:7168
    v_mfma_f32_16x16x32_bf16 v[164:167], v[220:223], a[124:127], v[164:167]
    ds_read_b128 a[192:195], v5 offset:8192
    ds_read_b128 a[196:199], v5 offset:9216
    v_mfma_f32_16x16x32_bf16 v[172:175], v[220:223], a[128:131], v[172:175]
    ds_read_b64_tr_b16 v[200:201], v12 offset:512
    ds_read_b64_tr_b16 v[202:203], v12 offset:768
    v_mfma_f32_16x16x32_bf16 v[180:183], v[220:223], a[132:135], v[180:183]
    ds_read_b64_tr_b16 v[204:205], v12 offset:17408
    ds_read_b64_tr_b16 v[206:207], v12 offset:17664
    buffer_load_dwordx4 v30, s[40:43], s56 offen offset:2112  lds
    v_mfma_f32_16x16x32_bf16 v[188:191], v[220:223], a[136:139], v[188:191]
    s_waitcnt lgkmcnt(4)
    v_cvt_pk_bf16_f32 v152, v152, v153
    v_cvt_pk_bf16_f32 v153, v154, v155
    v_cvt_pk_bf16_f32 v154, v156, v157
    v_cvt_pk_bf16_f32 v155, v158, v159
    v_mfma_f32_16x16x32_bf16 v[36:39], v[192:195], a[160:163], 0
    buffer_load_dwordx4 v31, s[40:43], s56 offen offset:3168  lds
    v_cvt_pk_bf16_f32 v160, v160, v161
    v_cvt_pk_bf16_f32 v161, v162, v163
    v_cvt_pk_bf16_f32 v162, v164, v165
    v_cvt_pk_bf16_f32 v163, v166, v167
    v_mfma_f32_16x16x32_bf16 v[44:47], v[192:195], a[164:167], 0
    s_add_u32 s51, s56, 3584
    v_cvt_pk_bf16_f32 v168, v168, v169
    v_cvt_pk_bf16_f32 v169, v170, v171
    v_cvt_pk_bf16_f32 v170, v172, v173
    v_cvt_pk_bf16_f32 v171, v174, v175
    s_add_u32 m0, s49, 38016
    v_mfma_f32_16x16x32_bf16 v[52:55], v[192:195], a[168:171], 0
    buffer_load_dwordx4 v28, s[40:43], s51 offen offset:0  lds
    v_cvt_pk_bf16_f32 v176, v176, v177
    v_cvt_pk_bf16_f32 v177, v178, v179
    v_cvt_pk_bf16_f32 v178, v180, v181
    v_mfma_f32_16x16x32_bf16 v[60:63], v[192:195], a[172:175], 0
    ds_read_b128 a[200:203], v5 offset:10240
    v_cvt_pk_bf16_f32 v179, v182, v183
    v_cvt_pk_bf16_f32 v184, v184, v185
    v_cvt_pk_bf16_f32 v185, v186, v187
    v_cvt_pk_bf16_f32 v186, v188, v189
    v_cvt_pk_bf16_f32 v187, v190, v191
    v_mfma_f32_16x16x32_bf16 v[68:71], v[192:195], a[176:179], 0
    ds_read_b128 a[204:207], v5 offset:11264
    ds_read_b128 a[208:211], v5 offset:12288
    ds_read_b128 a[212:215], v5 offset:13312
    v_mfma_f32_16x16x32_bf16 v[36:39], v[196:199], a[180:183], v[36:39]
    ds_read_b128 a[216:219], v5 offset:14336
    ds_read_b128 a[220:223], v5 offset:15360
    ds_read_b128 a[224:227], v5 offset:16384
    ds_read_b128 a[228:231], v5 offset:17408
    v_mfma_f32_16x16x32_bf16 v[44:47], v[196:199], a[184:187], v[44:47]
    ds_read_b128 a[232:235], v5 offset:18432
    ds_read_b128 a[236:239], v5 offset:19456
    ds_read_b64_tr_b16 v[208:209], v12 offset:8448
    v_mfma_f32_16x16x32_bf16 v[52:55], v[196:199], a[188:191], v[52:55]
    buffer_load_dwordx4 v29, s[40:43], s51 offen offset:1056  lds
    ds_read_b64_tr_b16 v[210:211], v12 offset:8704
    ds_read_b64_tr_b16 v[212:213], v12 offset:25344
    v_mfma_f32_16x16x32_bf16 v[60:63], v[196:199], a[192:195], v[60:63]
    ds_write_b128 v11, v[120:123] offset:41984
    ds_write_b128 v11, v[128:131] offset:43008
    ds_write_b128 v11, v[136:139] offset:44032
    ds_write_b128 v11, v[144:147] offset:45056
    v_mfma_f32_16x16x32_bf16 v[68:71], v[196:199], a[196:199], v[68:71]
    ds_read_b64_tr_b16 v[214:215], v12 offset:25600
    ds_read_b64_tr_b16 v[216:217], v12 offset:8960
    s_waitcnt lgkmcnt(2)
    s_barrier
    v_mfma_f32_16x16x32_bf16 v[36:39], v[200:203], a[200:203], v[36:39]
    buffer_load_dwordx4 v30, s[40:43], s51 offen offset:2112  lds
    ds_read_b64_tr_b16 v[218:219], v12 offset:9216
    s_add_u32 s58, s52, 30720
    v_mfma_f32_16x16x32_bf16 v[44:47], v[200:203], a[204:207], v[44:47]
    ds_read_b64_tr_b16 v[220:221], v12 offset:25856
    ds_read_b64_tr_b16 v[222:223], v12 offset:26112
    ds_read_b128 a[0:3], v5 offset:40960
    v_mfma_f32_16x16x32_bf16 v[52:55], v[200:203], a[208:211], v[52:55]
    buffer_load_dwordx4 v31, s[40:43], s51 offen offset:3168  lds
    ds_read_b128 a[4:7], v5 offset:41984
    v_mfma_f32_16x16x32_bf16 v[60:63], v[200:203], a[212:215], v[60:63]
    ds_read_b128 a[8:11], v5 offset:43008
    ds_read_b128 a[12:15], v5 offset:44032
    s_add_u32 s59, s52, 34816
    v_mfma_f32_16x16x32_bf16 v[68:71], v[200:203], a[216:219], v[68:71]
    ds_read_b128 a[16:19], v5 offset:45056
    ds_read_b128 a[20:23], v5 offset:46080
    ds_read_b128 a[24:27], v5 offset:47104
    v_mfma_f32_16x16x32_bf16 v[36:39], v[204:207], a[220:223], v[36:39]
    ds_read_b128 a[28:31], v5 offset:48128
    ds_read_b128 a[32:35], v5 offset:49152
    v_mfma_f32_16x16x32_bf16 v[44:47], v[204:207], a[224:227], v[44:47]
    ds_read_b128 a[36:39], v5 offset:50176
    v_mfma_f32_16x16x32_bf16 v[52:55], v[204:207], a[228:231], v[52:55]
    ds_write_b128 v11, v[152:155] offset:51200
    v_mfma_f32_16x16x32_bf16 v[60:63], v[204:207], a[232:235], v[60:63]
    ds_write_b128 v11, v[160:163] offset:52224
    ds_write_b128 v11, v[168:171] offset:53248
    ds_write_b128 v11, v[176:179] offset:54272
    ds_write_b128 v11, v[184:187] offset:55296
    v_mfma_f32_16x16x32_bf16 v[68:71], v[204:207], a[236:239], v[68:71]
    s_waitcnt vmcnt(8) lgkmcnt(0)
    s_barrier
    v_mfma_f32_16x16x32_bf16 v[36:39], v[208:211], a[0:3], v[36:39]
    ds_read_b128 a[40:43], v5 offset:51200
    v_add_u32 v12, 0, v10
    s_lshl_b32 s56, s55, 7
    v_mfma_f32_16x16x32_bf16 v[44:47], v[208:211], a[4:7], v[44:47]
    ds_read_b128 a[44:47], v5 offset:52224
    ds_read_b128 a[48:51], v5 offset:53248
    v_mfma_f32_16x16x32_bf16 v[52:55], v[208:211], a[8:11], v[52:55]
    ds_read_b128 a[52:55], v5 offset:54272
    s_add_u32 s56, s56, s1
    v_mfma_f32_16x16x32_bf16 v[60:63], v[208:211], a[12:15], v[60:63]
    ds_read_b128 a[56:59], v5 offset:55296
    ds_read_b128 a[60:63], v5 offset:56320
    v_mfma_f32_16x16x32_bf16 v[68:71], v[208:211], a[16:19], v[68:71]
    ds_read_b128 a[64:67], v5 offset:57344
    ds_read_b128 a[68:71], v5 offset:58368
    v_mfma_f32_16x16x32_bf16 v[36:39], v[212:215], a[20:23], v[36:39]
    ds_read_b128 a[72:75], v5 offset:59392
    ds_read_b128 a[76:79], v5 offset:60416
    v_mfma_f32_16x16x32_bf16 v[44:47], v[212:215], a[24:27], v[44:47]
    s_add_u32 s55, s55, 1
    s_cmp_eq_u32 s55, 7
    s_cselect_b32 s55, 0, s55
    s_add_u32 m0, s49, 67584
    v_mfma_f32_16x16x32_bf16 v[52:55], v[212:215], a[28:31], v[52:55]
    buffer_load_dwordx4 v28, s[40:43], s56 offen offset:0  lds
    v_mfma_f32_16x16x32_bf16 v[60:63], v[212:215], a[32:35], v[60:63]
    ds_read_b64_tr_b16 v[192:193], v12 offset:0
    ds_read_b64_tr_b16 v[194:195], v12 offset:256
    v_mfma_f32_16x16x32_bf16 v[68:71], v[212:215], a[36:39], v[68:71]
    s_waitcnt lgkmcnt(2)
    ds_read_b64_tr_b16 v[196:197], v12 offset:16896
    ds_read_b64_tr_b16 v[198:199], v12 offset:17152
    v_mfma_f32_16x16x32_bf16 v[36:39], v[216:219], a[40:43], v[36:39]
    buffer_load_dwordx4 v29, s[40:43], s56 offen offset:1056  lds
    v_mfma_f32_16x16x32_bf16 v[44:47], v[216:219], a[44:47], v[44:47]
    buffer_load_dwordx4 v30, s[40:43], s56 offen offset:2112  lds
    v_mfma_f32_16x16x32_bf16 v[52:55], v[216:219], a[48:51], v[52:55]
    buffer_load_dwordx4 v31, s[40:43], s56 offen offset:3168  lds
    v_mfma_f32_16x16x32_bf16 v[60:63], v[216:219], a[52:55], v[60:63]
    ds_read_b64_tr_b16 v[200:201], v12 offset:512
    s_add_u32 s51, s56, 3584
    v_mfma_f32_16x16x32_bf16 v[68:71], v[216:219], a[56:59], v[68:71]
    ds_read_b64_tr_b16 v[202:203], v12 offset:768
    s_add_u32 m0, s49, 71808
    v_mfma_f32_16x16x32_bf16 v[36:39], v[220:223], a[60:63], v[36:39]
    ds_read_b64_tr_b16 v[204:205], v12 offset:17408
    v_mfma_f32_16x16x32_bf16 v[44:47], v[220:223], a[64:67], v[44:47]
    ds_read_b64_tr_b16 v[206:207], v12 offset:17664
    v_mfma_f32_16x16x32_bf16 v[52:55], v[220:223], a[68:71], v[52:55]
    buffer_load_dwordx4 v28, s[40:43], s51 offen offset:0  lds
    v_mfma_f32_16x16x32_bf16 v[60:63], v[220:223], a[72:75], v[60:63]
    buffer_load_dwordx4 v29, s[40:43], s51 offen offset:1056  lds
    v_mfma_f32_16x16x32_bf16 v[68:71], v[220:223], a[76:79], v[68:71]
    s_waitcnt lgkmcnt(4)
    ds_read_b64_tr_b16 v[208:209], v12 offset:8448
    v_mfma_f32_16x16x32_bf16 v[76:79], v[192:195], a[160:163], 0
    buffer_load_dwordx4 v30, s[40:43], s51 offen offset:2112  lds
    v_mfma_f32_16x16x32_bf16 v[84:87], v[192:195], a[164:167], 0
    s_mov_b32 s7, 200000
    ds_read_b64_tr_b16 v[210:211], v12 offset:8704
    v_mfma_f32_16x16x32_bf16 v[92:95], v[192:195], a[168:171], 0
    ds_read_b64_tr_b16 v[212:213], v12 offset:25344
    v_lshrrev_b32 v16, 4, v0
    v_mfma_f32_16x16x32_bf16 v[100:103], v[192:195], a[172:175], 0
    ds_read_b64_tr_b16 v[214:215], v12 offset:25600
    v_and_b32 v17, 15, v0
    v_mfma_f32_16x16x32_bf16 v[108:111], v[192:195], a[176:179], 0
    buffer_load_dwordx4 v31, s[40:43], s51 offen offset:3168  lds
    v_mfma_f32_16x16x32_bf16 v[76:79], v[196:199], a[180:183], v[76:79]
    ds_read_b64_tr_b16 v[216:217], v12 offset:8960
    s_lshl_b32 s6, s62, 10
    v_mfma_f32_16x16x32_bf16 v[84:87], v[196:199], a[184:187], v[84:87]
    ds_read_b64_tr_b16 v[218:219], v12 offset:9216
    v_and_b32 v21, 7, v0
    v_mfma_f32_16x16x32_bf16 v[92:95], v[196:199], a[188:191], v[92:95]
    ds_read_b64_tr_b16 v[220:221], v12 offset:25856
    v_lshl_add_u32 v14, v21, 7, s6
    v_mfma_f32_16x16x32_bf16 v[100:103], v[196:199], a[192:195], v[100:103]
    ds_read_b64_tr_b16 v[222:223], v12 offset:26112
    v_mul_u32_u24 v1, 73728, v16
    v_mfma_f32_16x16x32_bf16 v[108:111], v[196:199], a[196:199], v[108:111]
    s_waitcnt lgkmcnt(8)
    v_lshl_add_u32 v1, v17, 4, v1
    v_add_u32 v2, 294912, v1
    v_mfma_f32_16x16x32_bf16 v[76:79], v[200:203], a[200:203], v[76:79]
    s_mov_b32 s54, 0x10248040
    s_mov_b32 s53, 0x799611
    v_mfma_f32_16x16x32_bf16 v[84:87], v[200:203], a[204:207], v[84:87]
    s_cmp_ge_u32 s62, 4
    s_cselect_b32 s54, 0x122ca0c2, s54
    s_cselect_b32 s53, 0x7db693, s53
    v_mfma_f32_16x16x32_bf16 v[92:95], v[200:203], a[208:211], v[92:95]
    s_cmp_ge_u32 s62, 8
    s_cselect_b32 s54, 0x1434c144, s54
    s_cselect_b32 s53, 0x81d715, s53
    v_mfma_f32_16x16x32_bf16 v[100:103], v[200:203], a[212:215], v[100:103]
    s_cmp_ge_u32 s62, 12
    s_cselect_b32 s54, 0x163ce1c6, s54
    s_cselect_b32 s53, 0x863897, s53
    v_mfma_f32_16x16x32_bf16 v[108:111], v[200:203], a[216:219], v[108:111]
    v_cmp_lt_u32 vcc, 4, v0
    v_mov_b32 v21, s54
    v_mfma_f32_16x16x32_bf16 v[76:79], v[204:207], a[220:223], v[76:79]
    v_mov_b32 v22, s53
    v_cndmask_b32 v21, v21, v22, vcc
    v_mfma_f32_16x16x32_bf16 v[84:87], v[204:207], a[224:227], v[84:87]
    v_subrev_u32 v22, 5, v0
    v_min_u32 v22, v22, v0
    v_mfma_f32_16x16x32_bf16 v[92:95], v[204:207], a[228:231], v[92:95]
    v_mul_u32_u24 v22, 6, v22
    v_bfe_u32 v21, v21, v22, 6
    v_mfma_f32_16x16x32_bf16 v[100:103], v[204:207], a[232:235], v[100:103]
    v_mul_u32_u24 v22, 26, v21
    v_lshrrev_b32 v22, 8, v22
    v_mfma_f32_16x16x32_bf16 v[108:111], v[204:207], a[236:239], v[108:111]
    v_mul_u32_u24 v8, 10, v22
    s_waitcnt vmcnt(8) lgkmcnt(0)
    s_barrier
    v_mfma_f32_16x16x32_bf16 v[76:79], v[208:211], a[0:3], v[76:79]
    s_lshl_b32 s56, s55, 7
    s_add_u32 s56, s56, s1
    v_add_u32 v12, 33792, v10
    v_mfma_f32_16x16x32_bf16 v[84:87], v[208:211], a[4:7], v[84:87]
    s_add_u32 s55, s55, 1
    s_cmp_eq_u32 s55, 7
    s_cselect_b32 s55, 0, s55
    v_mfma_f32_16x16x32_bf16 v[92:95], v[208:211], a[8:11], v[92:95]
    s_add_u32 m0, s49, 0
    ds_read_b64_tr_b16 v[192:193], v12 offset:0
    v_mfma_f32_16x16x32_bf16 v[100:103], v[208:211], a[12:15], v[100:103]
    buffer_load_dwordx4 v28, s[40:43], s56 offen offset:0  lds
    v_mfma_f32_16x16x32_bf16 v[108:111], v[208:211], a[16:19], v[108:111]
    ds_read_b64_tr_b16 v[194:195], v12 offset:256
    v_sub_u32 v21, v21, v8
    v_mfma_f32_16x16x32_bf16 v[76:79], v[212:215], a[20:23], v[76:79]
    ds_read_b64_tr_b16 v[196:197], v12 offset:16896
    s_and_b32 s6, s62, 2
    v_mfma_f32_16x16x32_bf16 v[84:87], v[212:215], a[24:27], v[84:87]
    ds_read_b64_tr_b16 v[198:199], v12 offset:17152
    s_lshl_b32 s6, s6, 1
    v_mfma_f32_16x16x32_bf16 v[92:95], v[212:215], a[28:31], v[92:95]
    buffer_load_dwordx4 v29, s[40:43], s56 offen offset:1056  lds
    v_mfma_f32_16x16x32_bf16 v[100:103], v[212:215], a[32:35], v[100:103]
    buffer_load_dwordx4 v30, s[40:43], s56 offen offset:2112  lds
    v_mfma_f32_16x16x32_bf16 v[108:111], v[212:215], a[36:39], v[108:111]
    ds_read_b64_tr_b16 v[200:201], v12 offset:512
    v_mfma_f32_16x16x32_bf16 v[76:79], v[216:219], a[40:43], v[76:79]
    buffer_load_dwordx4 v31, s[40:43], s56 offen offset:3168  lds
    v_mfma_f32_16x16x32_bf16 v[84:87], v[216:219], a[44:47], v[84:87]
    ds_read_b64_tr_b16 v[202:203], v12 offset:768
    s_add_u32 s51, s56, 3584
    v_mfma_f32_16x16x32_bf16 v[92:95], v[216:219], a[48:51], v[92:95]
    ds_read_b64_tr_b16 v[204:205], v12 offset:17408
    s_add_u32 m0, s49, 4224
    v_mfma_f32_16x16x32_bf16 v[100:103], v[216:219], a[52:55], v[100:103]
    ds_read_b64_tr_b16 v[206:207], v12 offset:17664
    s_add_u32 s6, s6, s48
    v_mfma_f32_16x16x32_bf16 v[108:111], v[216:219], a[56:59], v[108:111]
    buffer_load_dwordx4 v28, s[40:43], s51 offen offset:0  lds
    v_mfma_f32_16x16x32_bf16 v[76:79], v[220:223], a[60:63], v[76:79]
    buffer_load_dwordx4 v29, s[40:43], s51 offen offset:1056  lds
    v_mfma_f32_16x16x32_bf16 v[84:87], v[220:223], a[64:67], v[84:87]
    ds_read_b64_tr_b16 v[208:209], v12 offset:8448
    v_lshl_add_u32 v23, v21, 3, s6
    v_mfma_f32_16x16x32_bf16 v[92:95], v[220:223], a[68:71], v[92:95]
    ds_read_b64_tr_b16 v[210:211], v12 offset:8704
    s_lshl_b32 s6, s6, 1
    v_mfma_f32_16x16x32_bf16 v[100:103], v[220:223], a[72:75], v[100:103]
    buffer_load_dwordx4 v30, s[40:43], s51 offen offset:2112  lds
    v_mfma_f32_16x16x32_bf16 v[108:111], v[220:223], a[76:79], v[108:111]
    s_waitcnt lgkmcnt(6)
    v_and_b32 v8, 1, v21
    v_and_b32 v21, 14, v21
    v_mfma_f32_16x16x32_bf16 v[116:119], v[192:195], a[160:163], 0
    ds_read_b64_tr_b16 v[212:213], v12 offset:25344
    v_cmp_eq_u32 vcc, 8, v0
    v_mfma_f32_16x16x32_bf16 v[124:127], v[192:195], a[164:167], 0
    ds_read_b64_tr_b16 v[214:215], v12 offset:25600
    v_lshl_add_u32 v21, v21, 3, s6
    v_mfma_f32_16x16x32_bf16 v[132:135], v[192:195], a[168:171], 0
    buffer_load_dwordx4 v31, s[40:43], s51 offen offset:3168  lds
    v_mfma_f32_16x16x32_bf16 v[140:143], v[192:195], a[172:175], 0
    ds_read_b64_tr_b16 v[216:217], v12 offset:8960
    v_add_u32 v21, v21, v8
    v_mfma_f32_16x16x32_bf16 v[148:151], v[192:195], a[176:179], 0
    ds_read_b64_tr_b16 v[218:219], v12 offset:9216
    v_cndmask_b32 v21, v21, v23, vcc
    v_mfma_f32_16x16x32_bf16 v[116:119], v[196:199], a[180:183], v[116:119]
    ds_read_b64_tr_b16 v[220:221], v12 offset:25856
    v_cmp_lt_u32 vcc, 2, v22
    v_mfma_f32_16x16x32_bf16 v[124:127], v[196:199], a[184:187], v[124:127]
    ds_read_b64_tr_b16 v[222:223], v12 offset:26112
    v_lshlrev_b32 v7, 8, v21
    v_mfma_f32_16x16x32_bf16 v[132:135], v[196:199], a[188:191], v[132:135]
    v_mul_u32_u24 v8, 20480, v22
    v_add_u32 v7, v7, v8
    v_mfma_f32_16x16x32_bf16 v[140:143], v[196:199], a[192:195], v[140:143]
    v_lshl_add_u32 v22, v22, 1, s57
    v_subrev_u32 v8, 7, v22
    v_mfma_f32_16x16x32_bf16 v[148:151], v[196:199], a[196:199], v[148:151]
    s_waitcnt lgkmcnt(8)
    v_min_u32 v8, v8, v22
    v_add_u32 v22, 1, v8
    v_mfma_f32_16x16x32_bf16 v[116:119], v[200:203], a[200:203], v[116:119]
    v_subrev_u32 v9, 7, v22
    v_min_u32 v9, v9, v22
    v_mfma_f32_16x16x32_bf16 v[124:127], v[200:203], a[204:207], v[124:127]
    v_cndmask_b32 v9, v9, v8, vcc
    v_and_b32 v22, 15, v21
    v_lshl_add_u32 v22, v22, 3, s63
    v_mfma_f32_16x16x32_bf16 v[132:135], v[200:203], a[208:211], v[132:135]
    v_lshl_add_u32 v8, v8, 7, v22
    v_lshl_add_u32 v9, v9, 7, v22
    v_mfma_f32_16x16x32_bf16 v[140:143], v[200:203], a[212:215], v[140:143]
    v_lshrrev_b32 v21, 4, v21
    v_lshlrev_b32 v22, 1, v21
    v_mfma_f32_16x16x32_bf16 v[148:151], v[200:203], a[216:219], v[148:151]
    v_cndmask_b32 v21, v21, v22, vcc
    v_addc_co_u32 v22, vcc, 0, v21, vcc
    v_mfma_f32_16x16x32_bf16 v[116:119], v[204:207], a[220:223], v[116:119]
    v_mul_u32_u24 v21, 28672, v21
    v_add_u32 v8, v8, v21
    v_mfma_f32_16x16x32_bf16 v[124:127], v[204:207], a[224:227], v[124:127]
    v_cmp_lt_u32 vcc, 4, v22
    v_mul_u32_u24 v22, 28672, v22
    v_mfma_f32_16x16x32_bf16 v[132:135], v[204:207], a[228:231], v[132:135]
    v_add_u32 v9, v9, v22
    v_mov_b32 v21, 0x10000000
    v_mfma_f32_16x16x32_bf16 v[140:143], v[204:207], a[232:235], v[140:143]
    v_cndmask_b32 v9, v9, v21, vcc
    v_sub_u32 v9, v9, v8
    v_cmp_lt_u32 vcc, 31, v0
    v_mfma_f32_16x16x32_bf16 v[148:151], v[204:207], a[236:239], v[148:151]
    v_mul_u32_u24 v6, 1792, v17
    s_waitcnt vmcnt(8) lgkmcnt(0)
    s_barrier
    v_mfma_f32_16x16x32_bf16 v[116:119], v[208:211], a[0:3], v[116:119]
    s_lshl_b32 s56, s55, 7
    v_bfe_i32 v3, v0, 4, 1
    v_cndmask_b32 v6, v6, v21, vcc
    v_and_b32 v16, 1, v17
    v_mfma_f32_16x16x32_bf16 v[124:127], v[208:211], a[4:7], v[124:127]
    s_add_u32 s56, s56, s1
    v_lshlrev_b32 v16, 4, v16
    v_mov_b32 v21, 0x3f80
    v_lshlrev_b32 v21, v16, v21
    v_mfma_f32_16x16x32_bf16 v[132:135], v[208:211], a[8:11], v[132:135]
    s_add_u32 s55, s55, 1
    s_cmp_eq_u32 s55, 7
    s_cselect_b32 s55, 0, s55
    v_lshrrev_b32 v16, 1, v17
    v_mfma_f32_16x16x32_bf16 v[140:143], v[208:211], a[12:15], v[140:143]
    s_add_u32 m0, s49, 33792
    v_cmp_eq_u32 vcc, 0, v16
    s_nop 1
    v_cndmask_b32 v22, 0, v21, vcc
    v_mfma_f32_16x16x32_bf16 v[148:151], v[208:211], a[16:19], v[148:151]
    buffer_load_dwordx4 v28, s[40:43], s56 offen offset:0  lds
    v_accvgpr_write_b32 a244, v22
    v_mfma_f32_16x16x32_bf16 v[116:119], v[212:215], a[20:23], v[116:119]
    buffer_load_dwordx4 v29, s[40:43], s56 offen offset:1056  lds
    v_cmp_eq_u32 vcc, 1, v16
    v_mfma_f32_16x16x32_bf16 v[124:127], v[212:215], a[24:27], v[124:127]
    buffer_load_dwordx4 v30, s[40:43], s56 offen offset:2112  lds
    v_cndmask_b32 v22, 0, v21, vcc
    v_mfma_f32_16x16x32_bf16 v[132:135], v[212:215], a[28:31], v[132:135]
    v_accvgpr_write_b32 a245, v22
    v_cmp_eq_u32 vcc, 2, v16
    s_nop 1
    v_cndmask_b32 v22, 0, v21, vcc
    v_accvgpr_write_b32 a246, v22
    v_cmp_eq_u32 vcc, 3, v16
    v_mfma_f32_16x16x32_bf16 v[140:143], v[212:215], a[32:35], v[140:143]
    s_nop 0
    v_cndmask_b32 v22, 0, v21, vcc
    v_accvgpr_write_b32 a247, v22
    v_add_u32 v12, 67584, v10
    v_mfma_f32_16x16x32_bf16 v[148:151], v[212:215], a[36:39], v[148:151]
    ds_read_b64_tr_b16 v[192:193], v12 offset:0
    ds_read_b64_tr_b16 v[194:195], v12 offset:256
    ds_read_b64_tr_b16 v[196:197], v12 offset:16896
    ds_read_b64_tr_b16 v[198:199], v12 offset:17152
    v_mfma_f32_16x16x32_bf16 v[116:119], v[216:219], a[40:43], v[116:119]
    buffer_load_dwordx4 v31, s[40:43], s56 offen offset:3168  lds
    v_mfma_f32_16x16x32_bf16 v[124:127], v[216:219], a[44:47], v[124:127]
    ds_read_b64_tr_b16 v[200:201], v12 offset:512
    v_mov_b32 v238, 1
    v_mfma_f32_16x16x32_bf16 v[132:135], v[216:219], a[48:51], v[132:135]
    ds_read_b64_tr_b16 v[202:203], v12 offset:768
    v_mfma_f32_16x16x32_bf16 v[140:143], v[216:219], a[52:55], v[140:143]
    buffer_store_dword v238, v19, s[8:11], 0 offen sc1
    v_mfma_f32_16x16x32_bf16 v[148:151], v[216:219], a[56:59], v[148:151]
    ds_read_b64_tr_b16 v[204:205], v12 offset:17408
    s_add_u32 s51, s56, 3584
    v_mfma_f32_16x16x32_bf16 v[116:119], v[220:223], a[60:63], v[116:119]
    ds_read_b64_tr_b16 v[206:207], v12 offset:17664
    s_add_u32 m0, s49, 38016
    v_mfma_f32_16x16x32_bf16 v[124:127], v[220:223], a[64:67], v[124:127]
    buffer_load_dwordx4 v28, s[40:43], s51 offen offset:0  lds
    v_mfma_f32_16x16x32_bf16 v[132:135], v[220:223], a[68:71], v[132:135]
    buffer_load_dwordx4 v29, s[40:43], s51 offen offset:1056  lds
    v_mfma_f32_16x16x32_bf16 v[140:143], v[220:223], a[72:75], v[140:143]
    buffer_load_dwordx4 v30, s[40:43], s51 offen offset:2112  lds
    v_mfma_f32_16x16x32_bf16 v[148:151], v[220:223], a[76:79], v[148:151]
    s_waitcnt lgkmcnt(4)
    ds_read_b64_tr_b16 v[208:209], v12 offset:8448
    v_mfma_f32_16x16x32_bf16 v[156:159], v[192:195], a[160:163], 0
    ds_read_b64_tr_b16 v[210:211], v12 offset:8704
    v_mfma_f32_16x16x32_bf16 v[164:167], v[192:195], a[164:167], 0
    ds_read_b64_tr_b16 v[212:213], v12 offset:25344
    v_mfma_f32_16x16x32_bf16 v[172:175], v[192:195], a[168:171], 0
    ds_read_b64_tr_b16 v[214:215], v12 offset:25600
    v_mfma_f32_16x16x32_bf16 v[180:183], v[192:195], a[172:175], 0
    buffer_load_dwordx4 v31, s[40:43], s51 offen offset:3168  lds
    v_mfma_f32_16x16x32_bf16 v[188:191], v[192:195], a[176:179], 0
    ds_read_b64_tr_b16 v[216:217], v12 offset:8960
    v_mfma_f32_16x16x32_bf16 v[156:159], v[196:199], a[180:183], v[156:159]
    ds_read_b64_tr_b16 v[218:219], v12 offset:9216
    v_mfma_f32_16x16x32_bf16 v[164:167], v[196:199], a[184:187], v[164:167]
    ds_read_b64_tr_b16 v[220:221], v12 offset:25856
    v_mfma_f32_16x16x32_bf16 v[172:175], v[196:199], a[188:191], v[172:175]
    ds_read_b64_tr_b16 v[222:223], v12 offset:26112
    v_mfma_f32_16x16x32_bf16 v[180:183], v[196:199], a[192:195], v[180:183]
    v_mfma_f32_16x16x32_bf16 v[188:191], v[196:199], a[196:199], v[188:191]
    s_waitcnt lgkmcnt(8)
    v_mfma_f32_16x16x32_bf16 v[156:159], v[200:203], a[200:203], v[156:159]
    v_mfma_f32_16x16x32_bf16 v[164:167], v[200:203], a[204:207], v[164:167]
    v_mfma_f32_16x16x32_bf16 v[172:175], v[200:203], a[208:211], v[172:175]
    v_mfma_f32_16x16x32_bf16 v[180:183], v[200:203], a[212:215], v[180:183]
    v_mfma_f32_16x16x32_bf16 v[188:191], v[200:203], a[216:219], v[188:191]
    v_mfma_f32_16x16x32_bf16 v[156:159], v[204:207], a[220:223], v[156:159]
    v_mfma_f32_16x16x32_bf16 v[164:167], v[204:207], a[224:227], v[164:167]
    v_mfma_f32_16x16x32_bf16 v[172:175], v[204:207], a[228:231], v[172:175]
    v_mfma_f32_16x16x32_bf16 v[180:183], v[204:207], a[232:235], v[180:183]
    v_mfma_f32_16x16x32_bf16 v[188:191], v[204:207], a[236:239], v[188:191]
    s_waitcnt vmcnt(9) lgkmcnt(0)
    s_barrier
    v_mfma_f32_16x16x32_bf16 v[156:159], v[208:211], a[0:3], v[156:159]
    s_lshl_b32 s56, s55, 7
    s_add_u32 s56, s56, s1
    v_add_u32 v12, 0, v10
    v_mfma_f32_16x16x32_bf16 v[164:167], v[208:211], a[4:7], v[164:167]
    s_add_u32 s55, s55, 1
    s_cmp_eq_u32 s55, 7
    s_cselect_b32 s55, 0, s55
    v_mfma_f32_16x16x32_bf16 v[172:175], v[208:211], a[8:11], v[172:175]
    s_add_u32 m0, s49, 67584
    ds_read_b64_tr_b16 v[192:193], v12 offset:0
    v_mfma_f32_16x16x32_bf16 v[180:183], v[208:211], a[12:15], v[180:183]
    buffer_load_dwordx4 v28, s[40:43], s56 offen offset:0  lds
    v_mfma_f32_16x16x32_bf16 v[188:191], v[208:211], a[16:19], v[188:191]
    ds_read_b64_tr_b16 v[194:195], v12 offset:256
    v_mfma_f32_16x16x32_bf16 v[156:159], v[212:215], a[20:23], v[156:159]
    ds_read_b64_tr_b16 v[196:197], v12 offset:16896
    v_mfma_f32_16x16x32_bf16 v[164:167], v[212:215], a[24:27], v[164:167]
    ds_read_b64_tr_b16 v[198:199], v12 offset:17152
    v_mfma_f32_16x16x32_bf16 v[172:175], v[212:215], a[28:31], v[172:175]
    buffer_load_dwordx4 v29, s[40:43], s56 offen offset:1056  lds
    v_mfma_f32_16x16x32_bf16 v[180:183], v[212:215], a[32:35], v[180:183]
    buffer_load_dwordx4 v30, s[40:43], s56 offen offset:2112  lds
    v_mfma_f32_16x16x32_bf16 v[188:191], v[212:215], a[36:39], v[188:191]
    ds_read_b64_tr_b16 v[200:201], v12 offset:512
    v_mfma_f32_16x16x32_bf16 v[156:159], v[216:219], a[40:43], v[156:159]
    buffer_load_dwordx4 v31, s[40:43], s56 offen offset:3168  lds
    v_mfma_f32_16x16x32_bf16 v[164:167], v[216:219], a[44:47], v[164:167]
    ds_read_b64_tr_b16 v[202:203], v12 offset:768
    s_add_u32 s51, s56, 3584
    v_mfma_f32_16x16x32_bf16 v[172:175], v[216:219], a[48:51], v[172:175]
    ds_read_b64_tr_b16 v[204:205], v12 offset:17408
    s_add_u32 m0, s49, 71808
    v_mfma_f32_16x16x32_bf16 v[180:183], v[216:219], a[52:55], v[180:183]
    ds_read_b64_tr_b16 v[206:207], v12 offset:17664
    v_mfma_f32_16x16x32_bf16 v[188:191], v[216:219], a[56:59], v[188:191]
    buffer_load_dwordx4 v28, s[40:43], s51 offen offset:0  lds
    v_mfma_f32_16x16x32_bf16 v[156:159], v[220:223], a[60:63], v[156:159]
    buffer_load_dwordx4 v29, s[40:43], s51 offen offset:1056  lds
    v_mfma_f32_16x16x32_bf16 v[164:167], v[220:223], a[64:67], v[164:167]
    ds_read_b64_tr_b16 v[208:209], v12 offset:8448
    v_mfma_f32_16x16x32_bf16 v[172:175], v[220:223], a[68:71], v[172:175]
    ds_read_b64_tr_b16 v[210:211], v12 offset:8704
    v_mfma_f32_16x16x32_bf16 v[180:183], v[220:223], a[72:75], v[180:183]
    buffer_load_dwordx4 v30, s[40:43], s51 offen offset:2112  lds
    v_mfma_f32_16x16x32_bf16 v[188:191], v[220:223], a[76:79], v[188:191]
    s_waitcnt lgkmcnt(6)
    ds_read_b64_tr_b16 v[212:213], v12 offset:25344
    v_mfma_f32_16x16x32_bf16 v[32:35], v[192:195], a[160:163], 0
    ds_read_b64_tr_b16 v[214:215], v12 offset:25600
    v_mfma_f32_16x16x32_bf16 v[40:43], v[192:195], a[164:167], 0
    buffer_load_dwordx4 v31, s[40:43], s51 offen offset:3168  lds
    v_mfma_f32_16x16x32_bf16 v[48:51], v[192:195], a[168:171], 0
    ds_read_b64_tr_b16 v[216:217], v12 offset:8960
    v_mfma_f32_16x16x32_bf16 v[56:59], v[192:195], a[172:175], 0
    ds_read_b64_tr_b16 v[218:219], v12 offset:9216
    v_mfma_f32_16x16x32_bf16 v[64:67], v[192:195], a[176:179], 0
    ds_read_b64_tr_b16 v[220:221], v12 offset:25856
    v_mfma_f32_16x16x32_bf16 v[32:35], v[196:199], a[180:183], v[32:35]
    buffer_load_dword v251, v20, s[8:11], 0 offen sc1
    v_mfma_f32_16x16x32_bf16 v[40:43], v[196:199], a[184:187], v[40:43]
    ds_read_b64_tr_b16 v[222:223], v12 offset:26112
    v_mfma_f32_16x16x32_bf16 v[48:51], v[196:199], a[188:191], v[48:51]
    v_mfma_f32_16x16x32_bf16 v[56:59], v[196:199], a[192:195], v[56:59]
    v_mfma_f32_16x16x32_bf16 v[64:67], v[196:199], a[196:199], v[64:67]
    s_waitcnt lgkmcnt(8)
    v_mfma_f32_16x16x32_bf16 v[32:35], v[200:203], a[200:203], v[32:35]
    v_mfma_f32_16x16x32_bf16 v[40:43], v[200:203], a[204:207], v[40:43]
    v_mfma_f32_16x16x32_bf16 v[48:51], v[200:203], a[208:211], v[48:51]
    v_mfma_f32_16x16x32_bf16 v[56:59], v[200:203], a[212:215], v[56:59]
    v_mfma_f32_16x16x32_bf16 v[64:67], v[200:203], a[216:219], v[64:67]
    v_mfma_f32_16x16x32_bf16 v[32:35], v[204:207], a[220:223], v[32:35]
    v_mfma_f32_16x16x32_bf16 v[40:43], v[204:207], a[224:227], v[40:43]
    v_mfma_f32_16x16x32_bf16 v[48:51], v[204:207], a[228:231], v[48:51]
    v_mfma_f32_16x16x32_bf16 v[56:59], v[204:207], a[232:235], v[56:59]
    v_mfma_f32_16x16x32_bf16 v[64:67], v[204:207], a[236:239], v[64:67]
    s_waitcnt vmcnt(9) lgkmcnt(0)
    s_barrier
L_merge:
    v_mfma_f32_16x16x32_bf16 v[32:35], v[208:211], a[0:3], v[32:35]
    s_sub_u32 s1, 229376, s1
    s_lshl_b32 s56, s55, 7
    s_add_u32 s56, s56, s1
    v_mfma_f32_16x16x32_bf16 v[40:43], v[208:211], a[4:7], v[40:43]
    s_add_u32 s55, s55, 1
    s_cmp_eq_u32 s55, 7
    s_cselect_b32 s55, 0, s55
    v_mfma_f32_16x16x32_bf16 v[48:51], v[208:211], a[8:11], v[48:51]
    s_add_u32 m0, s49, 0
    v_add_u32 v12, 33792, v10
    v_mfma_f32_16x16x32_bf16 v[56:59], v[208:211], a[12:15], v[56:59]
    buffer_load_dwordx4 v28, s[40:43], s56 offen offset:0  lds
    v_mfma_f32_16x16x32_bf16 v[64:67], v[208:211], a[16:19], v[64:67]
    ds_read_b64_tr_b16 v[192:193], v12 offset:0
    v_mfma_f32_16x16x32_bf16 v[32:35], v[212:215], a[20:23], v[32:35]
    ds_read_b64_tr_b16 v[194:195], v12 offset:256
    v_mfma_f32_16x16x32_bf16 v[40:43], v[212:215], a[24:27], v[40:43]
    ds_read_b64_tr_b16 v[196:197], v12 offset:16896
    v_mfma_f32_16x16x32_bf16 v[48:51], v[212:215], a[28:31], v[48:51]
    ds_read_b64_tr_b16 v[198:199], v12 offset:17152
    v_mfma_f32_16x16x32_bf16 v[56:59], v[212:215], a[32:35], v[56:59]
    buffer_load_dwordx4 v29, s[40:43], s56 offen offset:1056  lds
    v_mfma_f32_16x16x32_bf16 v[64:67], v[212:215], a[36:39], v[64:67]
    ds_read_b64_tr_b16 v[200:201], v12 offset:512
    v_mfma_f32_16x16x32_bf16 v[32:35], v[216:219], a[40:43], v[32:35]
    buffer_load_dwordx4 v30, s[40:43], s56 offen offset:2112  lds
    v_mfma_f32_16x16x32_bf16 v[40:43], v[216:219], a[44:47], v[40:43]
    buffer_load_dwordx4 v31, s[40:43], s56 offen offset:3168  lds
    v_mfma_f32_16x16x32_bf16 v[48:51], v[216:219], a[48:51], v[48:51]
    ds_read_b64_tr_b16 v[202:203], v12 offset:768
    s_add_u32 s51, s56, 3584
    v_mfma_f32_16x16x32_bf16 v[56:59], v[216:219], a[52:55], v[56:59]
    ds_read_b64_tr_b16 v[204:205], v12 offset:17408
    s_add_u32 m0, s49, 4224
    v_mfma_f32_16x16x32_bf16 v[64:67], v[216:219], a[56:59], v[64:67]
    ds_read_b64_tr_b16 v[206:207], v12 offset:17664
    v_mfma_f32_16x16x32_bf16 v[32:35], v[220:223], a[60:63], v[32:35]
    buffer_load_dwordx4 v28, s[40:43], s51 offen offset:0  lds
    v_mfma_f32_16x16x32_bf16 v[40:43], v[220:223], a[64:67], v[40:43]
    buffer_load_dwordx4 v29, s[40:43], s51 offen offset:1056  lds
    v_mfma_f32_16x16x32_bf16 v[48:51], v[220:223], a[68:71], v[48:51]
    ds_read_b64_tr_b16 v[208:209], v12 offset:8448
    v_mfma_f32_16x16x32_bf16 v[56:59], v[220:223], a[72:75], v[56:59]
    buffer_load_dwordx4 v30, s[40:43], s51 offen offset:2112  lds
    v_mfma_f32_16x16x32_bf16 v[64:67], v[220:223], a[76:79], v[64:67]
    s_waitcnt lgkmcnt(5)
    ds_read_b64_tr_b16 v[210:211], v12 offset:8704
    v_mfma_f32_16x16x32_bf16 v[72:75], v[192:195], a[160:163], 0
    ds_read_b64_tr_b16 v[212:213], v12 offset:25344
    v_mfma_f32_16x16x32_bf16 v[80:83], v[192:195], a[164:167], 0
    ds_read_b64_tr_b16 v[214:215], v12 offset:25600
    v_mfma_f32_16x16x32_bf16 v[88:91], v[192:195], a[168:171], 0
    buffer_load_dwordx4 v31, s[40:43], s51 offen offset:3168  lds
    v_mfma_f32_16x16x32_bf16 v[96:99], v[192:195], a[172:175], 0
    ds_read_b64_tr_b16 v[216:217], v12 offset:8960
    v_mfma_f32_16x16x32_bf16 v[104:107], v[192:195], a[176:179], 0
    ds_read_b64_tr_b16 v[218:219], v12 offset:9216
    v_mfma_f32_16x16x32_bf16 v[72:75], v[196:199], a[180:183], v[72:75]
    ds_read_b64_tr_b16 v[220:221], v12 offset:25856
    v_mfma_f32_16x16x32_bf16 v[80:83], v[196:199], a[184:187], v[80:83]
    ds_read_b64_tr_b16 v[222:223], v12 offset:26112
    s_and_b32 s51, s48, 2
    v_mfma_f32_16x16x32_bf16 v[88:91], v[196:199], a[188:191], v[88:91]
    s_add_u32 s51, s51, s48
    s_mul_i32 s51, s51, 10240
    s_add_u32 m0, s51, 101376
    v_mfma_f32_16x16x32_bf16 v[96:99], v[196:199], a[192:195], v[96:99]
    s_lshl_b32 s51, s61, 1
    s_add_u32 s51, s51, s0
    v_mfma_f32_16x16x32_bf16 v[104:107], v[196:199], a[196:199], v[104:107]
    s_waitcnt lgkmcnt(8)
    v_mfma_f32_16x16x32_bf16 v[72:75], v[200:203], a[200:203], v[72:75]
    s_waitcnt vmcnt(8)
L_op:
    v_cmp_eq_u32 vcc, 0, v251
    s_nop 1
    s_cbranch_vccz L_op_ok
    s_cmp_eq_u32 s7, 0
    s_cbranch_scc1 L_op_ok
    s_sub_u32 s7, s7, 1
    buffer_load_dword v251, v20, s[8:11], 0 offen sc1
    s_waitcnt vmcnt(0)
    s_branch L_op
L_op_ok:
    s_cmp_gt_u32 s7, 199995
    s_cbranch_scc1 L_op_go
    buffer_store_dword v238, v19, s[8:11], 0 offen sc1
L_op_go:
    v_mfma_f32_16x16x32_bf16 v[80:83], v[200:203], a[204:207], v[80:83]
    buffer_load_dwordx4 v18, s[96:99], s51 offen offset:0 sc1 lds
    v_mfma_f32_16x16x32_bf16 v[88:91], v[200:203], a[208:211], v[88:91]
    buffer_load_dwordx4 v18, s[96:99], s51 offen offset:1024 sc1 lds
    v_mfma_f32_16x16x32_bf16 v[96:99], v[200:203], a[212:215], v[96:99]
    buffer_load_dwordx4 v18, s[96:99], s51 offen offset:2048 sc1 lds
    v_mfma_f32_16x16x32_bf16 v[104:107], v[200:203], a[216:219], v[104:107]
    buffer_load_dwordx4 v18, s[96:99], s51 offen offset:3072 sc1 lds
    v_mfma_f32_16x16x32_bf16 v[72:75], v[204:207], a[220:223], v[72:75]
    s_add_u32 m0, m0, 4096
    s_add_u32 s51, s51, 4096
    v_mfma_f32_16x16x32_bf16 v[80:83], v[204:207], a[224:227], v[80:83]
    buffer_load_dwordx4 v18, s[96:99], s51 offen offset:0 sc1 lds
    v_mfma_f32_16x16x32_bf16 v[88:91], v[204:207], a[228:231], v[88:91]
    buffer_load_dwordx4 v18, s[96:99], s51 offen offset:1024 sc1 lds
    v_mfma_f32_16x16x32_bf16 v[96:99], v[204:207], a[232:235], v[96:99]
    buffer_load_dwordx4 v18, s[96:99], s51 offen offset:2048 sc1 lds
    v_mfma_f32_16x16x32_bf16 v[104:107], v[204:207], a[236:239], v[104:107]
    buffer_load_dwordx4 v18, s[96:99], s51 offen offset:3072 sc1 lds
    s_waitcnt lgkmcnt(0)
    s_barrier
    v_mfma_f32_16x16x32_bf16 v[72:75], v[208:211], a[0:3], v[72:75]
    s_add_u32 m0, m0, 4096
    s_add_u32 s51, s51, 4096
    v_add_u32 v12, 67584, v10
    v_mfma_f32_16x16x32_bf16 v[80:83], v[208:211], a[4:7], v[80:83]
    buffer_load_dwordx4 v18, s[96:99], s51 offen offset:0 sc1 lds
    v_mfma_f32_16x16x32_bf16 v[88:91], v[208:211], a[8:11], v[88:91]
    buffer_load_dwordx4 v18, s[96:99], s51 offen offset:1024 sc1 lds
    v_mfma_f32_16x16x32_bf16 v[96:99], v[208:211], a[12:15], v[96:99]
    s_add_u32 s51, s0, 40960
    buffer_load_dwordx4 v[224:227], v18, s[96:99], s51 offen offset:0 sc1
    v_mfma_f32_16x16x32_bf16 v[104:107], v[208:211], a[16:19], v[104:107]
    buffer_load_dword v232, v236, s[96:99], s51 offen offset:1024 sc1
    v_mfma_f32_16x16x32_bf16 v[72:75], v[212:215], a[20:23], v[72:75]
    buffer_load_dwordx4 v[228:231], v18, s[96:99], s51 offen offset:1280 sc1
    v_mfma_f32_16x16x32_bf16 v[80:83], v[212:215], a[24:27], v[80:83]
    buffer_load_dword v233, v236, s[96:99], s51 offen offset:2304 sc1
    v_mfma_f32_16x16x32_bf16 v[88:91], v[212:215], a[28:31], v[88:91]
    ds_read_b64_tr_b16 v[192:193], v12 offset:0
    s_lshl_b32 s56, s55, 7
    v_mfma_f32_16x16x32_bf16 v[96:99], v[212:215], a[32:35], v[96:99]
    ds_read_b64_tr_b16 v[194:195], v12 offset:256
    s_add_u32 s56, s56, s1
    v_mfma_f32_16x16x32_bf16 v[104:107], v[212:215], a[36:39], v[104:107]
    ds_read_b64_tr_b16 v[196:197], v12 offset:16896
    ds_read_b64_tr_b16 v[198:199], v12 offset:17152
    v_mfma_f32_16x16x32_bf16 v[72:75], v[216:219], a[40:43], v[72:75]
    s_add_u32 s55, s55, 1
    s_cmp_eq_u32 s55, 7
    s_cselect_b32 s55, 0, s55
    v_mfma_f32_16x16x32_bf16 v[80:83], v[216:219], a[44:47], v[80:83]
    s_add_u32 m0, s49, 33792
    ds_read_b64_tr_b16 v[200:201], v12 offset:512
    v_mfma_f32_16x16x32_bf16 v[88:91], v[216:219], a[48:51], v[88:91]
    buffer_load_dwordx4 v28, s[40:43], s56 offen offset:0  lds
    v_mfma_f32_16x16x32_bf16 v[96:99], v[216:219], a[52:55], v[96:99]
    buffer_load_dwordx4 v29, s[40:43], s56 offen offset:1056  lds
    v_mfma_f32_16x16x32_bf16 v[104:107], v[216:219], a[56:59], v[104:107]
    ds_read_b64_tr_b16 v[202:203], v12 offset:768
    v_mfma_f32_16x16x32_bf16 v[72:75], v[220:223], a[60:63], v[72:75]
    ds_read_b64_tr_b16 v[204:205], v12 offset:17408
    v_mfma_f32_16x16x32_bf16 v[80:83], v[220:223], a[64:67], v[80:83]
    ds_read_b64_tr_b16 v[206:207], v12 offset:17664
    v_mfma_f32_16x16x32_bf16 v[88:91], v[220:223], a[68:71], v[88:91]
    buffer_load_dwordx4 v30, s[40:43], s56 offen offset:2112  lds
    v_mfma_f32_16x16x32_bf16 v[96:99], v[220:223], a[72:75], v[96:99]
    buffer_load_dwordx4 v31, s[40:43], s56 offen offset:3168  lds
    v_mfma_f32_16x16x32_bf16 v[104:107], v[220:223], a[76:79], v[104:107]
    s_waitcnt lgkmcnt(4)
    s_add_u32 s51, s56, 3584
    s_add_u32 m0, s49, 38016
    v_mfma_f32_16x16x32_bf16 v[112:115], v[192:195], a[160:163], 0
    buffer_load_dwordx4 v28, s[40:43], s51 offen offset:0  lds
    v_mfma_f32_16x16x32_bf16 v[120:123], v[192:195], a[164:167], 0
    buffer_load_dwordx4 v29, s[40:43], s51 offen offset:1056  lds
    v_mfma_f32_16x16x32_bf16 v[128:131], v[192:195], a[168:171], 0
    ds_read_b64_tr_b16 v[208:209], v12 offset:8448
    v_mfma_f32_16x16x32_bf16 v[136:139], v[192:195], a[172:175], 0
    ds_read_b64_tr_b16 v[210:211], v12 offset:8704
    v_mfma_f32_16x16x32_bf16 v[144:147], v[192:195], a[176:179], 0
    ds_read_b64_tr_b16 v[212:213], v12 offset:25344
    v_mfma_f32_16x16x32_bf16 v[112:115], v[196:199], a[180:183], v[112:115]
    ds_read_b64_tr_b16 v[214:215], v12 offset:25600
    v_mfma_f32_16x16x32_bf16 v[120:123], v[196:199], a[184:187], v[120:123]
    buffer_load_dwordx4 v30, s[40:43], s51 offen offset:2112  lds
    v_mfma_f32_16x16x32_bf16 v[128:131], v[196:199], a[188:191], v[128:131]
    ds_read_b64_tr_b16 v[216:217], v12 offset:8960
    v_mfma_f32_16x16x32_bf16 v[136:139], v[196:199], a[192:195], v[136:139]
    ds_read_b64_tr_b16 v[218:219], v12 offset:9216
    v_mfma_f32_16x16x32_bf16 v[144:147], v[196:199], a[196:199], v[144:147]
    s_waitcnt lgkmcnt(6)
    ds_read_b64_tr_b16 v[220:221], v12 offset:25856
    v_mfma_f32_16x16x32_bf16 v[112:115], v[200:203], a[200:203], v[112:115]
    ds_read_b64_tr_b16 v[222:223], v12 offset:26112
    v_mfma_f32_16x16x32_bf16 v[120:123], v[200:203], a[204:207], v[120:123]
    buffer_load_dwordx4 v31, s[40:43], s51 offen offset:3168  lds
    v_mfma_f32_16x16x32_bf16 v[128:131], v[200:203], a[208:211], v[128:131]
    v_mfma_f32_16x16x32_bf16 v[136:139], v[200:203], a[212:215], v[136:139]
    v_mfma_f32_16x16x32_bf16 v[144:147], v[200:203], a[216:219], v[144:147]
    v_mfma_f32_16x16x32_bf16 v[112:115], v[204:207], a[220:223], v[112:115]
    v_mfma_f32_16x16x32_bf16 v[120:123], v[204:207], a[224:227], v[120:123]
    v_mfma_f32_16x16x32_bf16 v[128:131], v[204:207], a[228:231], v[128:131]
    v_mfma_f32_16x16x32_bf16 v[136:139], v[204:207], a[232:235], v[136:139]
    v_mfma_f32_16x16x32_bf16 v[144:147], v[204:207], a[236:239], v[144:147]
    s_waitcnt vmcnt(12) lgkmcnt(0)
    s_barrier
    v_mfma_f32_16x16x32_bf16 v[112:115], v[208:211], a[0:3], v[112:115]
    s_waitcnt vmcnt(8)
    v_add_f32 v232, v232, v233
    v_add_f32 v224, v224, v228
    v_mfma_f32_16x16x32_bf16 v[120:123], v[208:211], a[4:7], v[120:123]
    s_lshl_b32 s56, s55, 7
    v_add_f32 v225, v225, v229
    v_add_f32 v226, v226, v230
    v_mfma_f32_16x16x32_bf16 v[128:131], v[208:211], a[8:11], v[128:131]
    s_add_u32 s56, s56, s1
    v_add_f32 v227, v227, v231
    v_mul_f32 v240, v240, v232
    v_mfma_f32_16x16x32_bf16 v[136:139], v[208:211], a[12:15], v[136:139]
    s_add_u32 s55, s55, 1
    s_cmp_eq_u32 s55, 7
    s_cselect_b32 s55, 0, s55
    v_mfma_f32_16x16x32_bf16 v[144:147], v[208:211], a[16:19], v[144:147]
    s_add_u32 m0, s49, 67584
    v_mul_f32 v241, v241, v224
    v_mul_f32 v242, v242, v225
    v_mfma_f32_16x16x32_bf16 v[112:115], v[212:215], a[20:23], v[112:115]
    buffer_load_dwordx4 v28, s[40:43], s56 offen offset:0  lds
    v_mul_f32 v243, v243, v226
    v_mfma_f32_16x16x32_bf16 v[120:123], v[212:215], a[24:27], v[120:123]
    buffer_load_dwordx4 v29, s[40:43], s56 offen offset:1056  lds
    v_mul_f32 v244, v244, v227
    v_mfma_f32_16x16x32_bf16 v[128:131], v[212:215], a[28:31], v[128:131]
    buffer_load_dwordx4 v30, s[40:43], s56 offen offset:2112  lds
    v_add_u32 v12, 0, v10
    v_mfma_f32_16x16x32_bf16 v[136:139], v[212:215], a[32:35], v[136:139]
    ds_read_b64_tr_b16 v[192:193], v12 offset:0
    v_mul_f32 v36, v36, v240
    v_mul_f32 v37, v37, v240
    v_mfma_f32_16x16x32_bf16 v[144:147], v[212:215], a[36:39], v[144:147]
    ds_read_b64_tr_b16 v[194:195], v12 offset:256
    ds_read_b64_tr_b16 v[196:197], v12 offset:16896
    ds_read_b64_tr_b16 v[198:199], v12 offset:17152
    v_mfma_f32_16x16x32_bf16 v[112:115], v[216:219], a[40:43], v[112:115]
    ds_read_b128 a[80:83], v5 offset:0
    v_mul_f32 v38, v38, v240
    v_mul_f32 v39, v39, v240
    v_mul_f32 v44, v44, v241
    v_mfma_f32_16x16x32_bf16 v[120:123], v[216:219], a[44:47], v[120:123]
    ds_read_b128 a[84:87], v5 offset:1024
    v_mul_f32 v45, v45, v241
    v_mul_f32 v46, v46, v241
    v_mfma_f32_16x16x32_bf16 v[128:131], v[216:219], a[48:51], v[128:131]
    ds_read_b128 a[88:91], v5 offset:2048
    v_mul_f32 v47, v47, v241
    v_mul_f32 v52, v52, v242
    v_mfma_f32_16x16x32_bf16 v[136:139], v[216:219], a[52:55], v[136:139]
    ds_read_b128 a[92:95], v5 offset:3072
    v_mul_f32 v53, v53, v242
    v_mul_f32 v54, v54, v242
    v_mul_f32 v55, v55, v242
    v_mfma_f32_16x16x32_bf16 v[144:147], v[216:219], a[56:59], v[144:147]
    ds_read_b128 a[96:99], v5 offset:4096
    v_mul_f32 v60, v60, v243
    v_mul_f32 v61, v61, v243
    v_mul_f32 v62, v62, v243
    v_mfma_f32_16x16x32_bf16 v[112:115], v[220:223], a[60:63], v[112:115]
    ds_read_b128 a[100:103], v5 offset:5120
    v_mul_f32 v63, v63, v243
    v_mul_f32 v68, v68, v244
    v_mul_f32 v69, v69, v244
    v_mfma_f32_16x16x32_bf16 v[120:123], v[220:223], a[64:67], v[120:123]
    ds_read_b128 a[104:107], v5 offset:6144
    ds_read_b128 a[108:111], v5 offset:7168
    ds_read_b128 a[112:115], v5 offset:8192
    ds_read_b128 a[116:119], v5 offset:9216
    v_mfma_f32_16x16x32_bf16 v[128:131], v[220:223], a[68:71], v[128:131]
    buffer_load_dwordx4 v31, s[40:43], s56 offen offset:3168  lds
    v_mul_f32 v70, v70, v244
    v_mfma_f32_16x16x32_bf16 v[136:139], v[220:223], a[72:75], v[136:139]
    ds_read_b64_tr_b16 v[200:201], v12 offset:512
    v_mul_f32 v71, v71, v244
    v_mul_f32 v76, v76, v240
    v_mfma_f32_16x16x32_bf16 v[144:147], v[220:223], a[76:79], v[144:147]
    s_waitcnt lgkmcnt(1)
    ds_read_b64_tr_b16 v[202:203], v12 offset:768
    ds_read_b64_tr_b16 v[204:205], v12 offset:17408
    ds_read_b64_tr_b16 v[206:207], v12 offset:17664
    v_mfma_f32_16x16x32_bf16 v[36:39], v[192:195], a[80:83], v[36:39]
    s_add_u32 s51, s56, 3584
    s_add_u32 m0, s49, 71808
    s_nop 0
    buffer_load_dwordx4 v28, s[40:43], s51 offen offset:0  lds
    v_mfma_f32_16x16x32_bf16 v[44:47], v[192:195], a[84:87], v[44:47]
    buffer_load_dwordx4 v29, s[40:43], s51 offen offset:1056  lds
    v_rcp_f32 v245, v232
    v_mfma_f32_16x16x32_bf16 v[52:55], v[192:195], a[88:91], v[52:55]
    buffer_load_dwordx4 v30, s[40:43], s51 offen offset:2112  lds
    v_mul_f32 v77, v77, v240
    v_mfma_f32_16x16x32_bf16 v[60:63], v[192:195], a[92:95], v[60:63]
    ds_read_b128 a[120:123], v5 offset:10240
    v_rcp_f32 v246, v224
    v_mul_f32 v78, v78, v240
    v_mfma_f32_16x16x32_bf16 v[68:71], v[192:195], a[96:99], v[68:71]
    ds_read_b128 a[124:127], v5 offset:11264
    v_rcp_f32 v247, v225
    v_rcp_f32 v248, v226
    v_mfma_f32_16x16x32_bf16 v[36:39], v[196:199], a[100:103], v[36:39]
    ds_read_b128 a[128:131], v5 offset:12288
    v_rcp_f32 v249, v227
    v_mul_f32 v79, v79, v240
    v_mul_f32 v84, v84, v241
    v_mul_f32 v85, v85, v241
    v_mul_f32 v86, v86, v241
    v_mfma_f32_16x16x32_bf16 v[44:47], v[196:199], a[104:107], v[44:47]
    ds_read_b128 a[132:135], v5 offset:13312
    ds_read_b128 a[136:139], v5 offset:14336
    ds_read_b128 a[140:143], v5 offset:15360
    ds_read_b128 a[144:147], v5 offset:16384
    ds_read_b128 a[148:151], v5 offset:17408
    ds_read_b128 a[152:155], v5 offset:18432
    ds_read_b128 a[156:159], v5 offset:19456
    v_mfma_f32_16x16x32_bf16 v[52:55], v[196:199], a[108:111], v[52:55]
    ds_read_b64_tr_b16 v[208:209], v12 offset:8448
    v_mul_f32 v87, v87, v241
    v_mul_f32 v92, v92, v242
    v_mfma_f32_16x16x32_bf16 v[60:63], v[196:199], a[112:115], v[60:63]
    ds_read_b64_tr_b16 v[210:211], v12 offset:8704
    v_mul_f32 v93, v93, v242
    v_mul_f32 v94, v94, v242
    v_mul_f32 v95, v95, v242
    v_mfma_f32_16x16x32_bf16 v[68:71], v[196:199], a[116:119], v[68:71]
    s_waitcnt lgkmcnt(2)
    ds_read_b64_tr_b16 v[212:213], v12 offset:25344
    ds_read_b64_tr_b16 v[214:215], v12 offset:25600
    buffer_load_dwordx4 v31, s[40:43], s51 offen offset:3168  lds
    v_mfma_f32_16x16x32_bf16 v[36:39], v[200:203], a[120:123], v[36:39]
    ds_read_b64_tr_b16 v[216:217], v12 offset:8960
    v_mul_f32 v100, v100, v243
    v_mul_f32 v101, v101, v243
    v_mfma_f32_16x16x32_bf16 v[44:47], v[200:203], a[124:127], v[44:47]
    ds_read_b64_tr_b16 v[218:219], v12 offset:9216
    v_mul_f32 v102, v102, v243
    v_mul_f32 v103, v103, v243
    v_mfma_f32_16x16x32_bf16 v[52:55], v[200:203], a[128:131], v[52:55]
    ds_read_b64_tr_b16 v[220:221], v12 offset:25856
    ds_read_b64_tr_b16 v[222:223], v12 offset:26112
    v_mul_f32 v108, v108, v244
    v_mfma_f32_16x16x32_bf16 v[60:63], v[200:203], a[132:135], v[60:63]
    ds_read_b128 a[160:163], v5 offset:40960
    v_mul_f32 v109, v109, v244
    v_mul_f32 v110, v110, v244
    v_mul_f32 v111, v111, v244
    v_mfma_f32_16x16x32_bf16 v[68:71], v[200:203], a[136:139], v[68:71]
    ds_read_b128 a[164:167], v5 offset:41984
    v_mul_f32 v116, v116, v240
    v_mul_f32 v117, v117, v240
    v_mul_f32 v118, v118, v240
    v_mul_f32 v119, v119, v240
    v_mfma_f32_16x16x32_bf16 v[36:39], v[204:207], a[140:143], v[36:39]
    ds_read_b128 a[168:171], v5 offset:43008
    v_mul_f32 v124, v124, v241
    v_mul_f32 v125, v125, v241
    v_mul_f32 v126, v126, v241
    v_mul_f32 v127, v127, v241
    v_mul_f32 v132, v132, v242
    v_mul_f32 v133, v133, v242
    v_mfma_f32_16x16x32_bf16 v[44:47], v[204:207], a[144:147], v[44:47]
    ds_read_b128 a[172:175], v5 offset:44032
    ds_read_b128 a[176:179], v5 offset:45056
    ds_read_b128 a[180:183], v5 offset:46080
    ds_read_b128 a[184:187], v5 offset:47104
    ds_read_b128 a[188:191], v5 offset:48128
    ds_read_b128 a[192:195], v5 offset:49152
    ds_read_b128 a[196:199], v5 offset:50176
    v_mfma_f32_16x16x32_bf16 v[52:55], v[204:207], a[148:151], v[52:55]
    ds_read_b128 a[200:203], v5 offset:51200
    s_lshl_b32 s59, s48, 10
    v_mfma_f32_16x16x32_bf16 v[60:63], v[204:207], a[152:155], v[60:63]
    ds_read_b128 a[204:207], v5 offset:52224
    v_mul_f32 v134, v134, v242
    v_mfma_f32_16x16x32_bf16 v[68:71], v[204:207], a[156:159], v[68:71]
    ds_read_b128 a[208:211], v5 offset:53248
    s_waitcnt vmcnt(8) lgkmcnt(0)
    s_barrier
    v_mfma_f32_16x16x32_bf16 v[36:39], v[208:211], a[160:163], v[36:39]
    ds_read_b128 a[212:215], v5 offset:54272
    v_add_u32 v12, 33792, v10
    v_mfma_f32_16x16x32_bf16 v[44:47], v[208:211], a[164:167], v[44:47]
    ds_read_b128 a[216:219], v5 offset:55296
    v_mul_f32 v135, v135, v242
    v_mfma_f32_16x16x32_bf16 v[52:55], v[208:211], a[168:171], v[52:55]
    ds_read_b128 a[220:223], v5 offset:56320
    v_mul_f32 v140, v140, v243
    v_mfma_f32_16x16x32_bf16 v[60:63], v[208:211], a[172:175], v[60:63]
    ds_read_b128 a[224:227], v5 offset:57344
    v_mul_f32 v141, v141, v243
    v_mul_f32 v142, v142, v243
    v_mfma_f32_16x16x32_bf16 v[68:71], v[208:211], a[176:179], v[68:71]
    ds_read_b128 a[228:231], v5 offset:58368
    v_mul_f32 v143, v143, v243
    v_mul_f32 v148, v148, v244
    v_mfma_f32_16x16x32_bf16 v[36:39], v[212:215], a[180:183], v[36:39]
    ds_read_b128 a[232:235], v5 offset:59392
    v_mul_f32 v149, v149, v244
    v_mul_f32 v150, v150, v244
    v_mfma_f32_16x16x32_bf16 v[44:47], v[212:215], a[184:187], v[44:47]
    ds_read_b128 a[236:239], v5 offset:60416
    v_mul_f32 v151, v151, v244
    v_mul_f32 v156, v156, v240
    v_mul_f32 v157, v157, v240
    v_mfma_f32_16x16x32_bf16 v[52:55], v[212:215], a[188:191], v[52:55]
    s_lshl_b32 s56, s55, 7
    v_mul_f32 v158, v158, v240
    v_mul_f32 v159, v159, v240
    v_mul_f32 v164, v164, v241
    v_mul_f32 v165, v165, v241
    v_mfma_f32_16x16x32_bf16 v[60:63], v[212:215], a[192:195], v[60:63]
    s_add_u32 s56, s56, s1
    s_add_u32 s55, s55, 1
    s_cmp_eq_u32 s55, 7
    s_cselect_b32 s55, 0, s55
    s_add_u32 m0, s49, 0
    s_nop 0
    buffer_load_dwordx4 v28, s[40:43], s56 offen offset:0  lds
    v_mfma_f32_16x16x32_bf16 v[68:71], v[212:215], a[196:199], v[68:71]
    s_waitcnt lgkmcnt(0)
    ds_read_b64_tr_b16 v[192:193], v12 offset:0
    ds_read_b64_tr_b16 v[194:195], v12 offset:256
    ds_read_b64_tr_b16 v[196:197], v12 offset:16896
    ds_read_b64_tr_b16 v[198:199], v12 offset:17152
    v_mfma_f32_16x16x32_bf16 v[36:39], v[216:219], a[200:203], v[36:39]
    buffer_load_dwordx4 v29, s[40:43], s56 offen offset:1056  lds
    v_mfma_f32_16x16x32_bf16 v[44:47], v[216:219], a[204:207], v[44:47]
    buffer_load_dwordx4 v30, s[40:43], s56 offen offset:2112  lds
    v_mfma_f32_16x16x32_bf16 v[52:55], v[216:219], a[208:211], v[52:55]
    buffer_load_dwordx4 v31, s[40:43], s56 offen offset:3168  lds
    v_mfma_f32_16x16x32_bf16 v[60:63], v[216:219], a[212:215], v[60:63]
    ds_read_b64_tr_b16 v[200:201], v12 offset:512
    s_add_u32 s51, s56, 3584
    v_mfma_f32_16x16x32_bf16 v[68:71], v[216:219], a[216:219], v[68:71]
    ds_read_b64_tr_b16 v[202:203], v12 offset:768
    s_add_u32 m0, s49, 4224
    v_mfma_f32_16x16x32_bf16 v[36:39], v[220:223], a[220:223], v[36:39]
    ds_read_b64_tr_b16 v[204:205], v12 offset:17408
    v_mul_f32 v166, v166, v241
    v_mfma_f32_16x16x32_bf16 v[44:47], v[220:223], a[224:227], v[44:47]
    ds_read_b64_tr_b16 v[206:207], v12 offset:17664
    v_mul_f32 v167, v167, v241
    v_mfma_f32_16x16x32_bf16 v[52:55], v[220:223], a[228:231], v[52:55]
    buffer_load_dwordx4 v28, s[40:43], s51 offen offset:0  lds
    v_mfma_f32_16x16x32_bf16 v[60:63], v[220:223], a[232:235], v[60:63]
    buffer_load_dwordx4 v29, s[40:43], s51 offen offset:1056  lds
    v_mfma_f32_16x16x32_bf16 v[68:71], v[220:223], a[236:239], v[68:71]
    s_waitcnt lgkmcnt(4)
    ds_read_b64_tr_b16 v[208:209], v12 offset:8448
    v_mfma_f32_16x16x32_bf16 v[76:79], v[192:195], a[80:83], v[76:79]
    buffer_load_dwordx4 v30, s[40:43], s51 offen offset:2112  lds
    v_mfma_f32_16x16x32_bf16 v[84:87], v[192:195], a[84:87], v[84:87]
    ds_read_b64_tr_b16 v[210:211], v12 offset:8704
    v_mul_f32 v36, v36, v245
    v_mfma_f32_16x16x32_bf16 v[92:95], v[192:195], a[88:91], v[92:95]
    ds_read_b64_tr_b16 v[212:213], v12 offset:25344
    v_mul_f32 v37, v37, v245
    v_mfma_f32_16x16x32_bf16 v[100:103], v[192:195], a[92:95], v[100:103]
    ds_read_b64_tr_b16 v[214:215], v12 offset:25600
    v_mul_f32 v38, v38, v245
    v_mfma_f32_16x16x32_bf16 v[108:111], v[192:195], a[96:99], v[108:111]
    buffer_load_dwordx4 v31, s[40:43], s51 offen offset:3168  lds
    v_mfma_f32_16x16x32_bf16 v[76:79], v[196:199], a[100:103], v[76:79]
    s_lshl_b32 s56, s55, 7
    s_add_u32 s56, s56, s1
    v_mul_f32 v39, v39, v245
    v_mfma_f32_16x16x32_bf16 v[84:87], v[196:199], a[104:107], v[84:87]
    s_add_u32 s55, s55, 1
    s_cmp_eq_u32 s55, 7
    s_cselect_b32 s55, 0, s55
    v_mfma_f32_16x16x32_bf16 v[92:95], v[196:199], a[108:111], v[92:95]
    s_add_u32 m0, s49, 101376
    ds_read_b64_tr_b16 v[216:217], v12 offset:8960
    v_mfma_f32_16x16x32_bf16 v[100:103], v[196:199], a[112:115], v[100:103]
    buffer_load_dwordx4 v28, s[40:43], s56 offen offset:0  lds
    v_mfma_f32_16x16x32_bf16 v[108:111], v[196:199], a[116:119], v[108:111]
    s_waitcnt lgkmcnt(5)
    ds_read_b64_tr_b16 v[218:219], v12 offset:9216
    v_mfma_f32_16x16x32_bf16 v[76:79], v[200:203], a[120:123], v[76:79]
    ds_read_b64_tr_b16 v[220:221], v12 offset:25856
    v_cvt_pk_bf16_f32 v36, v36, v37
    v_mfma_f32_16x16x32_bf16 v[84:87], v[200:203], a[124:127], v[84:87]
    ds_read_b64_tr_b16 v[222:223], v12 offset:26112
    v_cvt_pk_bf16_f32 v37, v38, v39
    v_mfma_f32_16x16x32_bf16 v[92:95], v[200:203], a[128:131], v[92:95]
    buffer_load_dwordx4 v29, s[40:43], s56 offen offset:1056  lds
    v_mfma_f32_16x16x32_bf16 v[100:103], v[200:203], a[132:135], v[100:103]
    buffer_load_dwordx4 v30, s[40:43], s56 offen offset:2112  lds
    v_mfma_f32_16x16x32_bf16 v[108:111], v[200:203], a[136:139], v[108:111]
    buffer_load_dwordx4 v31, s[40:43], s56 offen offset:3168  lds
    v_mfma_f32_16x16x32_bf16 v[76:79], v[204:207], a[140:143], v[76:79]
    s_add_u32 s51, s56, 3584
    s_add_u32 m0, s49, 105600
    v_mul_f32 v44, v44, v246
    v_mfma_f32_16x16x32_bf16 v[84:87], v[204:207], a[144:147], v[84:87]
    buffer_load_dwordx4 v28, s[40:43], s51 offen offset:0  lds
    v_mfma_f32_16x16x32_bf16 v[92:95], v[204:207], a[148:151], v[92:95]
    v_mul_f32 v45, v45, v246
    v_mul_f32 v46, v46, v246
    v_mfma_f32_16x16x32_bf16 v[100:103], v[204:207], a[152:155], v[100:103]
    buffer_load_dwordx4 v29, s[40:43], s51 offen offset:1056  lds
    v_mfma_f32_16x16x32_bf16 v[108:111], v[204:207], a[156:159], v[108:111]
    v_mul_f32 v47, v47, v246
    s_waitcnt vmcnt(14) lgkmcnt(0)
    s_barrier
    v_mfma_f32_16x16x32_bf16 v[76:79], v[208:211], a[160:163], v[76:79]
    v_add_u32 v12, 67584, v10
    v_cvt_pk_bf16_f32 v44, v44, v45
    v_mfma_f32_16x16x32_bf16 v[84:87], v[208:211], a[164:167], v[84:87]
    ds_read_b64_tr_b16 v[192:193], v12 offset:0
    v_cvt_pk_bf16_f32 v45, v46, v47
    v_mfma_f32_16x16x32_bf16 v[92:95], v[208:211], a[168:171], v[92:95]
    ds_read_b64_tr_b16 v[194:195], v12 offset:256
    v_mul_f32 v52, v52, v247
    v_mfma_f32_16x16x32_bf16 v[100:103], v[208:211], a[172:175], v[100:103]
    ds_read_b64_tr_b16 v[196:197], v12 offset:16896
    v_mul_f32 v53, v53, v247
    v_mfma_f32_16x16x32_bf16 v[108:111], v[208:211], a[176:179], v[108:111]
    ds_read_b64_tr_b16 v[198:199], v12 offset:17152
    v_mul_f32 v54, v54, v247
    v_mfma_f32_16x16x32_bf16 v[76:79], v[212:215], a[180:183], v[76:79]
    buffer_load_dwordx4 v30, s[40:43], s51 offen offset:2112  lds
    v_mfma_f32_16x16x32_bf16 v[84:87], v[212:215], a[184:187], v[84:87]
    buffer_load_dwordx4 v31, s[40:43], s51 offen offset:3168  lds
    v_mfma_f32_16x16x32_bf16 v[92:95], v[212:215], a[188:191], v[92:95]
    s_lshl_b32 s56, s55, 7
    s_add_u32 s56, s56, s1
    v_mul_f32 v55, v55, v247
    v_mfma_f32_16x16x32_bf16 v[100:103], v[212:215], a[192:195], v[100:103]
    s_add_u32 s55, s55, 1
    s_cmp_eq_u32 s55, 7
    s_cselect_b32 s55, 0, s55
    v_mfma_f32_16x16x32_bf16 v[108:111], v[212:215], a[196:199], v[108:111]
    s_add_u32 m0, s49, 33792
    v_cvt_pk_bf16_f32 v52, v52, v53
    v_mfma_f32_16x16x32_bf16 v[76:79], v[216:219], a[200:203], v[76:79]
    buffer_load_dwordx4 v28, s[40:43], s56 offen offset:0  lds
    v_mfma_f32_16x16x32_bf16 v[84:87], v[216:219], a[204:207], v[84:87]
    buffer_load_dwordx4 v29, s[40:43], s56 offen offset:1056  lds
    v_mfma_f32_16x16x32_bf16 v[92:95], v[216:219], a[208:211], v[92:95]
    ds_read_b64_tr_b16 v[200:201], v12 offset:512
    v_cvt_pk_bf16_f32 v53, v54, v55
    v_mfma_f32_16x16x32_bf16 v[100:103], v[216:219], a[212:215], v[100:103]
    ds_read_b64_tr_b16 v[202:203], v12 offset:768
    v_mul_f32 v60, v60, v248
    v_mfma_f32_16x16x32_bf16 v[108:111], v[216:219], a[216:219], v[108:111]
    ds_read_b64_tr_b16 v[204:205], v12 offset:17408
    v_mul_f32 v61, v61, v248
    v_mfma_f32_16x16x32_bf16 v[76:79], v[220:223], a[220:223], v[76:79]
    ds_read_b64_tr_b16 v[206:207], v12 offset:17664
    v_mul_f32 v62, v62, v248
    v_mul_f32 v63, v63, v248
    v_mfma_f32_16x16x32_bf16 v[84:87], v[220:223], a[224:227], v[84:87]
    buffer_load_dwordx4 v30, s[40:43], s56 offen offset:2112  lds
    v_mfma_f32_16x16x32_bf16 v[92:95], v[220:223], a[228:231], v[92:95]
    buffer_load_dwordx4 v31, s[40:43], s56 offen offset:3168  lds
    v_cvt_pk_bf16_f32 v60, v60, v61
    v_cvt_pk_bf16_f32 v61, v62, v63
    v_mfma_f32_16x16x32_bf16 v[100:103], v[220:223], a[232:235], v[100:103]
    s_add_u32 s51, s56, 3584
    v_mul_f32 v68, v68, v249
    v_mul_f32 v69, v69, v249
    v_mul_f32 v70, v70, v249
    v_mul_f32 v71, v71, v249
    v_cvt_pk_bf16_f32 v68, v68, v69
    v_cvt_pk_bf16_f32 v69, v70, v71
    v_mfma_f32_16x16x32_bf16 v[108:111], v[220:223], a[236:239], v[108:111]
    s_waitcnt lgkmcnt(4)
    s_add_u32 m0, s49, 38016
    s_add_u32 s58, s59, 0
    v_mfma_f32_16x16x32_bf16 v[116:119], v[192:195], a[80:83], v[116:119]
    buffer_load_dwordx4 v28, s[40:43], s51 offen offset:0  lds
    v_mfma_f32_16x16x32_bf16 v[124:127], v[192:195], a[84:87], v[124:127]
    ds_read_b64_tr_b16 v[208:209], v12 offset:8448
    v_mul_f32 v76, v76, v245
    v_mfma_f32_16x16x32_bf16 v[132:135], v[192:195], a[88:91], v[132:135]
    ds_read_b64_tr_b16 v[210:211], v12 offset:8704
    v_mul_f32 v77, v77, v245
    v_mfma_f32_16x16x32_bf16 v[140:143], v[192:195], a[92:95], v[140:143]
    ds_read_b64_tr_b16 v[212:213], v12 offset:25344
    v_mul_f32 v78, v78, v245
    v_mfma_f32_16x16x32_bf16 v[148:151], v[192:195], a[96:99], v[148:151]
    ds_read_b64_tr_b16 v[214:215], v12 offset:25600
    v_mul_f32 v79, v79, v245
    v_mfma_f32_16x16x32_bf16 v[116:119], v[196:199], a[100:103], v[116:119]
    buffer_load_dwordx4 v29, s[40:43], s51 offen offset:1056  lds
    v_mfma_f32_16x16x32_bf16 v[124:127], v[196:199], a[104:107], v[124:127]
    ds_read_b64_tr_b16 v[216:217], v12 offset:8960
    v_cvt_pk_bf16_f32 v38, v76, v77
    v_mfma_f32_16x16x32_bf16 v[132:135], v[196:199], a[108:111], v[132:135]
    ds_read_b64_tr_b16 v[218:219], v12 offset:9216
    v_cvt_pk_bf16_f32 v39, v78, v79
    v_mfma_f32_16x16x32_bf16 v[140:143], v[196:199], a[112:115], v[140:143]
    ds_read_b64_tr_b16 v[220:221], v12 offset:25856
    v_mul_f32 v172, v172, v242
    v_mfma_f32_16x16x32_bf16 v[148:151], v[196:199], a[116:119], v[148:151]
    s_waitcnt lgkmcnt(7)
    ds_read_b64_tr_b16 v[222:223], v12 offset:26112
    v_mfma_f32_16x16x32_bf16 v[116:119], v[200:203], a[120:123], v[116:119]
    buffer_load_dwordx4 v30, s[40:43], s51 offen offset:2112  lds
    v_mfma_f32_16x16x32_bf16 v[124:127], v[200:203], a[124:127], v[124:127]
    buffer_load_dwordx4 v31, s[40:43], s51 offen offset:3168  lds
    v_mfma_f32_16x16x32_bf16 v[132:135], v[200:203], a[128:131], v[132:135]
    buffer_store_dwordx4 v[36:39], v18, s[44:47], s58 offen sc1
    v_mfma_f32_16x16x32_bf16 v[140:143], v[200:203], a[132:135], v[140:143]
    s_add_u32 s58, s59, 4096
    v_mul_f32 v84, v84, v246
    v_mul_f32 v85, v85, v246
    v_mfma_f32_16x16x32_bf16 v[148:151], v[200:203], a[136:139], v[148:151]
    v_mul_f32 v86, v86, v246
    v_mul_f32 v87, v87, v246
    v_mfma_f32_16x16x32_bf16 v[116:119], v[204:207], a[140:143], v[116:119]
    v_cvt_pk_bf16_f32 v46, v84, v85
    v_cvt_pk_bf16_f32 v47, v86, v87
    v_mfma_f32_16x16x32_bf16 v[124:127], v[204:207], a[144:147], v[124:127]
    buffer_store_dwordx4 v[44:47], v18, s[44:47], s58 offen sc1
    v_mfma_f32_16x16x32_bf16 v[132:135], v[204:207], a[148:151], v[132:135]
    s_add_u32 s58, s59, 8192
    v_mul_f32 v92, v92, v247
    v_mul_f32 v93, v93, v247
    v_mfma_f32_16x16x32_bf16 v[140:143], v[204:207], a[152:155], v[140:143]
    v_mul_f32 v94, v94, v247
    v_mul_f32 v95, v95, v247
    v_mfma_f32_16x16x32_bf16 v[148:151], v[204:207], a[156:159], v[148:151]
    v_cvt_pk_bf16_f32 v54, v92, v93
    s_waitcnt vmcnt(18) lgkmcnt(0)
    s_barrier
    v_mfma_f32_16x16x32_bf16 v[116:119], v[208:211], a[160:163], v[116:119]
    s_lshl_b32 s56, s55, 7
    s_add_u32 s56, s56, s1
    v_add_u32 v12, 0, v10
    v_mfma_f32_16x16x32_bf16 v[124:127], v[208:211], a[164:167], v[124:127]
    s_add_u32 s55, s55, 1
    s_cmp_eq_u32 s55, 7
    s_cselect_b32 s55, 0, s55
    v_mfma_f32_16x16x32_bf16 v[132:135], v[208:211], a[168:171], v[132:135]
    s_add_u32 m0, s49, 67584
    ds_read_b64_tr_b16 v[192:193], v12 offset:0
    v_mfma_f32_16x16x32_bf16 v[140:143], v[208:211], a[172:175], v[140:143]
    buffer_load_dwordx4 v28, s[40:43], s56 offen offset:0  lds
    v_mfma_f32_16x16x32_bf16 v[148:151], v[208:211], a[176:179], v[148:151]
    ds_read_b64_tr_b16 v[194:195], v12 offset:256
    v_cvt_pk_bf16_f32 v55, v94, v95
    v_mfma_f32_16x16x32_bf16 v[116:119], v[212:215], a[180:183], v[116:119]
    ds_read_b64_tr_b16 v[196:197], v12 offset:16896
    v_mul_f32 v173, v173, v242
    v_mfma_f32_16x16x32_bf16 v[124:127], v[212:215], a[184:187], v[124:127]
    ds_read_b64_tr_b16 v[198:199], v12 offset:17152
    v_mul_f32 v174, v174, v242
    v_mfma_f32_16x16x32_bf16 v[132:135], v[212:215], a[188:191], v[132:135]
    buffer_load_dwordx4 v29, s[40:43], s56 offen offset:1056  lds
    v_mfma_f32_16x16x32_bf16 v[140:143], v[212:215], a[192:195], v[140:143]
    buffer_load_dwordx4 v30, s[40:43], s56 offen offset:2112  lds
    v_mul_f32 v175, v175, v242
    v_mfma_f32_16x16x32_bf16 v[148:151], v[212:215], a[196:199], v[148:151]
    v_mul_f32 v180, v180, v243
    v_mul_f32 v181, v181, v243
    v_mfma_f32_16x16x32_bf16 v[116:119], v[216:219], a[200:203], v[116:119]
    buffer_store_dwordx4 v[52:55], v18, s[44:47], s58 offen sc1
    v_mfma_f32_16x16x32_bf16 v[124:127], v[216:219], a[204:207], v[124:127]
    buffer_load_dwordx4 v31, s[40:43], s56 offen offset:3168  lds
    v_mfma_f32_16x16x32_bf16 v[132:135], v[216:219], a[208:211], v[132:135]
    s_add_u32 s58, s59, 12288
    v_mul_f32 v100, v100, v248
    v_mul_f32 v101, v101, v248
    v_mul_f32 v102, v102, v248
    v_mfma_f32_16x16x32_bf16 v[140:143], v[216:219], a[212:215], v[140:143]
    ds_read_b64_tr_b16 v[200:201], v12 offset:512
    v_mul_f32 v103, v103, v248
    v_mfma_f32_16x16x32_bf16 v[148:151], v[216:219], a[216:219], v[148:151]
    ds_read_b64_tr_b16 v[202:203], v12 offset:768
    v_cvt_pk_bf16_f32 v62, v100, v101
    v_cvt_pk_bf16_f32 v63, v102, v103
    v_mfma_f32_16x16x32_bf16 v[116:119], v[220:223], a[220:223], v[116:119]
    buffer_store_dwordx4 v[60:63], v18, s[44:47], s58 offen sc1
    v_mfma_f32_16x16x32_bf16 v[124:127], v[220:223], a[224:227], v[124:127]
    s_add_u32 s58, s59, 16384
    v_mul_f32 v108, v108, v249
    v_mul_f32 v109, v109, v249
    v_mul_f32 v110, v110, v249
    v_mfma_f32_16x16x32_bf16 v[132:135], v[220:223], a[228:231], v[132:135]
    ds_read_b64_tr_b16 v[204:205], v12 offset:17408
    v_mul_f32 v111, v111, v249
    v_mfma_f32_16x16x32_bf16 v[140:143], v[220:223], a[232:235], v[140:143]
    ds_read_b64_tr_b16 v[206:207], v12 offset:17664
    v_cvt_pk_bf16_f32 v70, v108, v109
    v_cvt_pk_bf16_f32 v71, v110, v111
    buffer_store_dwordx4 v[68:71], v18, s[44:47], s58 offen sc1
    v_mfma_f32_16x16x32_bf16 v[148:151], v[220:223], a[236:239], v[148:151]
    s_waitcnt lgkmcnt(4)
    s_add_u32 s51, s56, 3584
    s_add_u32 m0, s49, 71808
    v_mfma_f32_16x16x32_bf16 v[156:159], v[192:195], a[80:83], v[156:159]
    buffer_load_dwordx4 v28, s[40:43], s51 offen offset:0  lds
    v_mfma_f32_16x16x32_bf16 v[164:167], v[192:195], a[84:87], v[164:167]
    buffer_load_dwordx4 v29, s[40:43], s51 offen offset:1056  lds
    v_mul_f32 v182, v182, v243
    v_mul_f32 v183, v183, v243
    v_mfma_f32_16x16x32_bf16 v[172:175], v[192:195], a[88:91], v[172:175]
    buffer_load_dwordx4 v30, s[40:43], s51 offen offset:2112  lds
    v_mul_f32 v188, v188, v244
    v_mul_f32 v189, v189, v244
    v_mul_f32 v190, v190, v244
    v_mul_f32 v191, v191, v244
    v_mfma_f32_16x16x32_bf16 v[180:183], v[192:195], a[92:95], v[180:183]
    ds_read_b64_tr_b16 v[208:209], v12 offset:8448
    v_mul_f32 v116, v116, v245
    v_mfma_f32_16x16x32_bf16 v[188:191], v[192:195], a[96:99], v[188:191]
    ds_read_b64_tr_b16 v[210:211], v12 offset:8704
    v_mul_f32 v117, v117, v245
    v_mfma_f32_16x16x32_bf16 v[156:159], v[196:199], a[100:103], v[156:159]
    ds_read_b64_tr_b16 v[212:213], v12 offset:25344
    v_mul_f32 v118, v118, v245
    v_mfma_f32_16x16x32_bf16 v[164:167], v[196:199], a[104:107], v[164:167]
    ds_read_b64_tr_b16 v[214:215], v12 offset:25600
    v_mul_f32 v119, v119, v245
    v_mfma_f32_16x16x32_bf16 v[172:175], v[196:199], a[108:111], v[172:175]
    buffer_load_dwordx4 v31, s[40:43], s51 offen offset:3168  lds
    v_mfma_f32_16x16x32_bf16 v[180:183], v[196:199], a[112:115], v[180:183]
    ds_read_b64_tr_b16 v[216:217], v12 offset:8960
    v_cvt_pk_bf16_f32 v116, v116, v117
    v_mfma_f32_16x16x32_bf16 v[188:191], v[196:199], a[116:119], v[188:191]
    s_waitcnt lgkmcnt(5)
    ds_read_b64_tr_b16 v[218:219], v12 offset:9216
    v_mfma_f32_16x16x32_bf16 v[156:159], v[200:203], a[120:123], v[156:159]
    ds_read_b64_tr_b16 v[220:221], v12 offset:25856
    v_cvt_pk_bf16_f32 v117, v118, v119
    v_mfma_f32_16x16x32_bf16 v[164:167], v[200:203], a[124:127], v[164:167]
    ds_read_b64_tr_b16 v[222:223], v12 offset:26112
    v_mul_f32 v124, v124, v246
    v_mfma_f32_16x16x32_bf16 v[172:175], v[200:203], a[128:131], v[172:175]
    v_mul_f32 v125, v125, v246
    v_mul_f32 v126, v126, v246
    v_mfma_f32_16x16x32_bf16 v[180:183], v[200:203], a[132:135], v[180:183]
    v_mul_f32 v127, v127, v246
    v_cvt_pk_bf16_f32 v124, v124, v125
    v_mfma_f32_16x16x32_bf16 v[188:191], v[200:203], a[136:139], v[188:191]
    v_cvt_pk_bf16_f32 v125, v126, v127
    v_mul_f32 v132, v132, v247
    v_mfma_f32_16x16x32_bf16 v[156:159], v[204:207], a[140:143], v[156:159]
    v_mul_f32 v133, v133, v247
    v_mul_f32 v134, v134, v247
    v_mfma_f32_16x16x32_bf16 v[164:167], v[204:207], a[144:147], v[164:167]
    v_mul_f32 v135, v135, v247
    v_cvt_pk_bf16_f32 v132, v132, v133
    v_mfma_f32_16x16x32_bf16 v[172:175], v[204:207], a[148:151], v[172:175]
    v_cvt_pk_bf16_f32 v133, v134, v135
    v_mul_f32 v140, v140, v248
    v_mfma_f32_16x16x32_bf16 v[180:183], v[204:207], a[152:155], v[180:183]
    v_mul_f32 v141, v141, v248
    v_mul_f32 v142, v142, v248
    v_mfma_f32_16x16x32_bf16 v[188:191], v[204:207], a[156:159], v[188:191]
    v_mul_f32 v143, v143, v248
    s_waitcnt vmcnt(21) lgkmcnt(0)
    s_barrier
    v_mfma_f32_16x16x32_bf16 v[156:159], v[208:211], a[160:163], v[156:159]
    v_add_u32 v12, 101376, v10
    v_cvt_pk_bf16_f32 v140, v140, v141
    v_mfma_f32_16x16x32_bf16 v[164:167], v[208:211], a[164:167], v[164:167]
    ds_read_b64_tr_b16 v[192:193], v12 offset:0
    v_cvt_pk_bf16_f32 v141, v142, v143
    v_mfma_f32_16x16x32_bf16 v[172:175], v[208:211], a[168:171], v[172:175]
    ds_read_b64_tr_b16 v[194:195], v12 offset:256
    v_mul_f32 v32, v32, v240
    v_mfma_f32_16x16x32_bf16 v[180:183], v[208:211], a[172:175], v[180:183]
    ds_read_b64_tr_b16 v[196:197], v12 offset:16896
    v_mul_f32 v33, v33, v240
    v_mfma_f32_16x16x32_bf16 v[188:191], v[208:211], a[176:179], v[188:191]
    ds_read_b64_tr_b16 v[198:199], v12 offset:17152
    v_mul_f32 v34, v34, v240
    v_mfma_f32_16x16x32_bf16 v[156:159], v[212:215], a[180:183], v[156:159]
    ds_read_b64_tr_b16 v[200:201], v12 offset:512
    v_mul_f32 v35, v35, v240
    v_mfma_f32_16x16x32_bf16 v[164:167], v[212:215], a[184:187], v[164:167]
    ds_read_b64_tr_b16 v[202:203], v12 offset:768
    v_mul_f32 v148, v148, v249
    v_mfma_f32_16x16x32_bf16 v[172:175], v[212:215], a[188:191], v[172:175]
    ds_read_b64_tr_b16 v[204:205], v12 offset:17408
    v_mul_f32 v149, v149, v249
    v_mfma_f32_16x16x32_bf16 v[180:183], v[212:215], a[192:195], v[180:183]
    ds_read_b64_tr_b16 v[206:207], v12 offset:17664
    v_mul_f32 v150, v150, v249
    v_mfma_f32_16x16x32_bf16 v[188:191], v[212:215], a[196:199], v[188:191]
    v_mul_f32 v151, v151, v249
    v_cvt_pk_bf16_f32 v148, v148, v149
    v_mfma_f32_16x16x32_bf16 v[156:159], v[216:219], a[200:203], v[156:159]
    ds_read_b64_tr_b16 v[208:209], v12 offset:8448
    v_cvt_pk_bf16_f32 v149, v150, v151
    v_mfma_f32_16x16x32_bf16 v[164:167], v[216:219], a[204:207], v[164:167]
    ds_read_b64_tr_b16 v[210:211], v12 offset:8704
    v_mul_f32 v40, v40, v241
    v_mfma_f32_16x16x32_bf16 v[172:175], v[216:219], a[208:211], v[172:175]
    ds_read_b64_tr_b16 v[212:213], v12 offset:25344
    v_mul_f32 v41, v41, v241
    v_mfma_f32_16x16x32_bf16 v[180:183], v[216:219], a[212:215], v[180:183]
    ds_read_b64_tr_b16 v[214:215], v12 offset:25600
    v_mul_f32 v42, v42, v241
    v_mfma_f32_16x16x32_bf16 v[188:191], v[216:219], a[216:219], v[188:191]
    v_mul_f32 v43, v43, v241
    v_mul_f32 v48, v48, v242
    v_mfma_f32_16x16x32_bf16 v[156:159], v[220:223], a[220:223], v[156:159]
    ds_read_b64_tr_b16 v[216:217], v12 offset:8960
    v_mul_f32 v49, v49, v242
    v_mfma_f32_16x16x32_bf16 v[164:167], v[220:223], a[224:227], v[164:167]
    ds_read_b64_tr_b16 v[218:219], v12 offset:9216
    v_mul_f32 v50, v50, v242
    v_mfma_f32_16x16x32_bf16 v[172:175], v[220:223], a[228:231], v[172:175]
    v_mul_f32 v51, v51, v242
    v_mul_f32 v56, v56, v243
    v_mfma_f32_16x16x32_bf16 v[180:183], v[220:223], a[232:235], v[180:183]
    v_mul_f32 v57, v57, v243
    v_mul_f32 v58, v58, v243
    v_mfma_f32_16x16x32_bf16 v[188:191], v[220:223], a[236:239], v[188:191]
    s_waitcnt lgkmcnt(10)
    v_mul_f32 v59, v59, v243
    v_mul_f32 v64, v64, v244
    v_mfma_f32_16x16x32_bf16 v[32:35], v[192:195], a[80:83], v[32:35]
    ds_read_b64_tr_b16 v[220:221], v12 offset:25856
    v_mul_f32 v65, v65, v244
    v_mfma_f32_16x16x32_bf16 v[40:43], v[192:195], a[84:87], v[40:43]
    ds_read_b64_tr_b16 v[222:223], v12 offset:26112
    v_mul_f32 v66, v66, v244
    v_mfma_f32_16x16x32_bf16 v[48:51], v[192:195], a[88:91], v[48:51]
    s_add_u32 s58, s59, 20480
    v_mul_f32 v67, v67, v244
    v_mul_f32 v156, v156, v245
    v_mfma_f32_16x16x32_bf16 v[56:59], v[192:195], a[92:95], v[56:59]
    v_mul_f32 v157, v157, v245
    v_mul_f32 v158, v158, v245
    v_mfma_f32_16x16x32_bf16 v[64:67], v[192:195], a[96:99], v[64:67]
    v_mul_f32 v159, v159, v245
    v_cvt_pk_bf16_f32 v118, v156, v157
    v_mfma_f32_16x16x32_bf16 v[32:35], v[196:199], a[100:103], v[32:35]
    v_cvt_pk_bf16_f32 v119, v158, v159
    v_mul_f32 v72, v72, v240
    v_mfma_f32_16x16x32_bf16 v[40:43], v[196:199], a[104:107], v[40:43]
    buffer_store_dwordx4 v[116:119], v18, s[44:47], s58 offen sc1
    v_mfma_f32_16x16x32_bf16 v[48:51], v[196:199], a[108:111], v[48:51]
    s_add_u32 s58, s59, 24576
    v_mul_f32 v164, v164, v246
    v_mul_f32 v165, v165, v246
    v_mfma_f32_16x16x32_bf16 v[56:59], v[196:199], a[112:115], v[56:59]
    v_mul_f32 v166, v166, v246
    v_mul_f32 v167, v167, v246
    v_mfma_f32_16x16x32_bf16 v[64:67], v[196:199], a[116:119], v[64:67]
    s_waitcnt lgkmcnt(8)
    v_cvt_pk_bf16_f32 v126, v164, v165
    v_cvt_pk_bf16_f32 v127, v166, v167
    v_mfma_f32_16x16x32_bf16 v[32:35], v[200:203], a[120:123], v[32:35]
    buffer_store_dwordx4 v[124:127], v18, s[44:47], s58 offen sc1
    v_mfma_f32_16x16x32_bf16 v[40:43], v[200:203], a[124:127], v[40:43]
    s_add_u32 s58, s59, 28672
    v_mul_f32 v172, v172, v247
    v_mul_f32 v173, v173, v247
    v_mfma_f32_16x16x32_bf16 v[48:51], v[200:203], a[128:131], v[48:51]
    v_mul_f32 v174, v174, v247
    v_mul_f32 v175, v175, v247
    v_mfma_f32_16x16x32_bf16 v[56:59], v[200:203], a[132:135], v[56:59]
    v_cvt_pk_bf16_f32 v134, v172, v173
    v_cvt_pk_bf16_f32 v135, v174, v175
    v_mfma_f32_16x16x32_bf16 v[64:67], v[200:203], a[136:139], v[64:67]
    buffer_store_dwordx4 v[132:135], v18, s[44:47], s58 offen sc1
    v_mfma_f32_16x16x32_bf16 v[32:35], v[204:207], a[140:143], v[32:35]
    s_add_u32 s58, s59, 32768
    v_mul_f32 v180, v180, v248
    v_mul_f32 v181, v181, v248
    v_mfma_f32_16x16x32_bf16 v[40:43], v[204:207], a[144:147], v[40:43]
    v_mul_f32 v182, v182, v248
    v_mul_f32 v183, v183, v248
    v_mfma_f32_16x16x32_bf16 v[48:51], v[204:207], a[148:151], v[48:51]
    v_cvt_pk_bf16_f32 v142, v180, v181
    v_cvt_pk_bf16_f32 v143, v182, v183
    v_mfma_f32_16x16x32_bf16 v[56:59], v[204:207], a[152:155], v[56:59]
    buffer_store_dwordx4 v[140:143], v18, s[44:47], s58 offen sc1
    v_mfma_f32_16x16x32_bf16 v[64:67], v[204:207], a[156:159], v[64:67]
    s_add_u32 s58, s59, 36864
    v_mul_f32 v73, v73, v240
    s_waitcnt vmcnt(17) lgkmcnt(0)
    s_barrier
    v_mfma_f32_16x16x32_bf16 v[32:35], v[208:211], a[160:163], v[32:35]
    v_add_u32 v12, 33792, v10
    v_mul_f32 v74, v74, v240
    v_mfma_f32_16x16x32_bf16 v[40:43], v[208:211], a[164:167], v[40:43]
    ds_read_b64_tr_b16 v[192:193], v12 offset:0
    v_mul_f32 v75, v75, v240
    v_mfma_f32_16x16x32_bf16 v[48:51], v[208:211], a[168:171], v[48:51]
    ds_read_b64_tr_b16 v[194:195], v12 offset:256
    v_mul_f32 v188, v188, v249
    v_mfma_f32_16x16x32_bf16 v[56:59], v[208:211], a[172:175], v[56:59]
    ds_read_b64_tr_b16 v[196:197], v12 offset:16896
    v_mul_f32 v189, v189, v249
    v_mfma_f32_16x16x32_bf16 v[64:67], v[208:211], a[176:179], v[64:67]
    ds_read_b64_tr_b16 v[198:199], v12 offset:17152
    v_mul_f32 v190, v190, v249
    v_mfma_f32_16x16x32_bf16 v[32:35], v[212:215], a[180:183], v[32:35]
    ds_read_b64_tr_b16 v[200:201], v12 offset:512
    v_mul_f32 v191, v191, v249
    v_mfma_f32_16x16x32_bf16 v[40:43], v[212:215], a[184:187], v[40:43]
    ds_read_b64_tr_b16 v[202:203], v12 offset:768
    v_cvt_pk_bf16_f32 v150, v188, v189
    v_mfma_f32_16x16x32_bf16 v[48:51], v[212:215], a[188:191], v[48:51]
    ds_read_b64_tr_b16 v[204:205], v12 offset:17408
    v_cvt_pk_bf16_f32 v151, v190, v191
    v_mfma_f32_16x16x32_bf16 v[56:59], v[212:215], a[192:195], v[56:59]
    buffer_store_dwordx4 v[148:151], v18, s[44:47], s58 offen sc1
    v_mfma_f32_16x16x32_bf16 v[64:67], v[212:215], a[196:199], v[64:67]
    ds_read_b64_tr_b16 v[206:207], v12 offset:17664
    v_mfma_f32_16x16x32_bf16 v[32:35], v[216:219], a[200:203], v[32:35]
    ds_read_b64_tr_b16 v[208:209], v12 offset:8448
    v_mul_f32 v80, v80, v241
    v_mfma_f32_16x16x32_bf16 v[40:43], v[216:219], a[204:207], v[40:43]
    ds_read_b64_tr_b16 v[210:211], v12 offset:8704
    v_mul_f32 v81, v81, v241
    v_mfma_f32_16x16x32_bf16 v[48:51], v[216:219], a[208:211], v[48:51]
    ds_read_b64_tr_b16 v[212:213], v12 offset:25344
    v_mul_f32 v82, v82, v241
    v_mfma_f32_16x16x32_bf16 v[56:59], v[216:219], a[212:215], v[56:59]
    ds_read_b64_tr_b16 v[214:215], v12 offset:25600
    v_mul_f32 v83, v83, v241
    v_mfma_f32_16x16x32_bf16 v[64:67], v[216:219], a[216:219], v[64:67]
    v_mul_f32 v88, v88, v242
    v_mul_f32 v89, v89, v242
    v_mfma_f32_16x16x32_bf16 v[32:35], v[220:223], a[220:223], v[32:35]
    ds_read_b64_tr_b16 v[216:217], v12 offset:8960
    v_mul_f32 v90, v90, v242
    v_mfma_f32_16x16x32_bf16 v[40:43], v[220:223], a[224:227], v[40:43]
    ds_read_b64_tr_b16 v[218:219], v12 offset:9216
    v_mul_f32 v91, v91, v242
    v_mfma_f32_16x16x32_bf16 v[48:51], v[220:223], a[228:231], v[48:51]
    v_mul_f32 v96, v96, v243
    v_mul_f32 v97, v97, v243
    v_mfma_f32_16x16x32_bf16 v[56:59], v[220:223], a[232:235], v[56:59]
    v_mul_f32 v98, v98, v243
    v_mul_f32 v99, v99, v243
    v_mfma_f32_16x16x32_bf16 v[64:67], v[220:223], a[236:239], v[64:67]
    s_waitcnt lgkmcnt(10)
    v_mul_f32 v104, v104, v244
    v_mul_f32 v105, v105, v244
    v_mfma_f32_16x16x32_bf16 v[72:75], v[192:195], a[80:83], v[72:75]
    ds_read_b64_tr_b16 v[220:221], v12 offset:25856
    v_mul_f32 v106, v106, v244
    v_mfma_f32_16x16x32_bf16 v[80:83], v[192:195], a[84:87], v[80:83]
    ds_read_b64_tr_b16 v[222:223], v12 offset:26112
    v_mul_f32 v107, v107, v244
    v_mfma_f32_16x16x32_bf16 v[88:91], v[192:195], a[88:91], v[88:91]
    v_mul_f32 v32, v32, v245
    v_mul_f32 v33, v33, v245
    v_mfma_f32_16x16x32_bf16 v[96:99], v[192:195], a[92:95], v[96:99]
    v_mul_f32 v34, v34, v245
    v_mul_f32 v35, v35, v245
    v_mfma_f32_16x16x32_bf16 v[104:107], v[192:195], a[96:99], v[104:107]
    v_cvt_pk_bf16_f32 v32, v32, v33
    v_cvt_pk_bf16_f32 v33, v34, v35
    v_mfma_f32_16x16x32_bf16 v[72:75], v[196:199], a[100:103], v[72:75]
    v_mul_f32 v40, v40, v246
    v_mul_f32 v41, v41, v246
    v_mfma_f32_16x16x32_bf16 v[80:83], v[196:199], a[104:107], v[80:83]
    v_mul_f32 v42, v42, v246
    v_mul_f32 v43, v43, v246
    v_mfma_f32_16x16x32_bf16 v[88:91], v[196:199], a[108:111], v[88:91]
    v_cvt_pk_bf16_f32 v40, v40, v41
    v_cvt_pk_bf16_f32 v41, v42, v43
    v_mfma_f32_16x16x32_bf16 v[96:99], v[196:199], a[112:115], v[96:99]
    v_mul_f32 v48, v48, v247
    v_mul_f32 v49, v49, v247
    v_mfma_f32_16x16x32_bf16 v[104:107], v[196:199], a[116:119], v[104:107]
    s_waitcnt lgkmcnt(8)
    v_mul_f32 v50, v50, v247
    v_mul_f32 v51, v51, v247
    v_mfma_f32_16x16x32_bf16 v[72:75], v[200:203], a[120:123], v[72:75]
    v_cvt_pk_bf16_f32 v48, v48, v49
    v_cvt_pk_bf16_f32 v49, v50, v51
    v_mfma_f32_16x16x32_bf16 v[80:83], v[200:203], a[124:127], v[80:83]
    v_mul_f32 v56, v56, v248
    v_mul_f32 v57, v57, v248
    v_mfma_f32_16x16x32_bf16 v[88:91], v[200:203], a[128:131], v[88:91]
    v_mul_f32 v58, v58, v248
    v_mul_f32 v59, v59, v248
    v_mfma_f32_16x16x32_bf16 v[96:99], v[200:203], a[132:135], v[96:99]
    v_cvt_pk_bf16_f32 v56, v56, v57
    v_cvt_pk_bf16_f32 v57, v58, v59
    v_mfma_f32_16x16x32_bf16 v[104:107], v[200:203], a[136:139], v[104:107]
    v_mul_f32 v112, v112, v240
    v_mul_f32 v113, v113, v240
    v_mfma_f32_16x16x32_bf16 v[72:75], v[204:207], a[140:143], v[72:75]
    v_mul_f32 v114, v114, v240
    v_mul_f32 v115, v115, v240
    v_mfma_f32_16x16x32_bf16 v[80:83], v[204:207], a[144:147], v[80:83]
    v_mul_f32 v64, v64, v249
    v_mul_f32 v65, v65, v249
    v_mfma_f32_16x16x32_bf16 v[88:91], v[204:207], a[148:151], v[88:91]
    v_mul_f32 v66, v66, v249
    v_mul_f32 v67, v67, v249
    v_mfma_f32_16x16x32_bf16 v[96:99], v[204:207], a[152:155], v[96:99]
    v_cvt_pk_bf16_f32 v64, v64, v65
    v_cvt_pk_bf16_f32 v65, v66, v67
    v_mfma_f32_16x16x32_bf16 v[104:107], v[204:207], a[156:159], v[104:107]
    v_mul_f32 v120, v120, v241
    s_waitcnt vmcnt(5) lgkmcnt(0)
    s_barrier
    v_mfma_f32_16x16x32_bf16 v[72:75], v[208:211], a[160:163], v[72:75]
    v_add_u32 v12, 67584, v10
    v_mul_f32 v121, v121, v241
    v_mfma_f32_16x16x32_bf16 v[80:83], v[208:211], a[164:167], v[80:83]
    ds_read_b64_tr_b16 v[192:193], v12 offset:0
    v_mul_f32 v122, v122, v241
    v_mfma_f32_16x16x32_bf16 v[88:91], v[208:211], a[168:171], v[88:91]
    ds_read_b64_tr_b16 v[194:195], v12 offset:256
    v_mul_f32 v123, v123, v241
    v_mfma_f32_16x16x32_bf16 v[96:99], v[208:211], a[172:175], v[96:99]
    ds_read_b64_tr_b16 v[196:197], v12 offset:16896
    v_mul_f32 v128, v128, v242
    v_mfma_f32_16x16x32_bf16 v[104:107], v[208:211], a[176:179], v[104:107]
    ds_read_b64_tr_b16 v[198:199], v12 offset:17152
    v_mul_f32 v129, v129, v242
    v_mfma_f32_16x16x32_bf16 v[72:75], v[212:215], a[180:183], v[72:75]
    ds_read_b64_tr_b16 v[200:201], v12 offset:512
    v_mul_f32 v130, v130, v242
    v_mfma_f32_16x16x32_bf16 v[80:83], v[212:215], a[184:187], v[80:83]
    ds_read_b64_tr_b16 v[202:203], v12 offset:768
    v_mul_f32 v131, v131, v242
    v_mfma_f32_16x16x32_bf16 v[88:91], v[212:215], a[188:191], v[88:91]
    ds_read_b64_tr_b16 v[204:205], v12 offset:17408
    v_mul_f32 v136, v136, v243
    v_mfma_f32_16x16x32_bf16 v[96:99], v[212:215], a[192:195], v[96:99]
    ds_read_b64_tr_b16 v[206:207], v12 offset:17664
    v_mul_f32 v137, v137, v243
    v_mfma_f32_16x16x32_bf16 v[104:107], v[212:215], a[196:199], v[104:107]
    v_mul_f32 v138, v138, v243
    v_mul_f32 v139, v139, v243
    v_mfma_f32_16x16x32_bf16 v[72:75], v[216:219], a[200:203], v[72:75]
    ds_read_b64_tr_b16 v[208:209], v12 offset:8448
    v_mul_f32 v144, v144, v244
    v_mfma_f32_16x16x32_bf16 v[80:83], v[216:219], a[204:207], v[80:83]
    ds_read_b64_tr_b16 v[210:211], v12 offset:8704
    v_mul_f32 v145, v145, v244
    v_mfma_f32_16x16x32_bf16 v[88:91], v[216:219], a[208:211], v[88:91]
    buffer_load_dword v15, v14, s[8:11], 0 offen sc1
    v_mfma_f32_16x16x32_bf16 v[96:99], v[216:219], a[212:215], v[96:99]
    ds_read_b64_tr_b16 v[212:213], v12 offset:25344
    v_mul_f32 v146, v146, v244
    v_mfma_f32_16x16x32_bf16 v[104:107], v[216:219], a[216:219], v[104:107]
    ds_read_b64_tr_b16 v[214:215], v12 offset:25600
    v_mul_f32 v147, v147, v244
    v_mfma_f32_16x16x32_bf16 v[72:75], v[220:223], a[220:223], v[72:75]
    ds_read_b64_tr_b16 v[216:217], v12 offset:8960
    v_mfma_f32_16x16x32_bf16 v[80:83], v[220:223], a[224:227], v[80:83]
    ds_read_b64_tr_b16 v[218:219], v12 offset:9216
    v_mfma_f32_16x16x32_bf16 v[88:91], v[220:223], a[228:231], v[88:91]
    v_mfma_f32_16x16x32_bf16 v[96:99], v[220:223], a[232:235], v[96:99]
    v_mfma_f32_16x16x32_bf16 v[104:107], v[220:223], a[236:239], v[104:107]
    s_waitcnt lgkmcnt(10)
    s_add_u32 s58, s59, 40960
    v_mul_f32 v72, v72, v245
    v_mfma_f32_16x16x32_bf16 v[112:115], v[192:195], a[80:83], v[112:115]
    ds_read_b64_tr_b16 v[220:221], v12 offset:25856
    v_mul_f32 v73, v73, v245
    v_mfma_f32_16x16x32_bf16 v[120:123], v[192:195], a[84:87], v[120:123]
    ds_read_b64_tr_b16 v[222:223], v12 offset:26112
    v_mul_f32 v74, v74, v245
    v_mfma_f32_16x16x32_bf16 v[128:131], v[192:195], a[88:91], v[128:131]
    v_mul_f32 v75, v75, v245
    v_cvt_pk_bf16_f32 v34, v72, v73
    v_mfma_f32_16x16x32_bf16 v[136:139], v[192:195], a[92:95], v[136:139]
    v_cvt_pk_bf16_f32 v35, v74, v75
    v_mfma_f32_16x16x32_bf16 v[144:147], v[192:195], a[96:99], v[144:147]
    buffer_store_dwordx4 v[32:35], v18, s[44:47], s58 offen sc1
    v_mfma_f32_16x16x32_bf16 v[112:115], v[196:199], a[100:103], v[112:115]
    s_add_u32 s58, s59, 45056
    v_mul_f32 v80, v80, v246
    v_mul_f32 v81, v81, v246
    v_mfma_f32_16x16x32_bf16 v[120:123], v[196:199], a[104:107], v[120:123]
    v_mul_f32 v82, v82, v246
    v_mul_f32 v83, v83, v246
    v_mfma_f32_16x16x32_bf16 v[128:131], v[196:199], a[108:111], v[128:131]
    v_cvt_pk_bf16_f32 v42, v80, v81
    v_cvt_pk_bf16_f32 v43, v82, v83
    v_mfma_f32_16x16x32_bf16 v[136:139], v[196:199], a[112:115], v[136:139]
    buffer_store_dwordx4 v[40:43], v18, s[44:47], s58 offen sc1
    v_mfma_f32_16x16x32_bf16 v[144:147], v[196:199], a[116:119], v[144:147]
    s_waitcnt lgkmcnt(8)
    s_add_u32 s58, s59, 49152
    v_mul_f32 v88, v88, v247
    v_mfma_f32_16x16x32_bf16 v[112:115], v[200:203], a[120:123], v[112:115]
    v_mul_f32 v89, v89, v247
    v_mul_f32 v90, v90, v247
    v_mfma_f32_16x16x32_bf16 v[120:123], v[200:203], a[124:127], v[120:123]
    v_mul_f32 v91, v91, v247
    v_cvt_pk_bf16_f32 v50, v88, v89
    v_mfma_f32_16x16x32_bf16 v[128:131], v[200:203], a[128:131], v[128:131]
    v_cvt_pk_bf16_f32 v51, v90, v91
    v_mfma_f32_16x16x32_bf16 v[136:139], v[200:203], a[132:135], v[136:139]
    buffer_store_dwordx4 v[48:51], v18, s[44:47], s58 offen sc1
    v_mfma_f32_16x16x32_bf16 v[144:147], v[200:203], a[136:139], v[144:147]
    s_add_u32 s58, s59, 53248
    v_mul_f32 v96, v96, v248
    v_mul_f32 v97, v97, v248
    v_mfma_f32_16x16x32_bf16 v[112:115], v[204:207], a[140:143], v[112:115]
    v_mul_f32 v98, v98, v248
    v_mul_f32 v99, v99, v248
    v_mfma_f32_16x16x32_bf16 v[120:123], v[204:207], a[144:147], v[120:123]
    v_cvt_pk_bf16_f32 v58, v96, v97
    v_cvt_pk_bf16_f32 v59, v98, v99
    v_mfma_f32_16x16x32_bf16 v[128:131], v[204:207], a[148:151], v[128:131]
    buffer_store_dwordx4 v[56:59], v18, s[44:47], s58 offen sc1
    v_mfma_f32_16x16x32_bf16 v[136:139], v[204:207], a[152:155], v[136:139]
    s_add_u32 s58, s59, 57344
    v_mul_f32 v104, v104, v249
    v_mul_f32 v105, v105, v249
    v_mfma_f32_16x16x32_bf16 v[144:147], v[204:207], a[156:159], v[144:147]
    s_waitcnt lgkmcnt(4)
    v_mul_f32 v106, v106, v249
    v_mul_f32 v107, v107, v249
    v_mfma_f32_16x16x32_bf16 v[112:115], v[208:211], a[160:163], v[112:115]
    v_cvt_pk_bf16_f32 v66, v104, v105
    v_cvt_pk_bf16_f32 v67, v106, v107
    v_mfma_f32_16x16x32_bf16 v[120:123], v[208:211], a[164:167], v[120:123]
    buffer_store_dwordx4 v[64:67], v18, s[44:47], s58 offen sc1
    v_mfma_f32_16x16x32_bf16 v[128:131], v[208:211], a[168:171], v[128:131]
    v_mfma_f32_16x16x32_bf16 v[136:139], v[208:211], a[172:175], v[136:139]
    v_mfma_f32_16x16x32_bf16 v[144:147], v[208:211], a[176:179], v[144:147]
    v_mfma_f32_16x16x32_bf16 v[112:115], v[212:215], a[180:183], v[112:115]
    v_mfma_f32_16x16x32_bf16 v[120:123], v[212:215], a[184:187], v[120:123]
    v_mfma_f32_16x16x32_bf16 v[128:131], v[212:215], a[188:191], v[128:131]
    v_mfma_f32_16x16x32_bf16 v[136:139], v[212:215], a[192:195], v[136:139]
    v_mfma_f32_16x16x32_bf16 v[144:147], v[212:215], a[196:199], v[144:147]
    s_waitcnt lgkmcnt(0)
    v_mfma_f32_16x16x32_bf16 v[112:115], v[216:219], a[200:203], v[112:115]
    v_mfma_f32_16x16x32_bf16 v[120:123], v[216:219], a[204:207], v[120:123]
    v_mfma_f32_16x16x32_bf16 v[128:131], v[216:219], a[208:211], v[128:131]
    v_mfma_f32_16x16x32_bf16 v[136:139], v[216:219], a[212:215], v[136:139]
    v_mfma_f32_16x16x32_bf16 v[144:147], v[216:219], a[216:219], v[144:147]
    v_mfma_f32_16x16x32_bf16 v[112:115], v[220:223], a[220:223], v[112:115]
    v_mfma_f32_16x16x32_bf16 v[120:123], v[220:223], a[224:227], v[120:123]
    v_mfma_f32_16x16x32_bf16 v[128:131], v[220:223], a[228:231], v[128:131]
    v_mfma_f32_16x16x32_bf16 v[136:139], v[220:223], a[232:235], v[136:139]
    v_mfma_f32_16x16x32_bf16 v[144:147], v[220:223], a[236:239], v[144:147]
    s_nop 3
    v_mul_f32 v112, v112, v245
    v_mul_f32 v113, v113, v245
    v_mul_f32 v114, v114, v245
    v_mul_f32 v115, v115, v245
    v_cvt_pk_bf16_f32 v112, v112, v113
    v_cvt_pk_bf16_f32 v113, v114, v115
    s_add_u32 s58, s59, 61440
    v_mul_f32 v120, v120, v246
    v_mul_f32 v121, v121, v246
    v_mul_f32 v122, v122, v246
    v_mul_f32 v123, v123, v246
    v_cvt_pk_bf16_f32 v114, v120, v121
    v_cvt_pk_bf16_f32 v115, v122, v123
    buffer_store_dwordx4 v[112:115], v18, s[44:47], s58 offen sc1
    v_mul_f32 v128, v128, v247
    v_mul_f32 v129, v129, v247
    v_mul_f32 v130, v130, v247
    v_mul_f32 v131, v131, v247
    v_cvt_pk_bf16_f32 v128, v128, v129
    v_cvt_pk_bf16_f32 v129, v130, v131
    s_add_u32 s58, s59, 65536
    v_mul_f32 v136, v136, v248
    v_mul_f32 v137, v137, v248
    v_mul_f32 v138, v138, v248
    v_mul_f32 v139, v139, v248
    v_cvt_pk_bf16_f32 v130, v136, v137
    v_cvt_pk_bf16_f32 v131, v138, v139
    buffer_store_dwordx4 v[128:131], v18, s[44:47], s58 offen sc1
    s_add_u32 s58, s59, 69632
    v_mul_f32 v144, v144, v249
    v_mul_f32 v145, v145, v249
    v_mul_f32 v146, v146, v249
    v_mul_f32 v147, v147, v249
    v_cvt_pk_bf16_f32 v144, v144, v145
    v_cvt_pk_bf16_f32 v145, v146, v147
    v_mov_b32 v146, 0
    v_mov_b32 v147, 0
    buffer_store_dwordx4 v[144:147], v18, s[44:47], s58 offen sc1
    s_lshr_b32 s3, s62, 1
    v_and_b32 v4, 7, v0
    v_cmp_eq_u32 vcc, s3, v4
    s_nop 1
    v_cndmask_b32 v4, 0, 16, vcc
    s_waitcnt vmcnt(9)
    s_barrier
    v_mov_b32 v232, 2
    v_mov_b32 v233, 2
    v_mov_b32 v234, 2
    v_mov_b32 v235, 2
    buffer_store_dwordx4 v[232:235], v255, s[8:11], 0 offen sc1
    s_waitcnt vmcnt(9)
    v_or_b32 v15, v15, v4
    v_cmp_gt_u32 vcc, 2, v15
    s_nop 0
    s_nop 0
    s_cmp_eq_u64 vcc, 0
    s_cselect_b32 s53, 1, 0
    buffer_load_dword v15, v14, s[8:11], 0 offen sc1
    v_readlane_b32 s6, v7, 0
    s_nop 1
    s_cmp_eq_u32 s53, 1
    s_cselect_b32 s6, s6, 0x40000000
    buffer_load_dwordx4 a[0:3], v1, s[12:15], s6 offen sc1
    buffer_load_dwordx4 a[4:7], v2, s[12:15], s6 offen sc1
    v_readlane_b32 s6, v7, 1
    s_nop 1
    s_cmp_eq_u32 s53, 1
    s_cselect_b32 s6, s6, 0x40000000
    buffer_load_dwordx4 a[8:11], v1, s[12:15], s6 offen sc1
    buffer_load_dwordx4 a[12:15], v2, s[12:15], s6 offen sc1
    v_readlane_b32 s6, v7, 2
    s_nop 1
    s_cmp_eq_u32 s53, 1
    s_cselect_b32 s6, s6, 0x40000000
    buffer_load_dwordx4 a[16:19], v1, s[12:15], s6 offen sc1
    buffer_load_dwordx4 a[20:23], v2, s[12:15], s6 offen sc1
    v_readlane_b32 s6, v7, 3
    s_nop 1
    s_cmp_eq_u32 s53, 1
    s_cselect_b32 s6, s6, 0x40000000
    buffer_load_dwordx4 a[24:27], v1, s[12:15], s6 offen sc1
    buffer_load_dwordx4 a[28:31], v2, s[12:15], s6 offen sc1
    v_readlane_b32 s3, v8, 0
    v_readlane_b32 s54, v9, 0
    s_nop 0
    v_add_u32 v176, s3, v6
    v_and_b32 v228, s54, v3
    v_add_u32 v176, v176, v228
    v_readlane_b32 s3, v8, 2
    v_readlane_b32 s54, v9, 2
    s_nop 0
    v_add_u32 v178, s3, v6
    v_and_b32 v228, s54, v3
    v_add_u32 v178, v178, v228
    v_readlane_b32 s3, v8, 4
    v_readlane_b32 s54, v9, 4
    s_nop 0
    v_add_u32 v180, s3, v6
    v_and_b32 v228, s54, v3
    v_add_u32 v180, v180, v228
    v_readlane_b32 s3, v8, 6
    v_readlane_b32 s54, v9, 6
    s_nop 0
    v_add_u32 v182, s3, v6
    v_and_b32 v228, s54, v3
    v_add_u32 v182, v182, v228
    v_readlane_b32 s3, v8, 8
    v_readlane_b32 s54, v9, 8
    s_nop 0
    v_add_u32 v184, s3, v6
    v_and_b32 v228, s54, v3
    v_add_u32 v184, v184, v228
    s_waitcnt vmcnt(10)
    s_barrier
    v_mov_b32 v232, 4
    v_mov_b32 v233, 4
    v_mov_b32 v234, 4
    v_mov_b32 v235, 4
    buffer_store_dwordx4 v[232:235], v255, s[8:11], 0 offen sc1
    s_waitcnt vmcnt(9)
    s_cmp_eq_u32 s53, 1
    s_cbranch_scc1 L_have0
L_poll0:
    v_or_b32 v15, v15, v4
    v_cmp_gt_u32 vcc, 2, v15
    s_nop 1
    s_cbranch_vccz L_poll0_ok
    s_cmp_eq_u32 s7, 0
    s_cbranch_scc1 L_poll0_ok
    s_sub_u32 s7, s7, 1
    buffer_load_dword v15, v14, s[8:11], 0 offen sc1
    s_waitcnt vmcnt(0)
    s_branch L_poll0
L_poll0_ok:
    s_cmp_gt_u32 s7, 199995
    s_cbranch_scc1 L_poll0_go
    buffer_store_dwordx4 v[232:235], v255, s[8:11], 0 offen sc1
L_poll0_go:
    v_readlane_b32 s6, v7, 0
    s_nop 4
    buffer_load_dwordx4 a[0:3], v1, s[12:15], s6 offen sc1
    buffer_load_dwordx4 a[4:7], v2, s[12:15], s6 offen sc1
    v_readlane_b32 s6, v7, 1
    s_nop 4
    buffer_load_dwordx4 a[8:11], v1, s[12:15], s6 offen sc1
    buffer_load_dwordx4 a[12:15], v2, s[12:15], s6 offen sc1
    v_readlane_b32 s6, v7, 2
    s_nop 4
    buffer_load_dwordx4 a[16:19], v1, s[12:15], s6 offen sc1
    buffer_load_dwordx4 a[20:23], v2, s[12:15], s6 offen sc1
    v_readlane_b32 s6, v7, 3
    s_nop 4
    buffer_load_dwordx4 a[24:27], v1, s[12:15], s6 offen sc1
    buffer_load_dwordx4 a[28:31], v2, s[12:15], s6 offen sc1
L_have0:
    v_or_b32 v15, v15, v4
    v_cmp_gt_u32 vcc, 4, v15
    s_nop 0
    s_nop 0
    s_cmp_eq_u64 vcc, 0
    s_cselect_b32 s55, 1, 0
    buffer_load_dword v15, v14, s[8:11], 0 offen sc1
    v_readlane_b32 s6, v7, 4
    s_nop 1
    s_cmp_eq_u32 s55, 1
    s_cselect_b32 s6, s6, 0x40000000
    buffer_load_dwordx4 a[32:35], v1, s[12:15], s6 offen sc1
    buffer_load_dwordx4 a[36:39], v2, s[12:15], s6 offen sc1
    v_readlane_b32 s6, v7, 5
    s_nop 1
    s_cmp_eq_u32 s55, 1
    s_cselect_b32 s6, s6, 0x40000000
    buffer_load_dwordx4 a[40:43], v1, s[12:15], s6 offen sc1
    buffer_load_dwordx4 a[44:47], v2, s[12:15], s6 offen sc1
    v_readlane_b32 s6, v7, 6
    s_nop 1
    s_cmp_eq_u32 s55, 1
    s_cselect_b32 s6, s6, 0x40000000
    buffer_load_dwordx4 a[48:51], v1, s[12:15], s6 offen sc1
    buffer_load_dwordx4 a[52:55], v2, s[12:15], s6 offen sc1
    v_readlane_b32 s6, v7, 7
    s_nop 1
    s_cmp_eq_u32 s55, 1
    s_cselect_b32 s6, s6, 0x40000000
    buffer_load_dwordx4 a[56:59], v1, s[12:15], s6 offen sc1
    buffer_load_dwordx4 a[60:63], v2, s[12:15], s6 offen sc1
    v_readlane_b32 s6, v7, 8
    s_nop 1
    s_cmp_eq_u32 s55, 1
    s_cselect_b32 s6, s6, 0x40000000
    buffer_load_dwordx4 a[64:67], v1, s[12:15], s6 offen sc1
    buffer_load_dwordx4 a[68:71], v2, s[12:15], s6 offen sc1
    s_waitcnt vmcnt(11)
    v_mfma_f32_16x16x32_bf16 v[192:195], a[244:247], a[0:3], 0
    v_mfma_f32_16x16x32_bf16 v[192:195], a[244:247], a[4:7], v[192:195]
    s_waitcnt vmcnt(11)
    v_mfma_f32_16x16x32_bf16 v[196:199], a[244:247], a[8:11], 0
    v_mfma_f32_16x16x32_bf16 v[196:199], a[244:247], a[12:15], v[196:199]
    s_waitcnt vmcnt(11)
    v_mfma_f32_16x16x32_bf16 v[200:203], a[244:247], a[16:19], 0
    v_mfma_f32_16x16x32_bf16 v[200:203], a[244:247], a[20:23], v[200:203]
    s_waitcnt vmcnt(11)
    v_mfma_f32_16x16x32_bf16 v[204:207], a[244:247], a[24:27], 0
    v_mfma_f32_16x16x32_bf16 v[204:207], a[244:247], a[28:31], v[204:207]
    v_cvt_pk_bf16_f32 v192, v192, v193
    v_cvt_pk_bf16_f32 v193, v194, v195
    v_cvt_pk_bf16_f32 v194, v196, v197
    v_cvt_pk_bf16_f32 v195, v198, v199
    buffer_store_dwordx4 v[192:195], v176, s[16:19], 0 offen
    v_cvt_pk_bf16_f32 v200, v200, v201
    v_cvt_pk_bf16_f32 v201, v202, v203
    s_nop 0
    v_cvt_pk_bf16_f32 v202, v204, v205
    v_cvt_pk_bf16_f32 v203, v206, v207
    buffer_store_dwordx4 v[200:203], v178, s[16:19], 0 offen
    s_waitcnt vmcnt(12)
    s_cmp_eq_u32 s55, 1
    s_cbranch_scc1 L_have1
L_poll1:
    v_or_b32 v15, v15, v4
    v_cmp_gt_u32 vcc, 4, v15
    s_nop 1
    s_cbranch_vccz L_poll1_ok
    s_cmp_eq_u32 s7, 0
    s_cbranch_scc1 L_poll1_ok
    s_sub_u32 s7, s7, 1
    buffer_load_dword v15, v14, s[8:11], 0 offen sc1
    s_waitcnt vmcnt(0)
    s_branch L_poll1
L_poll1_ok:
    s_cmp_gt_u32 s7, 199995
    s_cbranch_scc1 L_poll1_go
    buffer_store_dwordx4 v[232:235], v255, s[8:11], 0 offen sc1
L_poll1_go:
    v_readlane_b32 s6, v7, 4
    s_nop 4
    buffer_load_dwordx4 a[32:35], v1, s[12:15], s6 offen sc1
    buffer_load_dwordx4 a[36:39], v2, s[12:15], s6 offen sc1
    v_readlane_b32 s6, v7, 5
    s_nop 4
    buffer_load_dwordx4 a[40:43], v1, s[12:15], s6 offen sc1
    buffer_load_dwordx4 a[44:47], v2, s[12:15], s6 offen sc1
    v_readlane_b32 s6, v7, 6
    s_nop 4
    buffer_load_dwordx4 a[48:51], v1, s[12:15], s6 offen sc1
    buffer_load_dwordx4 a[52:55], v2, s[12:15], s6 offen sc1
    v_readlane_b32 s6, v7, 7
    s_nop 4
    buffer_load_dwordx4 a[56:59], v1, s[12:15], s6 offen sc1
    buffer_load_dwordx4 a[60:63], v2, s[12:15], s6 offen sc1
    v_readlane_b32 s6, v7, 8
    s_nop 4
    buffer_load_dwordx4 a[64:67], v1, s[12:15], s6 offen sc1
    buffer_load_dwordx4 a[68:71], v2, s[12:15], s6 offen sc1
L_have1:
    s_waitcnt vmcnt(0)
    v_mfma_f32_16x16x32_bf16 v[208:211], a[244:247], a[32:35], 0
    v_mfma_f32_16x16x32_bf16 v[208:211], a[244:247], a[36:39], v[208:211]
    s_waitcnt vmcnt(0)
    v_mfma_f32_16x16x32_bf16 v[212:215], a[244:247], a[40:43], 0
    v_mfma_f32_16x16x32_bf16 v[212:215], a[244:247], a[44:47], v[212:215]
    s_waitcnt vmcnt(0)
    v_mfma_f32_16x16x32_bf16 v[216:219], a[244:247], a[48:51], 0
    v_mfma_f32_16x16x32_bf16 v[216:219], a[244:247], a[52:55], v[216:219]
    s_waitcnt vmcnt(0)
    v_mfma_f32_16x16x32_bf16 v[220:223], a[244:247], a[56:59], 0
    v_mfma_f32_16x16x32_bf16 v[220:223], a[244:247], a[60:63], v[220:223]
    s_waitcnt vmcnt(0)
    v_mfma_f32_16x16x32_bf16 v[192:195], a[244:247], a[64:67], 0
    v_mfma_f32_16x16x32_bf16 v[192:195], a[244:247], a[68:71], v[192:195]
    v_cvt_pk_bf16_f32 v208, v208, v209
    v_cvt_pk_bf16_f32 v209, v210, v211
    v_cvt_pk_bf16_f32 v210, v212, v213
    v_cvt_pk_bf16_f32 v211, v214, v215
    buffer_store_dwordx4 v[208:211], v180, s[16:19], 0 offen
    v_cvt_pk_bf16_f32 v216, v216, v217
    v_cvt_pk_bf16_f32 v217, v218, v219
    v_cvt_pk_bf16_f32 v218, v220, v221
    v_cvt_pk_bf16_f32 v219, v222, v223
    buffer_store_dwordx4 v[216:219], v182, s[16:19], 0 offen
    v_cvt_pk_bf16_f32 v192, v192, v193
    v_cvt_pk_bf16_f32 v193, v194, v195
    buffer_store_dwordx2 v[192:193], v184, s[16:19], 0 offen
    s_endpgm
L_redo:
    s_waitcnt vmcnt(0) lgkmcnt(0)
    s_nop 15
    s_barrier
    s_mov_b32 s5, 1
    v_mov_b32 v229, s48
    v_lshrrev_b32 v230, 3, v0
    v_mul_u32_u24 v232, 40, v229
    v_add_u32 v232, v232, v230
    v_mul_u32_u24 v232, 896, v232
    v_and_b32 v231, 1, v229
    v_lshlrev_b32 v231, 2, v231
    v_lshrrev_b32 v233, 4, v0
    v_add_u32 v231, v231, v233
    v_xor_b32 v231, v231, v0
    v_and_b32 v231, 7, v231
    v_lshl_add_u32 v224, v231, 4, v232
    v_xor_b32 v231, 4, v231
    v_lshl_add_u32 v225, v231, 4, v232
    v_add_u32 v226, 12288, v224
    v_add_u32 v227, 18432, v225
    v_add_u32 v228, 28672, v224
    v_add_u32 v225, 6144, v225
    v_add_u32 v28, 0, v1
    v_add_u32 v29, 7160, v1
    v_add_u32 v30, 14272, v1
    v_add_u32 v31, 21432, v1
    s_bitcmp1_b32 s56, 0
    s_cselect_b32 s54, 1, 0
    s_lshl_b32 s53, s54, 19
    s_lshl_b32 s54, s54, 7
    s_add_u32 m0, s50, 101376
    s_nop 0
    buffer_load_dwordx4 v224, s[24:27], s54 offen offset:0  lds
    buffer_load_dwordx4 v225, s[24:27], s54 offen offset:1024  lds
    buffer_load_dwordx4 v226, s[24:27], s54 offen offset:2048  lds
    buffer_load_dwordx4 v227, s[24:27], s54 offen offset:3072  lds
    s_add_u32 m0, s50, 105472
    s_nop 0
    buffer_load_dwordx4 v228, s[24:27], s54 offen  lds
    s_add_u32 m0, s49, 0
    s_nop 0
    buffer_load_dwordx4 v28, s[28:31], s53 offen offset:0  lds
    buffer_load_dwordx4 v29, s[28:31], s53 offen offset:1032  lds
    buffer_load_dwordx4 v30, s[28:31], s53 offen offset:2112  lds
    buffer_load_dwordx4 v31, s[28:31], s53 offen offset:3144  lds
    s_add_u32 s51, s53, 65536
    s_add_u32 m0, s49, 4224
    s_nop 0
    buffer_load_dwordx4 v28, s[28:31], s51 offen offset:0  lds
    buffer_load_dwordx4 v29, s[28:31], s51 offen offset:1032  lds
    buffer_load_dwordx4 v30, s[28:31], s51 offen offset:2112  lds
    buffer_load_dwordx4 v31, s[28:31], s51 offen offset:3144  lds
    s_waitcnt vmcnt(0)
    s_branch L_restart
L_clsB:
    s_nop 7
    v_mfma_f32_16x16x32_bf16 v[32:35], v[192:195], a[100:103], v[32:35]
    buffer_load_dwordx4 v30, s[40:43], s56 offen offset:2112  lds
    v_mfma_f32_16x16x32_bf16 v[40:43], v[192:195], a[104:107], v[40:43]
    ds_read_b128 a[120:123], v16 offset:25600
    v_mfma_f32_16x16x32_bf16 v[48:51], v[192:195], a[108:111], v[48:51]
    ds_read_b128 a[124:127], v16 offset:26624
    v_mfma_f32_16x16x32_bf16 v[56:59], v[192:195], a[112:115], v[56:59]
    ds_read_b128 a[128:131], v16 offset:27648
    v_mfma_f32_16x16x32_bf16 v[64:67], v[192:195], a[116:119], v[64:67]
    ds_read_b128 a[132:135], v16 offset:28672
    v_mfma_f32_16x16x32_bf16 v[36:39], v[196:199], a[100:103], v[36:39]
    ds_read_b128 a[136:139], v16 offset:29696
    v_lshlrev_b32 v236, 2, v0
    v_mfma_f32_16x16x32_bf16 v[44:47], v[196:199], a[104:107], v[44:47]
    ds_read_b64_tr_b16 v[210:211], v12 offset:25344
    v_mfma_f32_16x16x32_bf16 v[52:55], v[196:199], a[108:111], v[52:55]
    ds_read_b64_tr_b16 v[212:213], v12 offset:16928
    v_mfma_f32_16x16x32_bf16 v[60:63], v[196:199], a[112:115], v[60:63]
    ds_read_b64_tr_b16 v[214:215], v12 offset:25376
    v_mfma_f32_16x16x32_bf16 v[68:71], v[196:199], a[116:119], v[68:71]
    s_waitcnt lgkmcnt(9)
    ds_read_b64_tr_b16 v[216:217], v12 offset:16960
    v_mfma_f32_16x16x32_bf16 v[72:75], v[200:203], a[100:103], v[72:75]
    buffer_load_dwordx4 v31, s[40:43], s56 offen offset:3168  lds
    v_mfma_f32_16x16x32_bf16 v[80:83], v[200:203], a[104:107], v[80:83]
    s_add_u32 s51, s56, 3584
    s_add_u32 m0, s49, 4224
    v_mfma_f32_16x16x32_bf16 v[88:91], v[200:203], a[108:111], v[88:91]
    buffer_load_dwordx4 v28, s[40:43], s51 offen offset:0  lds
    v_mfma_f32_16x16x32_bf16 v[96:99], v[200:203], a[112:115], v[96:99]
    ds_read_b64_tr_b16 v[218:219], v12 offset:25408
    v_mfma_f32_16x16x32_bf16 v[104:107], v[200:203], a[116:119], v[104:107]
    ds_read_b64_tr_b16 v[220:221], v12 offset:16992
    v_mfma_f32_16x16x32_bf16 v[76:79], v[204:207], a[100:103], v[76:79]
    ds_read_b64_tr_b16 v[222:223], v12 offset:25440
    v_mfma_f32_16x16x32_bf16 v[84:87], v[204:207], a[104:107], v[84:87]
    buffer_load_dwordx4 v29, s[40:43], s51 offen offset:1056  lds
    v_mfma_f32_16x16x32_bf16 v[92:95], v[204:207], a[108:111], v[92:95]
    ds_read_b64_tr_b16 v[192:193], v12 offset:128
    v_mfma_f32_16x16x32_bf16 v[100:103], v[204:207], a[112:115], v[100:103]
    ds_read_b64_tr_b16 v[194:195], v12 offset:8576
    v_mfma_f32_16x16x32_bf16 v[108:111], v[204:207], a[116:119], v[108:111]
    s_waitcnt lgkmcnt(6)
    ds_read_b64_tr_b16 v[196:197], v12 offset:160
    v_mfma_f32_16x16x32_bf16 v[32:35], v[208:211], a[120:123], v[32:35]
    ds_read_b64_tr_b16 v[198:199], v12 offset:8608
    v_mfma_f32_16x16x32_bf16 v[40:43], v[208:211], a[124:127], v[40:43]
    buffer_load_dwordx4 v30, s[40:43], s51 offen offset:2112  lds
    v_mfma_f32_16x16x32_bf16 v[48:51], v[208:211], a[128:131], v[48:51]
    buffer_store_dwordx4 v[246:249], v18, s[96:99], s4 offen sc1
    v_mfma_f32_16x16x32_bf16 v[56:59], v[208:211], a[132:135], v[56:59]
    buffer_store_dword v245, v236, s[96:99], s4 offen offset:1024 sc1
    v_mfma_f32_16x16x32_bf16 v[64:67], v[208:211], a[136:139], v[64:67]
    ds_read_b64_tr_b16 v[200:201], v12 offset:17024
    s_add_u32 s58, s52, 0
    v_mfma_f32_16x16x32_bf16 v[36:39], v[212:215], a[120:123], v[36:39]
    ds_read_b64_tr_b16 v[202:203], v12 offset:25472
    s_add_u32 s59, s52, 4096
    v_mfma_f32_16x16x32_bf16 v[44:47], v[212:215], a[124:127], v[44:47]
    ds_read_b64_tr_b16 v[204:205], v12 offset:17056
    v_mfma_f32_16x16x32_bf16 v[52:55], v[212:215], a[128:131], v[52:55]
    buffer_load_dwordx4 v31, s[40:43], s51 offen offset:3168  lds
    v_mfma_f32_16x16x32_bf16 v[60:63], v[212:215], a[132:135], v[60:63]
    ds_read_b64_tr_b16 v[206:207], v12 offset:25504
    v_mfma_f32_16x16x32_bf16 v[68:71], v[212:215], a[136:139], v[68:71]
    s_waitcnt lgkmcnt(8)
    v_cvt_pk_bf16_f32 v32, v32, v33
    v_cvt_pk_bf16_f32 v33, v34, v35
    v_mfma_f32_16x16x32_bf16 v[72:75], v[216:219], a[120:123], v[72:75]
    ds_read_b64_tr_b16 v[208:209], v12 offset:192
    v_cvt_pk_bf16_f32 v34, v36, v37
    v_mfma_f32_16x16x32_bf16 v[80:83], v[216:219], a[124:127], v[80:83]
    ds_read_b64_tr_b16 v[210:211], v12 offset:8640
    v_cvt_pk_bf16_f32 v35, v38, v39
    v_mfma_f32_16x16x32_bf16 v[88:91], v[216:219], a[128:131], v[88:91]
    ds_read_b64_tr_b16 v[212:213], v12 offset:224
    v_cvt_pk_bf16_f32 v40, v40, v41
    v_mfma_f32_16x16x32_bf16 v[96:99], v[216:219], a[132:135], v[96:99]
    ds_read_b64_tr_b16 v[214:215], v12 offset:8672
    v_cvt_pk_bf16_f32 v41, v42, v43
    v_mfma_f32_16x16x32_bf16 v[104:107], v[216:219], a[136:139], v[104:107]
    buffer_store_dwordx4 v[32:35], v18, s[96:99], s58 offen offset:0 sc1
    v_mfma_f32_16x16x32_bf16 v[76:79], v[220:223], a[120:123], v[76:79]
    ds_read_b64_tr_b16 v[216:217], v12 offset:17088
    v_cvt_pk_bf16_f32 v42, v44, v45
    v_mfma_f32_16x16x32_bf16 v[84:87], v[220:223], a[124:127], v[84:87]
    ds_read_b64_tr_b16 v[218:219], v12 offset:25536
    v_cvt_pk_bf16_f32 v43, v46, v47
    v_mfma_f32_16x16x32_bf16 v[92:95], v[220:223], a[128:131], v[92:95]
    buffer_store_dwordx4 v[40:43], v18, s[96:99], s58 offen offset:1024 sc1
    v_mfma_f32_16x16x32_bf16 v[100:103], v[220:223], a[132:135], v[100:103]
    v_cvt_pk_bf16_f32 v48, v48, v49
    v_cvt_pk_bf16_f32 v49, v50, v51
    v_mfma_f32_16x16x32_bf16 v[108:111], v[220:223], a[136:139], v[108:111]
    s_waitcnt lgkmcnt(10)
    v_cvt_pk_bf16_f32 v50, v52, v53
    v_cvt_pk_bf16_f32 v51, v54, v55
    v_cvt_pk_bf16_f32 v56, v56, v57
    v_mfma_f32_16x16x32_bf16 v[112:115], v[192:195], a[100:103], v[112:115]
    ds_read_b64_tr_b16 v[220:221], v12 offset:17120
    v_cvt_pk_bf16_f32 v57, v58, v59
    v_cvt_pk_bf16_f32 v58, v60, v61
    v_mfma_f32_16x16x32_bf16 v[120:123], v[192:195], a[104:107], v[120:123]
    ds_read_b64_tr_b16 v[222:223], v12 offset:25568
    v_cvt_pk_bf16_f32 v59, v62, v63
    v_cvt_pk_bf16_f32 v64, v64, v65
    v_mfma_f32_16x16x32_bf16 v[128:131], v[192:195], a[108:111], v[128:131]
    buffer_store_dwordx4 v[48:51], v18, s[96:99], s58 offen offset:2048 sc1
    v_mfma_f32_16x16x32_bf16 v[136:139], v[192:195], a[112:115], v[136:139]
    buffer_store_dwordx4 v[56:59], v18, s[96:99], s58 offen offset:3072 sc1
    v_cvt_pk_bf16_f32 v65, v66, v67
    v_cvt_pk_bf16_f32 v66, v68, v69
    v_cvt_pk_bf16_f32 v67, v70, v71
    v_cvt_pk_bf16_f32 v72, v72, v73
    v_cvt_pk_bf16_f32 v73, v74, v75
    v_cvt_pk_bf16_f32 v74, v76, v77
    v_cvt_pk_bf16_f32 v75, v78, v79
    v_mfma_f32_16x16x32_bf16 v[144:147], v[192:195], a[116:119], v[144:147]
    v_cvt_pk_bf16_f32 v80, v80, v81
    v_cvt_pk_bf16_f32 v81, v82, v83
    v_mfma_f32_16x16x32_bf16 v[116:119], v[196:199], a[100:103], v[116:119]
    v_cvt_pk_bf16_f32 v82, v84, v85
    v_cvt_pk_bf16_f32 v83, v86, v87
    v_mfma_f32_16x16x32_bf16 v[124:127], v[196:199], a[104:107], v[124:127]
    buffer_store_dwordx4 v[64:67], v18, s[96:99], s59 offen sc1
    v_mfma_f32_16x16x32_bf16 v[132:135], v[196:199], a[108:111], v[132:135]
    s_add_u32 s58, s52, 10240
    v_cvt_pk_bf16_f32 v88, v88, v89
    v_cvt_pk_bf16_f32 v89, v90, v91
    v_mfma_f32_16x16x32_bf16 v[140:143], v[196:199], a[112:115], v[140:143]
    s_add_u32 s59, s52, 14336
    v_cvt_pk_bf16_f32 v90, v92, v93
    v_cvt_pk_bf16_f32 v91, v94, v95
    v_mfma_f32_16x16x32_bf16 v[148:151], v[196:199], a[116:119], v[148:151]
    s_waitcnt lgkmcnt(8)
    v_cvt_pk_bf16_f32 v96, v96, v97
    v_cvt_pk_bf16_f32 v97, v98, v99
    v_mfma_f32_16x16x32_bf16 v[112:115], v[200:203], a[120:123], v[112:115]
    buffer_store_dwordx4 v[72:75], v18, s[96:99], s58 offen offset:0 sc1
    v_mfma_f32_16x16x32_bf16 v[120:123], v[200:203], a[124:127], v[120:123]
    buffer_store_dwordx4 v[80:83], v18, s[96:99], s58 offen offset:1024 sc1
    v_mfma_f32_16x16x32_bf16 v[128:131], v[200:203], a[128:131], v[128:131]
    buffer_store_dwordx4 v[88:91], v18, s[96:99], s58 offen offset:2048 sc1
    v_cvt_pk_bf16_f32 v98, v100, v101
    v_cvt_pk_bf16_f32 v99, v102, v103
    v_mfma_f32_16x16x32_bf16 v[136:139], v[200:203], a[132:135], v[136:139]
    v_cvt_pk_bf16_f32 v104, v104, v105
    v_cvt_pk_bf16_f32 v105, v106, v107
    v_mfma_f32_16x16x32_bf16 v[144:147], v[200:203], a[136:139], v[144:147]
    buffer_store_dwordx4 v[96:99], v18, s[96:99], s58 offen offset:3072 sc1
    v_mfma_f32_16x16x32_bf16 v[116:119], v[204:207], a[120:123], v[116:119]
    v_cvt_pk_bf16_f32 v106, v108, v109
    v_cvt_pk_bf16_f32 v107, v110, v111
    v_mfma_f32_16x16x32_bf16 v[124:127], v[204:207], a[124:127], v[124:127]
    buffer_store_dwordx4 v[104:107], v18, s[96:99], s59 offen sc1
    v_mfma_f32_16x16x32_bf16 v[132:135], v[204:207], a[128:131], v[132:135]
    s_add_u32 s58, s52, 20480
    s_add_u32 s59, s52, 24576
    v_mfma_f32_16x16x32_bf16 v[140:143], v[204:207], a[132:135], v[140:143]
    v_mfma_f32_16x16x32_bf16 v[148:151], v[204:207], a[136:139], v[148:151]
    s_waitcnt lgkmcnt(4)
    v_cvt_pk_bf16_f32 v112, v112, v113
    v_cvt_pk_bf16_f32 v113, v114, v115
    v_mfma_f32_16x16x32_bf16 v[152:155], v[208:211], a[100:103], v[152:155]
    v_cvt_pk_bf16_f32 v114, v116, v117
    v_cvt_pk_bf16_f32 v115, v118, v119
    v_mfma_f32_16x16x32_bf16 v[160:163], v[208:211], a[104:107], v[160:163]
    v_cvt_pk_bf16_f32 v120, v120, v121
    v_cvt_pk_bf16_f32 v121, v122, v123
    v_mfma_f32_16x16x32_bf16 v[168:171], v[208:211], a[108:111], v[168:171]
    v_cvt_pk_bf16_f32 v122, v124, v125
    v_cvt_pk_bf16_f32 v123, v126, v127
    v_mfma_f32_16x16x32_bf16 v[176:179], v[208:211], a[112:115], v[176:179]
    v_cvt_pk_bf16_f32 v128, v128, v129
    v_cvt_pk_bf16_f32 v129, v130, v131
    v_mfma_f32_16x16x32_bf16 v[184:187], v[208:211], a[116:119], v[184:187]
    buffer_store_dwordx4 v[112:115], v18, s[96:99], s58 offen offset:0 sc1
    s_waitcnt vmcnt(21) lgkmcnt(0)
    s_barrier
    v_mfma_f32_16x16x32_bf16 v[156:159], v[212:215], a[100:103], v[156:159]
    s_lshl_b32 s56, s55, 7
    v_cvt_pk_bf16_f32 v130, v132, v133
    v_cvt_pk_bf16_f32 v131, v134, v135
    v_add_u32 v12, 67584, v10
    v_mfma_f32_16x16x32_bf16 v[164:167], v[212:215], a[104:107], v[164:167]
    ds_read_b64_tr_b16 v[192:193], v12 offset:0
    v_cvt_pk_bf16_f32 v136, v136, v137
    v_cvt_pk_bf16_f32 v137, v138, v139
    v_mfma_f32_16x16x32_bf16 v[172:175], v[212:215], a[108:111], v[172:175]
    ds_read_b64_tr_b16 v[194:195], v12 offset:256
    v_cvt_pk_bf16_f32 v138, v140, v141
    v_cvt_pk_bf16_f32 v139, v142, v143
    v_mfma_f32_16x16x32_bf16 v[180:183], v[212:215], a[112:115], v[180:183]
    ds_read_b64_tr_b16 v[196:197], v12 offset:16896
    v_cvt_pk_bf16_f32 v144, v144, v145
    v_cvt_pk_bf16_f32 v145, v146, v147
    v_cvt_pk_bf16_f32 v146, v148, v149
    v_mfma_f32_16x16x32_bf16 v[188:191], v[212:215], a[116:119], v[188:191]
    ds_read_b64_tr_b16 v[198:199], v12 offset:17152
    v_cvt_pk_bf16_f32 v147, v150, v151
    v_mfma_f32_16x16x32_bf16 v[152:155], v[216:219], a[120:123], v[152:155]
    s_add_u32 s56, s56, s1
    s_add_u32 s55, s55, 1
    s_cmp_eq_u32 s55, 7
    s_cselect_b32 s55, 0, s55
    v_mfma_f32_16x16x32_bf16 v[160:163], v[216:219], a[124:127], v[160:163]
    s_add_u32 m0, s49, 33792
    s_nop 0
    buffer_load_dwordx4 v28, s[40:43], s56 offen offset:0  lds
    v_mfma_f32_16x16x32_bf16 v[168:171], v[216:219], a[128:131], v[168:171]
    buffer_load_dwordx4 v29, s[40:43], s56 offen offset:1056  lds
    ds_read_b128 a[160:163], v5 offset:0
    v_mfma_f32_16x16x32_bf16 v[176:179], v[216:219], a[132:135], v[176:179]
    ds_read_b128 a[164:167], v5 offset:1024
    ds_read_b128 a[168:171], v5 offset:2048
    v_mfma_f32_16x16x32_bf16 v[184:187], v[216:219], a[136:139], v[184:187]
    ds_read_b128 a[172:175], v5 offset:3072
    ds_read_b128 a[176:179], v5 offset:4096
    ds_read_b128 a[180:183], v5 offset:5120
    v_mfma_f32_16x16x32_bf16 v[156:159], v[220:223], a[120:123], v[156:159]
    ds_read_b128 a[184:187], v5 offset:6144
    ds_read_b128 a[188:191], v5 offset:7168
    v_mfma_f32_16x16x32_bf16 v[164:167], v[220:223], a[124:127], v[164:167]
    ds_read_b128 a[192:195], v5 offset:8192
    ds_read_b128 a[196:199], v5 offset:9216
    v_mfma_f32_16x16x32_bf16 v[172:175], v[220:223], a[128:131], v[172:175]
    ds_read_b64_tr_b16 v[200:201], v12 offset:512
    ds_read_b64_tr_b16 v[202:203], v12 offset:768
    v_mfma_f32_16x16x32_bf16 v[180:183], v[220:223], a[132:135], v[180:183]
    ds_read_b64_tr_b16 v[204:205], v12 offset:17408
    ds_read_b64_tr_b16 v[206:207], v12 offset:17664
    buffer_load_dwordx4 v30, s[40:43], s56 offen offset:2112  lds
    v_mfma_f32_16x16x32_bf16 v[188:191], v[220:223], a[136:139], v[188:191]
    s_waitcnt lgkmcnt(4)
    v_cvt_pk_bf16_f32 v152, v152, v153
    v_cvt_pk_bf16_f32 v153, v154, v155
    v_cvt_pk_bf16_f32 v154, v156, v157
    v_cvt_pk_bf16_f32 v155, v158, v159
    v_mfma_f32_16x16x32_bf16 v[36:39], v[192:195], a[160:163], 0
    buffer_load_dwordx4 v31, s[40:43], s56 offen offset:3168  lds
    v_cvt_pk_bf16_f32 v160, v160, v161
    v_cvt_pk_bf16_f32 v161, v162, v163
    v_cvt_pk_bf16_f32 v162, v164, v165
    v_cvt_pk_bf16_f32 v163, v166, v167
    v_mfma_f32_16x16x32_bf16 v[44:47], v[192:195], a[164:167], 0
    s_add_u32 s51, s56, 3584
    v_cvt_pk_bf16_f32 v168, v168, v169
    v_cvt_pk_bf16_f32 v169, v170, v171
    v_cvt_pk_bf16_f32 v170, v172, v173
    v_cvt_pk_bf16_f32 v171, v174, v175
    s_add_u32 m0, s49, 38016
    v_mfma_f32_16x16x32_bf16 v[52:55], v[192:195], a[168:171], 0
    buffer_load_dwordx4 v28, s[40:43], s51 offen offset:0  lds
    v_cvt_pk_bf16_f32 v176, v176, v177
    v_cvt_pk_bf16_f32 v177, v178, v179
    v_cvt_pk_bf16_f32 v178, v180, v181
    v_mfma_f32_16x16x32_bf16 v[60:63], v[192:195], a[172:175], 0
    ds_read_b128 a[200:203], v5 offset:10240
    v_cvt_pk_bf16_f32 v179, v182, v183
    v_cvt_pk_bf16_f32 v184, v184, v185
    v_cvt_pk_bf16_f32 v185, v186, v187
    v_cvt_pk_bf16_f32 v186, v188, v189
    v_cvt_pk_bf16_f32 v187, v190, v191
    v_mfma_f32_16x16x32_bf16 v[68:71], v[192:195], a[176:179], 0
    ds_read_b128 a[204:207], v5 offset:11264
    ds_read_b128 a[208:211], v5 offset:12288
    ds_read_b128 a[212:215], v5 offset:13312
    v_mfma_f32_16x16x32_bf16 v[36:39], v[196:199], a[180:183], v[36:39]
    ds_read_b128 a[216:219], v5 offset:14336
    ds_read_b128 a[220:223], v5 offset:15360
    ds_read_b128 a[224:227], v5 offset:16384
    ds_read_b128 a[228:231], v5 offset:17408
    v_mfma_f32_16x16x32_bf16 v[44:47], v[196:199], a[184:187], v[44:47]
    ds_read_b128 a[232:235], v5 offset:18432
    ds_read_b128 a[236:239], v5 offset:19456
    ds_read_b64_tr_b16 v[208:209], v12 offset:8448
    v_mfma_f32_16x16x32_bf16 v[52:55], v[196:199], a[188:191], v[52:55]
    buffer_load_dwordx4 v29, s[40:43], s51 offen offset:1056  lds
    ds_read_b64_tr_b16 v[210:211], v12 offset:8704
    ds_read_b64_tr_b16 v[212:213], v12 offset:25344
    v_mfma_f32_16x16x32_bf16 v[60:63], v[196:199], a[192:195], v[60:63]
    buffer_store_dwordx4 v[120:123], v18, s[96:99], s58 offen offset:1024 sc1
    buffer_store_dwordx4 v[128:131], v18, s[96:99], s58 offen offset:2048 sc1
    buffer_store_dwordx4 v[136:139], v18, s[96:99], s58 offen offset:3072 sc1
    buffer_store_dwordx4 v[144:147], v18, s[96:99], s59 offen sc1
    v_mfma_f32_16x16x32_bf16 v[68:71], v[196:199], a[196:199], v[68:71]
    ds_read_b64_tr_b16 v[214:215], v12 offset:25600
    ds_read_b64_tr_b16 v[216:217], v12 offset:8960
    s_barrier
    s_waitcnt lgkmcnt(5)
    v_mfma_f32_16x16x32_bf16 v[36:39], v[200:203], a[200:203], v[36:39]
    buffer_load_dwordx4 v30, s[40:43], s51 offen offset:2112  lds
    ds_read_b64_tr_b16 v[218:219], v12 offset:9216
    s_add_u32 s58, s52, 30720
    v_mfma_f32_16x16x32_bf16 v[44:47], v[200:203], a[204:207], v[44:47]
    ds_read_b64_tr_b16 v[220:221], v12 offset:25856
    ds_read_b64_tr_b16 v[222:223], v12 offset:26112
    ds_read_b128 a[0:3], v5 offset:40960
    v_mfma_f32_16x16x32_bf16 v[52:55], v[200:203], a[208:211], v[52:55]
    buffer_load_dwordx4 v31, s[40:43], s51 offen offset:3168  lds
    ds_read_b128 a[4:7], v5 offset:41984
    v_mfma_f32_16x16x32_bf16 v[60:63], v[200:203], a[212:215], v[60:63]
    ds_read_b128 a[8:11], v5 offset:43008
    ds_read_b128 a[12:15], v5 offset:44032
    s_add_u32 s59, s52, 34816
    v_mfma_f32_16x16x32_bf16 v[68:71], v[200:203], a[216:219], v[68:71]
    ds_read_b128 a[16:19], v5 offset:45056
    ds_read_b128 a[20:23], v5 offset:46080
    ds_read_b128 a[24:27], v5 offset:47104
    v_mfma_f32_16x16x32_bf16 v[36:39], v[204:207], a[220:223], v[36:39]
    ds_read_b128 a[28:31], v5 offset:48128
    ds_read_b128 a[32:35], v5 offset:49152
    v_mfma_f32_16x16x32_bf16 v[44:47], v[204:207], a[224:227], v[44:47]
    ds_read_b128 a[36:39], v5 offset:50176
    v_mfma_f32_16x16x32_bf16 v[52:55], v[204:207], a[228:231], v[52:55]
    buffer_store_dwordx4 v[152:155], v18, s[96:99], s58 offen offset:0 sc1
    v_mfma_f32_16x16x32_bf16 v[60:63], v[204:207], a[232:235], v[60:63]
    buffer_store_dwordx4 v[160:163], v18, s[96:99], s58 offen offset:1024 sc1
    buffer_store_dwordx4 v[168:171], v18, s[96:99], s58 offen offset:2048 sc1
    buffer_store_dwordx4 v[176:179], v18, s[96:99], s58 offen offset:3072 sc1
    buffer_store_dwordx4 v[184:187], v18, s[96:99], s59 offen sc1
    v_mfma_f32_16x16x32_bf16 v[68:71], v[204:207], a[236:239], v[68:71]
    s_waitcnt vmcnt(28) lgkmcnt(0)
    s_barrier
    v_mfma_f32_16x16x32_bf16 v[36:39], v[208:211], a[0:3], v[36:39]
    ds_read_b128 a[40:43], v5 offset:51200
    v_add_u32 v12, 0, v10
    s_lshl_b32 s56, s55, 7
    v_mfma_f32_16x16x32_bf16 v[44:47], v[208:211], a[4:7], v[44:47]
    ds_read_b128 a[44:47], v5 offset:52224
    ds_read_b128 a[48:51], v5 offset:53248
    v_mfma_f32_16x16x32_bf16 v[52:55], v[208:211], a[8:11], v[52:55]
    ds_read_b128 a[52:55], v5 offset:54272
    s_add_u32 s56, s56, s1
    v_mfma_f32_16x16x32_bf16 v[60:63], v[208:211], a[12:15], v[60:63]
    ds_read_b128 a[56:59], v5 offset:55296
    ds_read_b128 a[60:63], v5 offset:56320
    v_mfma_f32_16x16x32_bf16 v[68:71], v[208:211], a[16:19], v[68:71]
    ds_read_b128 a[64:67], v5 offset:57344
    ds_read_b128 a[68:71], v5 offset:58368
    v_mfma_f32_16x16x32_bf16 v[36:39], v[212:215], a[20:23], v[36:39]
    ds_read_b128 a[72:75], v5 offset:59392
    ds_read_b128 a[76:79], v5 offset:60416
    v_mfma_f32_16x16x32_bf16 v[44:47], v[212:215], a[24:27], v[44:47]
    s_add_u32 s55, s55, 1
    s_cmp_eq_u32 s55, 7
    s_cselect_b32 s55, 0, s55
    s_add_u32 m0, s49, 67584
    v_mfma_f32_16x16x32_bf16 v[52:55], v[212:215], a[28:31], v[52:55]
    buffer_load_dwordx4 v28, s[40:43], s56 offen offset:0  lds
    v_mfma_f32_16x16x32_bf16 v[60:63], v[212:215], a[32:35], v[60:63]
    ds_read_b64_tr_b16 v[192:193], v12 offset:0
    ds_read_b64_tr_b16 v[194:195], v12 offset:256
    v_mfma_f32_16x16x32_bf16 v[68:71], v[212:215], a[36:39], v[68:71]
    s_waitcnt lgkmcnt(2)
    ds_read_b64_tr_b16 v[196:197], v12 offset:16896
    ds_read_b64_tr_b16 v[198:199], v12 offset:17152
    v_mfma_f32_16x16x32_bf16 v[36:39], v[216:219], a[40:43], v[36:39]
    buffer_load_dwordx4 v29, s[40:43], s56 offen offset:1056  lds
    v_mfma_f32_16x16x32_bf16 v[44:47], v[216:219], a[44:47], v[44:47]
    buffer_load_dwordx4 v30, s[40:43], s56 offen offset:2112  lds
    v_mfma_f32_16x16x32_bf16 v[52:55], v[216:219], a[48:51], v[52:55]
    buffer_load_dwordx4 v31, s[40:43], s56 offen offset:3168  lds
    v_mfma_f32_16x16x32_bf16 v[60:63], v[216:219], a[52:55], v[60:63]
    ds_read_b64_tr_b16 v[200:201], v12 offset:512
    s_add_u32 s51, s56, 3584
    v_mfma_f32_16x16x32_bf16 v[68:71], v[216:219], a[56:59], v[68:71]
    ds_read_b64_tr_b16 v[202:203], v12 offset:768
    s_add_u32 m0, s49, 71808
    v_mfma_f32_16x16x32_bf16 v[36:39], v[220:223], a[60:63], v[36:39]
    ds_read_b64_tr_b16 v[204:205], v12 offset:17408
    v_mfma_f32_16x16x32_bf16 v[44:47], v[220:223], a[64:67], v[44:47]
    ds_read_b64_tr_b16 v[206:207], v12 offset:17664
    v_mfma_f32_16x16x32_bf16 v[52:55], v[220:223], a[68:71], v[52:55]
    buffer_load_dwordx4 v28, s[40:43], s51 offen offset:0  lds
    v_mfma_f32_16x16x32_bf16 v[60:63], v[220:223], a[72:75], v[60:63]
    buffer_load_dwordx4 v29, s[40:43], s51 offen offset:1056  lds
    v_mfma_f32_16x16x32_bf16 v[68:71], v[220:223], a[76:79], v[68:71]
    s_waitcnt lgkmcnt(4)
    ds_read_b64_tr_b16 v[208:209], v12 offset:8448
    v_mfma_f32_16x16x32_bf16 v[76:79], v[192:195], a[160:163], 0
    buffer_load_dwordx4 v30, s[40:43], s51 offen offset:2112  lds
    v_mfma_f32_16x16x32_bf16 v[84:87], v[192:195], a[164:167], 0
    s_mov_b32 s7, 200000
    ds_read_b64_tr_b16 v[210:211], v12 offset:8704
    v_mfma_f32_16x16x32_bf16 v[92:95], v[192:195], a[168:171], 0
    ds_read_b64_tr_b16 v[212:213], v12 offset:25344
    v_lshrrev_b32 v16, 4, v0
    v_mfma_f32_16x16x32_bf16 v[100:103], v[192:195], a[172:175], 0
    ds_read_b64_tr_b16 v[214:215], v12 offset:25600
    v_and_b32 v17, 15, v0
    v_mfma_f32_16x16x32_bf16 v[108:111], v[192:195], a[176:179], 0
    buffer_load_dwordx4 v31, s[40:43], s51 offen offset:3168  lds
    v_mfma_f32_16x16x32_bf16 v[76:79], v[196:199], a[180:183], v[76:79]
    ds_read_b64_tr_b16 v[216:217], v12 offset:8960
    s_lshl_b32 s6, s62, 10
    v_mfma_f32_16x16x32_bf16 v[84:87], v[196:199], a[184:187], v[84:87]
    ds_read_b64_tr_b16 v[218:219], v12 offset:9216
    v_and_b32 v21, 7, v0
    v_mfma_f32_16x16x32_bf16 v[92:95], v[196:199], a[188:191], v[92:95]
    ds_read_b64_tr_b16 v[220:221], v12 offset:25856
    v_lshl_add_u32 v14, v21, 7, s6
    v_mfma_f32_16x16x32_bf16 v[100:103], v[196:199], a[192:195], v[100:103]
    ds_read_b64_tr_b16 v[222:223], v12 offset:26112
    v_mul_u32_u24 v1, 73728, v16
    v_mfma_f32_16x16x32_bf16 v[108:111], v[196:199], a[196:199], v[108:111]
    s_waitcnt lgkmcnt(8)
    v_lshl_add_u32 v1, v17, 4, v1
    v_add_u32 v2, 294912, v1
    v_mfma_f32_16x16x32_bf16 v[76:79], v[200:203], a[200:203], v[76:79]
    s_mov_b32 s54, 0x10248040
    s_mov_b32 s53, 0x799611
    v_mfma_f32_16x16x32_bf16 v[84:87], v[200:203], a[204:207], v[84:87]
    s_cmp_ge_u32 s62, 4
    s_cselect_b32 s54, 0x122ca0c2, s54
    s_cselect_b32 s53, 0x7db693, s53
    v_mfma_f32_16x16x32_bf16 v[92:95], v[200:203], a[208:211], v[92:95]
    s_cmp_ge_u32 s62, 8
    s_cselect_b32 s54, 0x1434c144, s54
    s_cselect_b32 s53, 0x81d715, s53
    v_mfma_f32_16x16x32_bf16 v[100:103], v[200:203], a[212:215], v[100:103]
    s_cmp_ge_u32 s62, 12
    s_cselect_b32 s54, 0x163ce1c6, s54
    s_cselect_b32 s53, 0x863897, s53
    v_mfma_f32_16x16x32_bf16 v[108:111], v[200:203], a[216:219], v[108:111]
    v_cmp_lt_u32 vcc, 4, v0
    v_mov_b32 v21, s54
    v_mfma_f32_16x16x32_bf16 v[76:79], v[204:207], a[220:223], v[76:79]
    v_mov_b32 v22, s53
    v_cndmask_b32 v21, v21, v22, vcc
    v_mfma_f32_16x16x32_bf16 v[84:87], v[204:207], a[224:227], v[84:87]
    v_subrev_u32 v22, 5, v0
    v_min_u32 v22, v22, v0
    v_mfma_f32_16x16x32_bf16 v[92:95], v[204:207], a[228:231], v[92:95]
    v_mul_u32_u24 v22, 6, v22
    v_bfe_u32 v21, v21, v22, 6
    v_mfma_f32_16x16x32_bf16 v[100:103], v[204:207], a[232:235], v[100:103]
    v_mul_u32_u24 v22, 26, v21
    v_lshrrev_b32 v22, 8, v22
    v_mfma_f32_16x16x32_bf16 v[108:111], v[204:207], a[236:239], v[108:111]
    v_mul_u32_u24 v8, 10, v22
    s_waitcnt vmcnt(13) lgkmcnt(0)
    s_barrier
    v_mfma_f32_16x16x32_bf16 v[76:79], v[208:211], a[0:3], v[76:79]
    s_lshl_b32 s56, s55, 7
    s_add_u32 s56, s56, s1
    v_add_u32 v12, 33792, v10
    v_mfma_f32_16x16x32_bf16 v[84:87], v[208:211], a[4:7], v[84:87]
    s_add_u32 s55, s55, 1
    s_cmp_eq_u32 s55, 7
    s_cselect_b32 s55, 0, s55
    v_mfma_f32_16x16x32_bf16 v[92:95], v[208:211], a[8:11], v[92:95]
    s_add_u32 m0, s49, 0
    ds_read_b64_tr_b16 v[192:193], v12 offset:0
    v_mfma_f32_16x16x32_bf16 v[100:103], v[208:211], a[12:15], v[100:103]
    buffer_load_dwordx4 v28, s[40:43], s56 offen offset:0  lds
    v_mfma_f32_16x16x32_bf16 v[108:111], v[208:211], a[16:19], v[108:111]
    ds_read_b64_tr_b16 v[194:195], v12 offset:256
    v_sub_u32 v21, v21, v8
    v_mfma_f32_16x16x32_bf16 v[76:79], v[212:215], a[20:23], v[76:79]
    ds_read_b64_tr_b16 v[196:197], v12 offset:16896
    s_and_b32 s6, s62, 2
    v_mfma_f32_16x16x32_bf16 v[84:87], v[212:215], a[24:27], v[84:87]
    ds_read_b64_tr_b16 v[198:199], v12 offset:17152
    s_lshl_b32 s6, s6, 1
    v_mfma_f32_16x16x32_bf16 v[92:95], v[212:215], a[28:31], v[92:95]
    buffer_load_dwordx4 v29, s[40:43], s56 offen offset:1056  lds
    v_mfma_f32_16x16x32_bf16 v[100:103], v[212:215], a[32:35], v[100:103]
    buffer_load_dwordx4 v30, s[40:43], s56 offen offset:2112  lds
    v_mfma_f32_16x16x32_bf16 v[108:111], v[212:215], a[36:39], v[108:111]
    ds_read_b64_tr_b16 v[200:201], v12 offset:512
    v_mfma_f32_16x16x32_bf16 v[76:79], v[216:219], a[40:43], v[76:79]
    buffer_load_dwordx4 v31, s[40:43], s56 offen offset:3168  lds
    v_mfma_f32_16x16x32_bf16 v[84:87], v[216:219], a[44:47], v[84:87]
    ds_read_b64_tr_b16 v[202:203], v12 offset:768
    s_add_u32 s51, s56, 3584
    v_mfma_f32_16x16x32_bf16 v[92:95], v[216:219], a[48:51], v[92:95]
    ds_read_b64_tr_b16 v[204:205], v12 offset:17408
    s_add_u32 m0, s49, 4224
    v_mfma_f32_16x16x32_bf16 v[100:103], v[216:219], a[52:55], v[100:103]
    ds_read_b64_tr_b16 v[206:207], v12 offset:17664
    s_add_u32 s6, s6, s48
    v_mfma_f32_16x16x32_bf16 v[108:111], v[216:219], a[56:59], v[108:111]
    buffer_load_dwordx4 v28, s[40:43], s51 offen offset:0  lds
    v_mfma_f32_16x16x32_bf16 v[76:79], v[220:223], a[60:63], v[76:79]
    buffer_load_dwordx4 v29, s[40:43], s51 offen offset:1056  lds
    v_mfma_f32_16x16x32_bf16 v[84:87], v[220:223], a[64:67], v[84:87]
    ds_read_b64_tr_b16 v[208:209], v12 offset:8448
    v_lshl_add_u32 v23, v21, 3, s6
    v_mfma_f32_16x16x32_bf16 v[92:95], v[220:223], a[68:71], v[92:95]
    ds_read_b64_tr_b16 v[210:211], v12 offset:8704
    s_lshl_b32 s6, s6, 1
    v_mfma_f32_16x16x32_bf16 v[100:103], v[220:223], a[72:75], v[100:103]
    buffer_load_dwordx4 v30, s[40:43], s51 offen offset:2112  lds
    v_mfma_f32_16x16x32_bf16 v[108:111], v[220:223], a[76:79], v[108:111]
    s_waitcnt lgkmcnt(6)
    v_and_b32 v8, 1, v21
    v_and_b32 v21, 14, v21
    v_mfma_f32_16x16x32_bf16 v[116:119], v[192:195], a[160:163], 0
    ds_read_b64_tr_b16 v[212:213], v12 offset:25344
    v_cmp_eq_u32 vcc, 8, v0
    v_mfma_f32_16x16x32_bf16 v[124:127], v[192:195], a[164:167], 0
    ds_read_b64_tr_b16 v[214:215], v12 offset:25600
    v_lshl_add_u32 v21, v21, 3, s6
    v_mfma_f32_16x16x32_bf16 v[132:135], v[192:195], a[168:171], 0
    buffer_load_dwordx4 v31, s[40:43], s51 offen offset:3168  lds
    v_mfma_f32_16x16x32_bf16 v[140:143], v[192:195], a[172:175], 0
    ds_read_b64_tr_b16 v[216:217], v12 offset:8960
    v_add_u32 v21, v21, v8
    v_mfma_f32_16x16x32_bf16 v[148:151], v[192:195], a[176:179], 0
    ds_read_b64_tr_b16 v[218:219], v12 offset:9216
    v_cndmask_b32 v21, v21, v23, vcc
    v_mfma_f32_16x16x32_bf16 v[116:119], v[196:199], a[180:183], v[116:119]
    ds_read_b64_tr_b16 v[220:221], v12 offset:25856
    v_cmp_lt_u32 vcc, 2, v22
    v_mfma_f32_16x16x32_bf16 v[124:127], v[196:199], a[184:187], v[124:127]
    ds_read_b64_tr_b16 v[222:223], v12 offset:26112
    v_lshlrev_b32 v7, 8, v21
    v_mfma_f32_16x16x32_bf16 v[132:135], v[196:199], a[188:191], v[132:135]
    v_mul_u32_u24 v8, 20480, v22
    v_add_u32 v7, v7, v8
    v_mfma_f32_16x16x32_bf16 v[140:143], v[196:199], a[192:195], v[140:143]
    v_lshl_add_u32 v22, v22, 1, s57
    v_subrev_u32 v8, 7, v22
    v_mfma_f32_16x16x32_bf16 v[148:151], v[196:199], a[196:199], v[148:151]
    s_waitcnt lgkmcnt(8)
    v_min_u32 v8, v8, v22
    v_add_u32 v22, 1, v8
    v_mfma_f32_16x16x32_bf16 v[116:119], v[200:203], a[200:203], v[116:119]
    v_subrev_u32 v9, 7, v22
    v_min_u32 v9, v9, v22
    v_mfma_f32_16x16x32_bf16 v[124:127], v[200:203], a[204:207], v[124:127]
    v_cndmask_b32 v9, v9, v8, vcc
    v_and_b32 v22, 15, v21
    v_lshl_add_u32 v22, v22, 3, s63
    v_mfma_f32_16x16x32_bf16 v[132:135], v[200:203], a[208:211], v[132:135]
    v_lshl_add_u32 v8, v8, 7, v22
    v_lshl_add_u32 v9, v9, 7, v22
    v_mfma_f32_16x16x32_bf16 v[140:143], v[200:203], a[212:215], v[140:143]
    v_lshrrev_b32 v21, 4, v21
    v_lshlrev_b32 v22, 1, v21
    v_mfma_f32_16x16x32_bf16 v[148:151], v[200:203], a[216:219], v[148:151]
    v_cndmask_b32 v21, v21, v22, vcc
    v_addc_co_u32 v22, vcc, 0, v21, vcc
    v_mfma_f32_16x16x32_bf16 v[116:119], v[204:207], a[220:223], v[116:119]
    v_mul_u32_u24 v21, 28672, v21
    v_add_u32 v8, v8, v21
    v_mfma_f32_16x16x32_bf16 v[124:127], v[204:207], a[224:227], v[124:127]
    v_cmp_lt_u32 vcc, 4, v22
    v_mul_u32_u24 v22, 28672, v22
    v_mfma_f32_16x16x32_bf16 v[132:135], v[204:207], a[228:231], v[132:135]
    v_add_u32 v9, v9, v22
    v_mov_b32 v21, 0x10000000
    v_mfma_f32_16x16x32_bf16 v[140:143], v[204:207], a[232:235], v[140:143]
    v_cndmask_b32 v9, v9, v21, vcc
    v_sub_u32 v9, v9, v8
    v_cmp_lt_u32 vcc, 31, v0
    v_mfma_f32_16x16x32_bf16 v[148:151], v[204:207], a[236:239], v[148:151]
    v_mul_u32_u24 v6, 1792, v17
    s_waitcnt vmcnt(8) lgkmcnt(0)
    s_barrier
    v_mfma_f32_16x16x32_bf16 v[116:119], v[208:211], a[0:3], v[116:119]
    s_lshl_b32 s56, s55, 7
    v_bfe_i32 v3, v0, 4, 1
    v_cndmask_b32 v6, v6, v21, vcc
    v_and_b32 v16, 1, v17
    v_mfma_f32_16x16x32_bf16 v[124:127], v[208:211], a[4:7], v[124:127]
    s_add_u32 s56, s56, s1
    v_lshlrev_b32 v16, 4, v16
    v_mov_b32 v21, 0x3f80
    v_lshlrev_b32 v21, v16, v21
    v_mfma_f32_16x16x32_bf16 v[132:135], v[208:211], a[8:11], v[132:135]
    s_add_u32 s55, s55, 1
    s_cmp_eq_u32 s55, 7
    s_cselect_b32 s55, 0, s55
    v_lshrrev_b32 v16, 1, v17
    v_mfma_f32_16x16x32_bf16 v[140:143], v[208:211], a[12:15], v[140:143]
    s_add_u32 m0, s49, 33792
    v_cmp_eq_u32 vcc, 0, v16
    s_nop 1
    v_cndmask_b32 v22, 0, v21, vcc
    v_mfma_f32_16x16x32_bf16 v[148:151], v[208:211], a[16:19], v[148:151]
    buffer_load_dwordx4 v28, s[40:43], s56 offen offset:0  lds
    v_accvgpr_write_b32 a244, v22
    v_mfma_f32_16x16x32_bf16 v[116:119], v[212:215], a[20:23], v[116:119]
    buffer_load_dwordx4 v29, s[40:43], s56 offen offset:1056  lds
    v_cmp_eq_u32 vcc, 1, v16
    v_mfma_f32_16x16x32_bf16 v[124:127], v[212:215], a[24:27], v[124:127]
    buffer_load_dwordx4 v30, s[40:43], s56 offen offset:2112  lds
    v_cndmask_b32 v22, 0, v21, vcc
    v_mfma_f32_16x16x32_bf16 v[132:135], v[212:215], a[28:31], v[132:135]
    v_accvgpr_write_b32 a245, v22
    v_cmp_eq_u32 vcc, 2, v16
    s_nop 1
    v_cndmask_b32 v22, 0, v21, vcc
    v_accvgpr_write_b32 a246, v22
    v_cmp_eq_u32 vcc, 3, v16
    v_mfma_f32_16x16x32_bf16 v[140:143], v[212:215], a[32:35], v[140:143]
    s_nop 0
    v_cndmask_b32 v22, 0, v21, vcc
    v_accvgpr_write_b32 a247, v22
    v_add_u32 v12, 67584, v10
    v_mfma_f32_16x16x32_bf16 v[148:151], v[212:215], a[36:39], v[148:151]
    ds_read_b64_tr_b16 v[192:193], v12 offset:0
    ds_read_b64_tr_b16 v[194:195], v12 offset:256
    ds_read_b64_tr_b16 v[196:197], v12 offset:16896
    ds_read_b64_tr_b16 v[198:199], v12 offset:17152
    v_mfma_f32_16x16x32_bf16 v[116:119], v[216:219], a[40:43], v[116:119]
    buffer_load_dwordx4 v31, s[40:43], s56 offen offset:3168  lds
    v_mfma_f32_16x16x32_bf16 v[124:127], v[216:219], a[44:47], v[124:127]
    ds_read_b64_tr_b16 v[200:201], v12 offset:512
    v_mov_b32 v238, 1
    v_mfma_f32_16x16x32_bf16 v[132:135], v[216:219], a[48:51], v[132:135]
    ds_read_b64_tr_b16 v[202:203], v12 offset:768
    v_mfma_f32_16x16x32_bf16 v[140:143], v[216:219], a[52:55], v[140:143]
    buffer_store_dword v238, v19, s[8:11], 0 offen sc1
    v_mfma_f32_16x16x32_bf16 v[148:151], v[216:219], a[56:59], v[148:151]
    ds_read_b64_tr_b16 v[204:205], v12 offset:17408
    s_add_u32 s51, s56, 3584
    v_mfma_f32_16x16x32_bf16 v[116:119], v[220:223], a[60:63], v[116:119]
    ds_read_b64_tr_b16 v[206:207], v12 offset:17664
    s_add_u32 m0, s49, 38016
    v_mfma_f32_16x16x32_bf16 v[124:127], v[220:223], a[64:67], v[124:127]
    buffer_load_dwordx4 v28, s[40:43], s51 offen offset:0  lds
    v_mfma_f32_16x16x32_bf16 v[132:135], v[220:223], a[68:71], v[132:135]
    buffer_load_dwordx4 v29, s[40:43], s51 offen offset:1056  lds
    v_mfma_f32_16x16x32_bf16 v[140:143], v[220:223], a[72:75], v[140:143]
    buffer_load_dwordx4 v30, s[40:43], s51 offen offset:2112  lds
    v_mfma_f32_16x16x32_bf16 v[148:151], v[220:223], a[76:79], v[148:151]
    s_waitcnt lgkmcnt(4)
    ds_read_b64_tr_b16 v[208:209], v12 offset:8448
    v_mfma_f32_16x16x32_bf16 v[156:159], v[192:195], a[160:163], 0
    ds_read_b64_tr_b16 v[210:211], v12 offset:8704
    v_mfma_f32_16x16x32_bf16 v[164:167], v[192:195], a[164:167], 0
    ds_read_b64_tr_b16 v[212:213], v12 offset:25344
    v_mfma_f32_16x16x32_bf16 v[172:175], v[192:195], a[168:171], 0
    ds_read_b64_tr_b16 v[214:215], v12 offset:25600
    v_mfma_f32_16x16x32_bf16 v[180:183], v[192:195], a[172:175], 0
    buffer_load_dwordx4 v31, s[40:43], s51 offen offset:3168  lds
    v_mfma_f32_16x16x32_bf16 v[188:191], v[192:195], a[176:179], 0
    ds_read_b64_tr_b16 v[216:217], v12 offset:8960
    v_mfma_f32_16x16x32_bf16 v[156:159], v[196:199], a[180:183], v[156:159]
    ds_read_b64_tr_b16 v[218:219], v12 offset:9216
    v_mfma_f32_16x16x32_bf16 v[164:167], v[196:199], a[184:187], v[164:167]
    ds_read_b64_tr_b16 v[220:221], v12 offset:25856
    v_mfma_f32_16x16x32_bf16 v[172:175], v[196:199], a[188:191], v[172:175]
    ds_read_b64_tr_b16 v[222:223], v12 offset:26112
    v_mfma_f32_16x16x32_bf16 v[180:183], v[196:199], a[192:195], v[180:183]
    v_mfma_f32_16x16x32_bf16 v[188:191], v[196:199], a[196:199], v[188:191]
    s_waitcnt lgkmcnt(8)
    v_mfma_f32_16x16x32_bf16 v[156:159], v[200:203], a[200:203], v[156:159]
    v_mfma_f32_16x16x32_bf16 v[164:167], v[200:203], a[204:207], v[164:167]
    v_mfma_f32_16x16x32_bf16 v[172:175], v[200:203], a[208:211], v[172:175]
    v_mfma_f32_16x16x32_bf16 v[180:183], v[200:203], a[212:215], v[180:183]
    v_mfma_f32_16x16x32_bf16 v[188:191], v[200:203], a[216:219], v[188:191]
    v_mfma_f32_16x16x32_bf16 v[156:159], v[204:207], a[220:223], v[156:159]
    v_mfma_f32_16x16x32_bf16 v[164:167], v[204:207], a[224:227], v[164:167]
    v_mfma_f32_16x16x32_bf16 v[172:175], v[204:207], a[228:231], v[172:175]
    v_mfma_f32_16x16x32_bf16 v[180:183], v[204:207], a[232:235], v[180:183]
    v_mfma_f32_16x16x32_bf16 v[188:191], v[204:207], a[236:239], v[188:191]
    s_waitcnt vmcnt(9) lgkmcnt(0)
    s_barrier
    v_mfma_f32_16x16x32_bf16 v[156:159], v[208:211], a[0:3], v[156:159]
    s_lshl_b32 s56, s55, 7
    s_add_u32 s56, s56, s1
    v_add_u32 v12, 0, v10
    v_mfma_f32_16x16x32_bf16 v[164:167], v[208:211], a[4:7], v[164:167]
    s_add_u32 s55, s55, 1
    s_cmp_eq_u32 s55, 7
    s_cselect_b32 s55, 0, s55
    v_mfma_f32_16x16x32_bf16 v[172:175], v[208:211], a[8:11], v[172:175]
    s_add_u32 m0, s49, 67584
    ds_read_b64_tr_b16 v[192:193], v12 offset:0
    v_mfma_f32_16x16x32_bf16 v[180:183], v[208:211], a[12:15], v[180:183]
    buffer_load_dwordx4 v28, s[40:43], s56 offen offset:0  lds
    v_mfma_f32_16x16x32_bf16 v[188:191], v[208:211], a[16:19], v[188:191]
    ds_read_b64_tr_b16 v[194:195], v12 offset:256
    v_mfma_f32_16x16x32_bf16 v[156:159], v[212:215], a[20:23], v[156:159]
    ds_read_b64_tr_b16 v[196:197], v12 offset:16896
    v_mfma_f32_16x16x32_bf16 v[164:167], v[212:215], a[24:27], v[164:167]
    ds_read_b64_tr_b16 v[198:199], v12 offset:17152
    v_mfma_f32_16x16x32_bf16 v[172:175], v[212:215], a[28:31], v[172:175]
    buffer_load_dwordx4 v29, s[40:43], s56 offen offset:1056  lds
    v_mfma_f32_16x16x32_bf16 v[180:183], v[212:215], a[32:35], v[180:183]
    buffer_load_dwordx4 v30, s[40:43], s56 offen offset:2112  lds
    v_mfma_f32_16x16x32_bf16 v[188:191], v[212:215], a[36:39], v[188:191]
    ds_read_b64_tr_b16 v[200:201], v12 offset:512
    v_mfma_f32_16x16x32_bf16 v[156:159], v[216:219], a[40:43], v[156:159]
    buffer_load_dwordx4 v31, s[40:43], s56 offen offset:3168  lds
    v_mfma_f32_16x16x32_bf16 v[164:167], v[216:219], a[44:47], v[164:167]
    ds_read_b64_tr_b16 v[202:203], v12 offset:768
    s_add_u32 s51, s56, 3584
    v_mfma_f32_16x16x32_bf16 v[172:175], v[216:219], a[48:51], v[172:175]
    ds_read_b64_tr_b16 v[204:205], v12 offset:17408
    s_add_u32 m0, s49, 71808
    v_mfma_f32_16x16x32_bf16 v[180:183], v[216:219], a[52:55], v[180:183]
    ds_read_b64_tr_b16 v[206:207], v12 offset:17664
    v_mfma_f32_16x16x32_bf16 v[188:191], v[216:219], a[56:59], v[188:191]
    buffer_load_dwordx4 v28, s[40:43], s51 offen offset:0  lds
    v_mfma_f32_16x16x32_bf16 v[156:159], v[220:223], a[60:63], v[156:159]
    buffer_load_dwordx4 v29, s[40:43], s51 offen offset:1056  lds
    v_mfma_f32_16x16x32_bf16 v[164:167], v[220:223], a[64:67], v[164:167]
    ds_read_b64_tr_b16 v[208:209], v12 offset:8448
    v_mfma_f32_16x16x32_bf16 v[172:175], v[220:223], a[68:71], v[172:175]
    ds_read_b64_tr_b16 v[210:211], v12 offset:8704
    v_mfma_f32_16x16x32_bf16 v[180:183], v[220:223], a[72:75], v[180:183]
    buffer_load_dwordx4 v30, s[40:43], s51 offen offset:2112  lds
    v_mfma_f32_16x16x32_bf16 v[188:191], v[220:223], a[76:79], v[188:191]
    s_waitcnt lgkmcnt(6)
    ds_read_b64_tr_b16 v[212:213], v12 offset:25344
    v_mfma_f32_16x16x32_bf16 v[32:35], v[192:195], a[160:163], 0
    ds_read_b64_tr_b16 v[214:215], v12 offset:25600
    v_mfma_f32_16x16x32_bf16 v[40:43], v[192:195], a[164:167], 0
    buffer_load_dwordx4 v31, s[40:43], s51 offen offset:3168  lds
    v_mfma_f32_16x16x32_bf16 v[48:51], v[192:195], a[168:171], 0
    ds_read_b64_tr_b16 v[216:217], v12 offset:8960
    v_mfma_f32_16x16x32_bf16 v[56:59], v[192:195], a[172:175], 0
    ds_read_b64_tr_b16 v[218:219], v12 offset:9216
    v_mfma_f32_16x16x32_bf16 v[64:67], v[192:195], a[176:179], 0
    ds_read_b64_tr_b16 v[220:221], v12 offset:25856
    v_mfma_f32_16x16x32_bf16 v[32:35], v[196:199], a[180:183], v[32:35]
    buffer_load_dword v251, v20, s[8:11], 0 offen sc1
    v_mfma_f32_16x16x32_bf16 v[40:43], v[196:199], a[184:187], v[40:43]
    ds_read_b64_tr_b16 v[222:223], v12 offset:26112
    v_mfma_f32_16x16x32_bf16 v[48:51], v[196:199], a[188:191], v[48:51]
    v_mfma_f32_16x16x32_bf16 v[56:59], v[196:199], a[192:195], v[56:59]
    v_mfma_f32_16x16x32_bf16 v[64:67], v[196:199], a[196:199], v[64:67]
    s_waitcnt lgkmcnt(8)
    v_mfma_f32_16x16x32_bf16 v[32:35], v[200:203], a[200:203], v[32:35]
    v_mfma_f32_16x16x32_bf16 v[40:43], v[200:203], a[204:207], v[40:43]
    v_mfma_f32_16x16x32_bf16 v[48:51], v[200:203], a[208:211], v[48:51]
    v_mfma_f32_16x16x32_bf16 v[56:59], v[200:203], a[212:215], v[56:59]
    v_mfma_f32_16x16x32_bf16 v[64:67], v[200:203], a[216:219], v[64:67]
    v_mfma_f32_16x16x32_bf16 v[32:35], v[204:207], a[220:223], v[32:35]
    v_mfma_f32_16x16x32_bf16 v[40:43], v[204:207], a[224:227], v[40:43]
    v_mfma_f32_16x16x32_bf16 v[48:51], v[204:207], a[228:231], v[48:51]
    v_mfma_f32_16x16x32_bf16 v[56:59], v[204:207], a[232:235], v[56:59]
    v_mfma_f32_16x16x32_bf16 v[64:67], v[204:207], a[236:239], v[64:67]
    s_waitcnt vmcnt(9) lgkmcnt(0)
    s_barrier
    s_branch L_merge
L_end:
    s_endpgm
.section .rodata,"a"
.p2align 6
.amdhsa_kernel concat_heads__mha_block_cached__gqa_block_cached__near_ridge_kernel
  .amdhsa_next_free_vgpr 512
  .amdhsa_next_free_sgpr 102
  .amdhsa_accum_offset 256
  .amdhsa_group_segment_fixed_size 0
  .amdhsa_kernarg_size 104
  .amdhsa_user_sgpr_count 2
  .amdhsa_user_sgpr_kernarg_segment_ptr 1
  .amdhsa_system_sgpr_workgroup_id_x 1
.end_amdhsa_kernel
```
